```python
import torch

def _softmax(x, axis=-1):
    return torch.softmax(x, dim=axis)
def _gelu(x):
    return torch.nn.functional.gelu(x, approximate="tanh")
def _silu(x):
    return torch.nn.functional.silu(x)
def _sigmoid(x):
    return torch.sigmoid(x)
def _layernorm(x, axis=-1, eps=1e-5):
    m = x.mean(dim=axis, keepdim=True)
    v = x.var(dim=axis, keepdim=True, unbiased=False)
    return (x - m) / torch.sqrt(v + eps)
def _scatter_add(tgt, idx, src, axis=0):
    return tgt.clone().index_add_(axis, idx, src)
def _segment_sum(src, seg, n):
    out = torch.zeros((n,) + src.shape[1:], dtype=src.dtype)
    return out.index_add_(0, seg, src)
def _pad(x, pw):
    flat = tuple(v for pair in reversed(pw) for v in pair)
    return torch.nn.functional.pad(x, flat)

kernel_name = 'gated_mix__linear_attn_block__ssm_conv_h3__prompt'

def setup_inputs():

    _w = (lambda a: (lambda t: t.to(torch.bfloat16) if t.is_floating_point() else t)(torch.as_tensor(a)))
    def _A_setup():
        B, S, D = 1, 2048, 640
        return {
            "x": _w((lambda *s: torch.randn(*s, dtype=torch.bfloat16) * 0.05)(B, S, D)),
            "wqkv": _w((lambda *s: torch.randn(*s, dtype=torch.bfloat16) * 1.6)(D, 3 * D)),
            "wo": _w((lambda *s: torch.randn(*s, dtype=torch.bfloat16) * 0.1)(D, D)),
        }
    _A_in = _A_setup()

    def _B_setup():
        B, S, D = 1, 2048, 640
        ks = 4
        return {
            "q": _w((lambda *s: torch.randn(*s, dtype=torch.bfloat16) * 0.05)(B, S, D)),
            "k": _w((lambda *s: torch.randn(*s, dtype=torch.bfloat16) * 0.8)(B, S, D)),
            "v": _w((lambda *s: torch.randn(*s, dtype=torch.bfloat16) * 0.8)(B, S, D)),
            "shift_k": _w((lambda *s: torch.randn(*s, dtype=torch.bfloat16) * 0.8)(D, ks) * 0.5),
            "ssm_k": _w((lambda *s: torch.randn(*s, dtype=torch.bfloat16) * 0.8)(D, S) * (1.0 / S ** 0.5)),
            "ssm_D": _w((lambda *s: torch.randn(*s, dtype=torch.bfloat16) * 0.8)(D)),
        }
    _B_in = _B_setup()

    return {
        "A_x": _A_in["x"],
        "A_wqkv": _A_in["wqkv"],
        "A_wo": _A_in["wo"],
        "B_q": _B_in["q"],
        "B_k": _B_in["k"],
        "B_v": _B_in["v"],
        "B_shift_k": _B_in["shift_k"],
        "B_ssm_k": _B_in["ssm_k"],
        "B_ssm_D": _B_in["ssm_D"],
        "gate_w": _w((lambda *s: torch.randn(*s, dtype=torch.bfloat16) * 0.05)(640) * 16.0),
    }

def reference(A_x, A_wqkv, A_wo, B_q, B_k, B_v, B_shift_k, B_ssm_k, B_ssm_D, gate_w):
    def _A_ref(x, wqkv, wo):
        B, S, D = x.shape
        H = 32; Dh = D // H
        qkv = (lambda x, *d: x.permute(*d))((x @ wqkv).reshape(B, S, 3, H, Dh), 2, 0, 3, 1, 4)
        q, k, v = qkv[0], qkv[1], qkv[2]
        phi = lambda t: torch.where(t > 0, t + 1, torch.exp(t)) + 1e-6
        pq, pk = phi(q), phi(k)
        kv = torch.einsum("bhsd,bhse->bhde", pk, v)
        z = torch.einsum("bhsd->bhd", pk)
        num = torch.einsum("bhqd,bhde->bhqe", pq, kv)
        den = torch.einsum("bhqd,bhd->bhq", pq, z)[..., None] + 1e-6
        o = num / den
        return (lambda x, *d: x.permute(*d))(o, 0, 2, 1, 3).reshape(B, S, D) @ wo

    def _B_ref(q, k, v, shift_k, ssm_k, ssm_D):
        B, S, D = q.shape
        ks = shift_k.shape[-1]
        k_pad = _pad(k, ((0, 0), (ks - 1, 0), (0, 0)))
        k_shift = torch.zeros_like(k)
        for t in range(ks):
            k_shift = k_shift + k_pad[:, t:t + S, :] * shift_k[:, ks - 1 - t][None, None, :]
        kv = k_shift * v
        L = 2 * S
        kv_pad = _pad(kv, ((0, 0), (0, S), (0, 0)))
        kf_pad = _pad(ssm_k, ((0, 0), (0, S)))
        kv_f = (lambda x, axes=(-2,-1): torch.fft.rfft2(x.float(), dim=axes))(kv_pad[:, None, :, :], axes=(1, 2))
        kf_f = (lambda x, axes=(-2,-1): torch.fft.rfft2(x.float(), dim=axes))(kf_pad[:, None, :], axes=(1, 2))
        kf_f = (lambda x, *d: x.permute(*d))(kf_f, 1, 2, 0)
        y_f = kv_f * kf_f[None, :, :, :]
        y = (lambda x, s, axes=(-2,-1): torch.fft.irfft2(x, s=s, dim=axes).to(torch.bfloat16))(y_f, (1, L), axes=(1, 2))[:, 0, :S, :]
        y = y + kv * ssm_D[None, None, :]
        return q * y

    x = A_x
    g = _sigmoid((x * gate_w).sum(-1, keepdims=True))
    a = _A_ref(x, A_wqkv, A_wo)
    b = _B_ref(x, B_k, B_v, B_shift_k, B_ssm_k, B_ssm_D)
    return g * a + (1 - g) * b
```

```asm
; @launch grid=(256,1,1) block=(512,1,1) lds=162960
.amdgcn_target "amdgcn-amd-amdhsa--gfx950"
.text
.globl gated_mix__linear_attn_block__ssm_conv_h3__prompt_kernel
.p2align 8
.type gated_mix__linear_attn_block__ssm_conv_h3__prompt_kernel,@function
gated_mix__linear_attn_block__ssm_conv_h3__prompt_kernel:
    s_cmp_ge_u32 s2, 256
    s_cbranch_scc1 L_end
    s_load_dwordx16 s[16:31], s[0:1], 0
    s_load_dwordx8 s[32:39], s[0:1], 64
    s_load_dwordx2 s[40:41], s[0:1], 96
    v_and_b32 v1, 63, v0
    v_lshrrev_b32 v2, 6, v0
    s_nop 0
    v_readfirstlane_b32 s3, v2
    s_and_b32 s4, s2, 7
    s_lshr_b32 s5, s2, 3
    s_cmp_ge_u32 s5, 24
    s_cselect_b32 s15, 0, s3
    s_cmp_ge_u32 s15, 4
    s_cbranch_scc0 L_other
    s_and_b32 s8, s5, 3
    s_lshr_b32 s9, s4, 1
    s_lshl_b32 s9, s9, 2
    s_add_u32 s9, s9, s8
    s_lshr_b32 s10, s5, 2
    s_sub_u32 s15, s3, 4
    v_lshrrev_b32 v2, 3, v1
    v_and_b32 v3, 7, v1
    v_lshrrev_b32 v13, 1, v2
    v_xor_b32 v3, v3, v13
    s_lshl_b32 s78, s9, 7
    s_lshl_b32 s79, s15, 5
    s_add_u32 s78, s78, s79
    v_add_u32 v2, s78, v2
    v_mul_u32_u24 v2, 1280, v2
    v_lshl_add_u32 v4, v3, 4, v2
    v_xor_b32 v5, 64, v4
    v_add_u32 v5, 9216, v5
    v_add_u32 v6, 18432, v4
    v_add_u32 v7, 18432, v5
    s_lshl_b32 s80, s15, 12
    s_add_u32 s43, s8, s10
    s_and_b32 s43, s43, 3
    s_mul_i32 s79, s43, 245760
    s_lshl_b32 s78, s43, 7
    s_and_b32 s11, s4, 1
    s_lshl_b32 s12, s11, 2
    s_add_u32 s12, s12, s10
    s_lshl_b32 s13, s11, 1
    s_add_u32 s13, s13, s10
    s_sub_u32 s13, s13, 4
    s_lshl_b32 s14, s2, 1
    s_add_u32 s14, s14, 256
    s_mul_i32 s72, s12, 160
    s_add_u32 s72, s72, 1280
    s_mul_i32 s73, s13, 320
    s_cmp_ge_u32 s10, 4
    s_cselect_b32 s72, s73, s72
    s_cselect_b32 s74, 0, -80
    s_cselect_b32 s75, 0, 1200
    s_mul_i32 s73, s15, 61440
    s_add_u32 s73, s73, s72
    s_mul_i32 s42, s15, 5120
    s_add_u32 s42, s42, 16384
    s_movk_i32 s76, 3840
    s_movk_i32 s77, -20
    s_waitcnt lgkmcnt(0)
    s_mov_b32 s44, s16
    s_and_b32 s45, s17, 0xffff
    s_mov_b32 s46, 2621440
    s_mov_b32 s47, 0x00020000
    s_add_u32 m0, s80, 0
    s_nop 0
    buffer_load_dwordx4 v4, s[44:47], s78 offen offset:0 lds
    buffer_load_dwordx4 v5, s[44:47], s78 offen offset:1024 lds
    buffer_load_dwordx4 v6, s[44:47], s78 offen offset:2048 lds
    buffer_load_dwordx4 v7, s[44:47], s78 offen offset:3072 lds
    s_mov_b32 s48, s18
    s_and_b32 s49, s19, 0xffff
    s_mov_b32 s50, 2457600
    s_mov_b32 s51, 0x00020000
    s_mov_b32 s81, s78
    v_mul_u32_u24 v14, 3277, v1
    v_lshrrev_b32 v14, 16, v14
    v_mad_i32_i24 v13, v14, s77, v1
    v_lshrrev_b32 v15, 2, v14
    v_and_b32 v15, 2, v15
    v_xor_b32 v13, v15, v13
    v_lshl_add_u32 v8, v13, 4, s73
    v_mad_u32_u24 v8, v14, s76, v8
    v_mul_u32_u24 v13, 13, v13
    v_bfe_u32 v14, v13, 6, 1
    v_mad_i32_i24 v8, v14, s75, v8
    v_lshrrev_b32 v14, 7, v13
    v_mad_i32_i24 v8, v14, s74, v8
    s_sub_u32 s73, s73, 1024
    s_add_u32 m0, s42, 0
    s_nop 0
    buffer_load_dwordx4 v8, s[48:51], s79 offen offset:0 lds
    v_add_u32 v13, 64, v1
    v_mul_u32_u24 v14, 3277, v13
    v_lshrrev_b32 v14, 16, v14
    v_mad_i32_i24 v13, v14, s77, v13
    v_lshrrev_b32 v15, 2, v14
    v_and_b32 v15, 2, v15
    v_xor_b32 v13, v15, v13
    v_lshl_add_u32 v9, v13, 4, s73
    v_mad_u32_u24 v9, v14, s76, v9
    v_mul_u32_u24 v13, 13, v13
    v_bfe_u32 v14, v13, 6, 1
    v_mad_i32_i24 v9, v14, s75, v9
    v_lshrrev_b32 v14, 7, v13
    v_mad_i32_i24 v9, v14, s74, v9
    s_sub_u32 s73, s73, 1024
    buffer_load_dwordx4 v9, s[48:51], s79 offen offset:1024 lds
    v_add_u32 v13, 128, v1
    v_mul_u32_u24 v14, 3277, v13
    v_lshrrev_b32 v14, 16, v14
    v_mad_i32_i24 v13, v14, s77, v13
    v_lshrrev_b32 v15, 2, v14
    v_and_b32 v15, 2, v15
    v_xor_b32 v13, v15, v13
    v_lshl_add_u32 v10, v13, 4, s73
    v_mad_u32_u24 v10, v14, s76, v10
    v_mul_u32_u24 v13, 13, v13
    v_bfe_u32 v14, v13, 6, 1
    v_mad_i32_i24 v10, v14, s75, v10
    v_lshrrev_b32 v14, 7, v13
    v_mad_i32_i24 v10, v14, s74, v10
    s_sub_u32 s73, s73, 1024
    buffer_load_dwordx4 v10, s[48:51], s79 offen offset:2048 lds
    v_add_u32 v13, 192, v1
    v_mul_u32_u24 v14, 3277, v13
    v_lshrrev_b32 v14, 16, v14
    v_mad_i32_i24 v13, v14, s77, v13
    v_lshrrev_b32 v15, 2, v14
    v_and_b32 v15, 2, v15
    v_xor_b32 v13, v15, v13
    v_lshl_add_u32 v11, v13, 4, s73
    v_mad_u32_u24 v11, v14, s76, v11
    v_mul_u32_u24 v13, 13, v13
    v_bfe_u32 v14, v13, 6, 1
    v_mad_i32_i24 v11, v14, s75, v11
    v_lshrrev_b32 v14, 7, v13
    v_mad_i32_i24 v11, v14, s74, v11
    s_add_u32 s73, s73, 3072
    buffer_load_dwordx4 v11, s[48:51], s79 offen offset:3072 lds
    v_add_u32 v13, 256, v1
    v_mul_u32_u24 v14, 3277, v13
    v_lshrrev_b32 v14, 16, v14
    v_mad_i32_i24 v13, v14, s77, v13
    v_lshrrev_b32 v15, 2, v14
    v_and_b32 v15, 2, v15
    v_xor_b32 v13, v15, v13
    v_lshl_add_u32 v12, v13, 4, s73
    v_mad_u32_u24 v12, v14, s76, v12
    v_mul_u32_u24 v13, 13, v13
    v_bfe_u32 v14, v13, 6, 1
    v_mad_i32_i24 v12, v14, s75, v12
    v_lshrrev_b32 v14, 7, v13
    v_mad_i32_i24 v12, v14, s74, v12
    s_mov_b32 s76, 2271560481
    s_mov_b32 s77, 9
    s_cmp_eq_u32 s43, 1
    s_cselect_b32 s76, 2490781746, s76
    s_cselect_b32 s77, 8, s77
    s_cmp_eq_u32 s43, 2
    s_cselect_b32 s76, 2236047619, s76
    s_cselect_b32 s77, 9, s77
    s_cmp_eq_u32 s43, 3
    s_cselect_b32 s76, 2522116624, s76
    s_cselect_b32 s77, 8, s77
    s_add_u32 m0, s42, 4096
    s_nop 0
    buffer_load_dwordx4 v12, s[48:51], s79 offen offset:0 lds
    s_and_b32 s78, s76, 15
    s_lshr_b64 s[76:77], s[76:77], 4
    s_mul_i32 s79, s78, 245760
    s_lshl_b32 s78, s78, 7
    s_branch L_ld1
L_other:
    s_lshl_b32 s73, s5, 3
    s_add_u32 s73, s73, s3
    s_and_b32 s74, s73, 0xc7
    s_cmp_eq_u32 s74, 0xc0
    s_cbranch_scc0 L_nocpf
    s_getpc_b64 s[74:75]
L_pc:
    s_sub_u32 s73, s5, 24
    s_lshl_b32 s73, s73, 6
    v_add_u32 v2, s73, v1
    v_lshlrev_b32 v2, 7, v2
    v_min_u32 v2, L_end-L_pc-4, v2
    v_mov_b32 v3, s75
    v_add_co_u32 v2, vcc, s74, v2
    s_nop 1
    v_addc_co_u32 v3, vcc, 0, v3, vcc
    global_load_dword v255, v[2:3], off
L_nocpf:
    s_lshl_b32 s9, s4, 3
    s_add_u32 s9, s9, s5
    s_sub_u32 s9, s9, 24
    s_mul_i32 s80, s9, 8
    s_add_u32 s80, s80, 128
    s_mul_i32 s72, s2, 2
    s_add_u32 s72, s72, 4294967040
    s_cmp_ge_u32 s5, 24
    s_cselect_b32 s80, s80, s72
    s_cselect_b32 s72, 8, 2
    s_mul_i32 s73, s2, 0
    s_cmp_ge_u32 s5, 16
    s_cselect_b32 s80, s80, s73
    s_cselect_b32 s72, s72, 0
    s_add_u32 s80, s80, s3
    v_mov_b32 v158, 2147483392
    s_cmp_ge_u32 s3, s72
    s_cbranch_scc1 L_nopp
    s_and_b32 s78, s80, 63
    s_lshr_b32 s79, s80, 6
    v_lshrrev_b32 v2, 4, v1
    v_and_b32 v3, 15, v1
    s_lshl_b32 s72, s78, 2
    v_add_u32 v4, s72, v2
    v_mul_u32_u24 v4, 10240, v4
    s_lshl_b32 s72, s79, 4
    v_add_u32 v6, s72, v3
    v_lshl_add_u32 v4, v6, 3, v4
    v_subrev_u32 v5, 3840, v4
    v_lshlrev_b32 v6, 5, v6
    s_movk_i32 s72, 5120
    s_waitcnt lgkmcnt(0)
    s_mov_b32 s48, s24
    s_and_b32 s49, s25, 0xffff
    s_mov_b32 s50, 2621440
    s_mov_b32 s51, 0x00020000
    s_mov_b32 s52, s26
    s_and_b32 s53, s27, 0xffff
    s_mov_b32 s54, 2621440
    s_mov_b32 s55, 0x00020000
    s_mov_b32 s56, s28
    s_and_b32 s57, s29, 0xffff
    s_mov_b32 s58, 5120
    s_mov_b32 s59, 0x00020000
    buffer_load_dwordx2 v[24:25], v5, s[48:51], 0 offen offset:0 nt
    buffer_load_dwordx2 v[26:27], v5, s[48:51], 0 offen offset:1280 nt
    buffer_load_dwordx2 v[28:29], v5, s[48:51], 0 offen offset:2560 nt
    buffer_load_dwordx4 v[64:67], v6, s[56:59], 0 offen offset:0
    buffer_load_dwordx4 v[68:71], v6, s[56:59], 0 offen offset:16
    buffer_load_dwordx2 v[30:31], v4, s[48:51], 0 offen offset:0 nt
    buffer_load_dwordx2 v[32:33], v4, s[48:51], 0 offen offset:1280 nt
    buffer_load_dwordx2 v[34:35], v4, s[48:51], 0 offen offset:2560 nt
    buffer_load_dwordx2 v[36:37], v4, s[48:51], 0 offen offset:3840 nt
    buffer_load_dwordx2 v[46:47], v4, s[52:55], 0 offen offset:0 nt
    buffer_load_dwordx2 v[48:49], v4, s[52:55], 0 offen offset:1280 nt
    buffer_load_dwordx2 v[50:51], v4, s[52:55], 0 offen offset:2560 nt
    buffer_load_dwordx2 v[52:53], v4, s[52:55], 0 offen offset:3840 nt
    buffer_load_dwordx2 v[38:39], v4, s[48:51], s72 offen offset:0 nt
    buffer_load_dwordx2 v[40:41], v4, s[48:51], s72 offen offset:1280 nt
    buffer_load_dwordx2 v[42:43], v4, s[48:51], s72 offen offset:2560 nt
    buffer_load_dwordx2 v[44:45], v4, s[48:51], s72 offen offset:3840 nt
    buffer_load_dwordx2 v[54:55], v4, s[52:55], s72 offen offset:0 nt
    buffer_load_dwordx2 v[56:57], v4, s[52:55], s72 offen offset:1280 nt
    buffer_load_dwordx2 v[58:59], v4, s[52:55], s72 offen offset:2560 nt
    buffer_load_dwordx2 v[60:61], v4, s[52:55], s72 offen offset:3840 nt
    s_mul_i32 s72, s3, 4352
    s_add_u32 s72, s72, 110592
    s_add_u32 s73, s72, 34816
    s_cmp_ge_u32 s5, 24
    s_cselect_b32 s72, s72, s73
    v_mul_u32_u24 v4, 272, v3
    v_sub_u32 v5, 3, v2
    v_lshl_add_u32 v4, v5, 2, v4
    v_add_u32 v156, s72, v4
    v_mul_u32_u24 v4, 272, v2
    v_lshl_add_u32 v4, v3, 4, v4
    v_add_u32 v157, s72, v4
    v_lshrrev_b32 v4, 3, v1
    v_mul_u32_u24 v4, 8320, v4
    v_and_b32 v5, 7, v1
    v_lshl_add_u32 v4, v5, 4, v4
    s_mul_i32 s72, s79, 266240
    s_lshl_b32 s73, s78, 7
    s_add_u32 s72, s72, s73
    v_add_u32 v158, s72, v4
L_nopp:
    s_lshr_b32 s6, s4, 1
    s_lshl_b32 s6, s6, 3
    s_and_b32 s7, s5, 7
    s_add_u32 s6, s6, s7
    s_and_b32 s7, s4, 1
    s_lshl_b32 s7, s7, 2
    s_lshr_b32 s72, s5, 3
    s_add_u32 s72, s72, s5
    s_and_b32 s72, s72, 3
    s_add_u32 s7, s7, s72
    s_cmp_ge_u32 s5, 24
    s_cbranch_scc1 L_aux
    s_and_b32 s8, s5, 3
    s_lshr_b32 s9, s4, 1
    s_lshl_b32 s9, s9, 2
    s_add_u32 s9, s9, s8
    s_lshr_b32 s10, s5, 2
    s_and_b32 s11, s4, 1
    s_lshl_b32 s12, s11, 2
    s_add_u32 s12, s12, s10
    s_lshl_b32 s13, s11, 1
    s_add_u32 s13, s13, s10
    s_sub_u32 s13, s13, 4
    s_lshl_b32 s14, s2, 1
    s_add_u32 s14, s14, 256
    s_branch L_comp
L_ld1:
    s_lshr_b32 s6, s4, 1
    s_lshl_b32 s6, s6, 3
    s_and_b32 s7, s5, 7
    s_add_u32 s6, s6, s7
    s_and_b32 s7, s4, 1
    s_lshl_b32 s7, s7, 2
    s_lshr_b32 s72, s5, 3
    s_add_u32 s72, s72, s5
    s_and_b32 s72, s72, 3
    s_add_u32 s7, s7, s72
    s_mov_b32 s52, s34
    s_and_b32 s53, s35, 0xffff
    s_mov_b32 s54, 1280
    s_mov_b32 s55, 0x00020000
    v_lshrrev_b32 v13, 4, v1
    s_lshl_b32 s72, s13, 2
    v_add_u32 v13, s72, v13
    v_xor_b32 v13, v13, v1
    v_and_b32 v13, 7, v13
    v_lshlrev_b32 v20, 4, v13
    s_and_b32 s72, s13, 3
    s_lshl_b32 s72, s72, 10
    s_add_u32 s72, s72, s80
    v_lshlrev_b32 v21, 4, v1
    v_add_u32 v21, s72, v21
    v_add_u32 v23, 73728, v21
    v_mov_b32 v22, 0
    s_mov_b32 s60, s40
    s_and_b32 s61, s41, 0xffff
    s_mov_b32 s62, 268435456
    s_mov_b32 s63, 0x00020000
    s_mov_b32 s56, s38
    s_and_b32 s57, s39, 0xffff
    s_mov_b32 s58, 256
    s_mov_b32 s59, 0x00020000
    s_mov_b32 s68, s30
    s_and_b32 s69, s31, 0xffff
    s_mov_b32 s70, 2621440
    s_mov_b32 s71, 0x00020000
    s_mov_b32 s64, s20
    s_and_b32 s65, s21, 0xffff
    s_mov_b32 s66, 819200
    s_mov_b32 s67, 0x00020000
    s_lshr_b32 s72, s15, 1
    s_add_u32 s43, s14, s72
    s_mul_i32 s27, s72, 8752
    s_add_u32 s27, s27, 145408
    s_and_b32 s28, s15, 1
    s_lshl_b32 s72, s12, 2
    s_add_u32 s72, s72, s15
    s_mul_i32 s72, s72, 28672
    s_mul_i32 s73, s9, 1792
    s_add_u32 s72, s72, s73
    s_add_u32 s11, s72, 2752512
    s_cmp_ge_u32 s10, 4
    s_cselect_b32 s11, 2147483392, s11
    s_mul_i32 s72, s7, 160
    v_add_u32 v16, 0, v1
    v_mul_u32_u24 v17, 6554, v16
    v_lshrrev_b32 v17, 16, v17
    v_mul_u32_u24 v18, 10, v17
    v_sub_u32 v16, v16, v18
    v_and_b32 v18, 17, v17
    v_bfe_u32 v19, v17, 1, 2
    v_lshl_add_u32 v18, v19, 2, v18
    v_bfe_u32 v19, v17, 3, 1
    v_lshl_add_u32 v18, v19, 1, v18
    v_mul_u32_u24 v18, 1280, v18
    v_lshl_add_u32 v18, v16, 4, v18
    v_add_u32 v44, s72, v18
    v_add_u32 v16, 64, v1
    v_mul_u32_u24 v17, 6554, v16
    v_lshrrev_b32 v17, 16, v17
    v_mul_u32_u24 v18, 10, v17
    v_sub_u32 v16, v16, v18
    v_and_b32 v18, 17, v17
    v_bfe_u32 v19, v17, 1, 2
    v_lshl_add_u32 v18, v19, 2, v18
    v_bfe_u32 v19, v17, 3, 1
    v_lshl_add_u32 v18, v19, 1, v18
    v_mul_u32_u24 v18, 1280, v18
    v_lshl_add_u32 v18, v16, 4, v18
    v_add_u32 v45, s72, v18
    v_add_u32 v16, 128, v1
    v_mul_u32_u24 v17, 6554, v16
    v_lshrrev_b32 v17, 16, v17
    v_mul_u32_u24 v18, 10, v17
    v_sub_u32 v16, v16, v18
    v_and_b32 v18, 17, v17
    v_bfe_u32 v19, v17, 1, 2
    v_lshl_add_u32 v18, v19, 2, v18
    v_bfe_u32 v19, v17, 3, 1
    v_lshl_add_u32 v18, v19, 1, v18
    v_mul_u32_u24 v18, 1280, v18
    v_lshl_add_u32 v18, v16, 4, v18
    v_add_u32 v46, s72, v18
    v_add_u32 v16, 192, v1
    v_mul_u32_u24 v17, 6554, v16
    v_lshrrev_b32 v17, 16, v17
    v_mul_u32_u24 v18, 10, v17
    v_sub_u32 v16, v16, v18
    v_and_b32 v18, 17, v17
    v_bfe_u32 v19, v17, 1, 2
    v_lshl_add_u32 v18, v19, 2, v18
    v_bfe_u32 v19, v17, 3, 1
    v_lshl_add_u32 v18, v19, 1, v18
    v_mul_u32_u24 v18, 1280, v18
    v_lshl_add_u32 v18, v16, 4, v18
    v_add_u32 v47, s72, v18
    v_add_u32 v16, 256, v1
    v_mul_u32_u24 v17, 6554, v16
    v_lshrrev_b32 v17, 16, v17
    v_mul_u32_u24 v18, 10, v17
    v_sub_u32 v16, v16, v18
    v_and_b32 v18, 17, v17
    v_bfe_u32 v19, v17, 1, 2
    v_lshl_add_u32 v18, v19, 2, v18
    v_bfe_u32 v19, v17, 3, 1
    v_lshl_add_u32 v18, v19, 1, v18
    v_mul_u32_u24 v18, 1280, v18
    v_lshl_add_u32 v18, v16, 4, v18
    v_add_u32 v48, s72, v18
    s_and_b32 s72, s3, 3
    s_mul_i32 s22, s72, 15360
    s_mul_i32 s23, s72, 10240
    s_mul_i32 s25, s72, 204800
    s_add_u32 s26, s25, 204800
    s_and_b32 s73, s5, 7
    s_cmp_ge_u32 s73, 5
    s_cselect_b32 s1, 5, 0
    s_sub_u32 s73, s73, s1
    s_mul_i32 s24, s73, 40960
    s_add_u32 s24, s24, s25
    v_and_b32 v50, 15, v1
    v_lshrrev_b32 v51, 4, v1
    s_and_b32 s75, s5, 7
    s_cmp_ge_u32 s75, 5
    s_cselect_b32 s1, 5, 0
    s_sub_u32 s75, s75, s1
    s_and_b32 s1, s3, 3
    v_lshrrev_b32 v52, 1, v51
    v_lshlrev_b32 v52, 3, v52
    v_bfe_u32 v53, v1, 2, 2
    v_lshl_add_u32 v52, v53, 1, v52
    v_and_b32 v53, 1, v51
    v_add_u32 v52, v52, v53
    v_mul_u32_u24 v52, 160, v52
    v_and_b32 v53, 3, v1
    v_lshl_add_u32 v52, v53, 3, v52
    s_sub_u32 s75, 5, s75
    s_cmp_ge_u32 s75, 5
    s_cselect_b32 s75, 0, s75
    s_mul_i32 s72, s1, 15360
    s_add_u32 s72, s72, 40960
    s_mul_i32 s73, s1, 10240
    s_sub_u32 s73, s73, 15360
    s_cmp_ge_u32 s75, 3
    s_cselect_b32 s72, s73, s72
    s_mul_i32 s73, s75, 5120
    s_add_u32 s72, s72, s73
    v_add_u32 v236, s72, v52
    s_add_u32 s75, s75, 1
    s_cmp_ge_u32 s75, 5
    s_cselect_b32 s75, 0, s75
    s_mul_i32 s72, s1, 15360
    s_add_u32 s72, s72, 40960
    s_mul_i32 s73, s1, 10240
    s_sub_u32 s73, s73, 15360
    s_cmp_ge_u32 s75, 3
    s_cselect_b32 s72, s73, s72
    s_mul_i32 s73, s75, 5120
    s_add_u32 s72, s72, s73
    v_add_u32 v237, s72, v52
    s_add_u32 s75, s75, 1
    s_cmp_ge_u32 s75, 5
    s_cselect_b32 s75, 0, s75
    s_mul_i32 s72, s1, 15360
    s_add_u32 s72, s72, 40960
    s_mul_i32 s73, s1, 10240
    s_sub_u32 s73, s73, 15360
    s_cmp_ge_u32 s75, 3
    s_cselect_b32 s72, s73, s72
    s_mul_i32 s73, s75, 5120
    s_add_u32 s72, s72, s73
    v_add_u32 v238, s72, v52
    s_add_u32 s75, s75, 1
    s_cmp_ge_u32 s75, 5
    s_cselect_b32 s75, 0, s75
    s_mul_i32 s72, s1, 15360
    s_add_u32 s72, s72, 40960
    s_mul_i32 s73, s1, 10240
    s_sub_u32 s73, s73, 15360
    s_cmp_ge_u32 s75, 3
    s_cselect_b32 s72, s73, s72
    s_mul_i32 s73, s75, 5120
    s_add_u32 s72, s72, s73
    v_add_u32 v239, s72, v52
    s_add_u32 s75, s75, 1
    s_cmp_ge_u32 s75, 5
    s_cselect_b32 s75, 0, s75
    s_mul_i32 s72, s1, 15360
    s_add_u32 s72, s72, 40960
    s_mul_i32 s73, s1, 10240
    s_sub_u32 s73, s73, 15360
    s_cmp_ge_u32 s75, 3
    s_cselect_b32 s72, s73, s72
    s_mul_i32 s73, s75, 5120
    s_add_u32 s72, s72, s73
    v_add_u32 v240, s72, v52
    s_add_u32 s75, s75, 1
    v_lshrrev_b32 v52, 2, v1
    v_lshlrev_b32 v52, 7, v52
    v_lshl_add_u32 v52, v53, 3, v52
    s_lshr_b32 s73, s3, 2
    s_lshl_b32 s72, s73, 11
    s_lshl_b32 s74, s1, 5
    s_add_u32 s72, s72, s74
    s_add_u32 s72, s72, 81920
    v_add_u32 v249, s72, v52
    s_mul_i32 s72, s1, 10752
    s_add_u32 s72, s72, 102400
    v_lshlrev_b32 v52, 4, v51
    v_and_b32 v54, 8, v50
    v_lshlrev_b32 v54, 2, v54
    v_xor_b32 v54, v54, v52
    v_lshl_add_u32 v54, v50, 6, v54
    v_add_u32 v244, s72, v54
    v_lshrrev_b32 v54, 2, v50
    v_add_u32 v54, 16, v54
    v_lshl_add_u32 v54, v54, 6, v52
    v_xor_b32 v55, 32, v52
    v_add_u32 v55, 1280, v55
    v_cmp_eq_u32 vcc, 0, v53
    s_nop 1
    v_cndmask_b32 v54, v55, v54, vcc
    v_add_u32 v245, s72, v54
    v_lshlrev_b32 v251, 4, v1
    s_mul_i32 s72, s1, 20480
    s_xor_b32 s74, s73, s7
    s_and_b32 s74, s74, 1
    s_mul_i32 s74, s74, 10240
    s_add_u32 s72, s72, s74
    v_add_u32 v246, s72, v251
    s_mul_i32 s72, s1, 5120
    s_lshl_b32 s74, s73, 10
    s_add_u32 s72, s72, s74
    v_add_u32 v247, s72, v251
    s_lshl_b32 s72, s6, 6
    s_lshl_b32 s74, s1, 4
    s_add_u32 s72, s72, s74
    v_add_u32 v52, s72, v50
    v_mul_u32_u24 v52, 1280, v52
    v_lshl_add_u32 v52, v51, 3, v52
    s_mul_i32 s72, s7, 160
    s_lshl_b32 s74, s73, 5
    s_add_u32 s72, s72, s74
    v_add_u32 v248, s72, v52
    s_mul_i32 s72, s7, 80
    s_lshl_b32 s74, s3, 3
    s_add_u32 s72, s72, s74
    v_lshrrev_b32 v52, 3, v1
    v_add_u32 v52, s72, v52
    v_mul_u32_u24 v52, 4224, v52
    v_and_b32 v54, 7, v1
    v_lshl_add_u32 v52, v54, 4, v52
    s_lshl_b32 s72, s6, 7
    s_add_u32 s72, s72, 6815744
    v_add_u32 v250, s72, v52
    v_lshlrev_b32 v50, 1, v1
    s_add_u32 s72, s1, 5
    s_and_b32 s73, s72, 3
    s_lshl_b32 s73, s73, 4
    s_bfe_u32 s72, s72, 0x10002
    s_lshl_b32 s72, s72, 3
    s_add_u32 s73, s73, s72
    s_mul_i32 s72, s1, 1344
    s_add_u32 s72, s72, 102400
    v_mul_u32_u24 v51, 3121, v50
    v_lshrrev_b32 v51, 16, v51
    v_mul_u32_u24 v52, 21, v51
    v_sub_u32 v52, v50, v52
    v_and_b32 v53, 3, v52
    v_lshrrev_b32 v54, 2, v52
    v_lshl_add_u32 v53, v53, 2, v54
    v_cmp_gt_u32 vcc, 16, v52
    s_nop 1
    v_cndmask_b32 v52, v52, v53, vcc
    v_add_u32 v51, s1, v51
    v_and_b32 v53, 3, v51
    v_lshlrev_b32 v53, 4, v53
    v_and_b32 v54, 8, v52
    v_lshlrev_b32 v54, 2, v54
    v_cmp_eq_u32 vcc, 20, v52
    s_nop 1
    v_cndmask_b32 v54, v54, 32, vcc
    v_xor_b32 v53, v53, v54
    v_lshl_add_u32 v52, v52, 6, v53
    v_lshrrev_b32 v51, 2, v51
    v_lshl_add_u32 v52, v51, 3, v52
    v_cmp_gt_u32 vcc, 105, v50
    v_mov_b32 v53, s73
    s_nop 0
    v_cndmask_b32 v52, v53, v52, vcc
    v_add_u32 v241, s72, v52
    v_add_u32 v50, 1, v50
    v_mul_u32_u24 v51, 3121, v50
    v_lshrrev_b32 v51, 16, v51
    v_mul_u32_u24 v52, 21, v51
    v_sub_u32 v52, v50, v52
    v_and_b32 v53, 3, v52
    v_lshrrev_b32 v54, 2, v52
    v_lshl_add_u32 v53, v53, 2, v54
    v_cmp_gt_u32 vcc, 16, v52
    s_nop 1
    v_cndmask_b32 v52, v52, v53, vcc
    v_add_u32 v51, s1, v51
    v_and_b32 v53, 3, v51
    v_lshlrev_b32 v53, 4, v53
    v_and_b32 v54, 8, v52
    v_lshlrev_b32 v54, 2, v54
    v_cmp_eq_u32 vcc, 20, v52
    s_nop 1
    v_cndmask_b32 v54, v54, 32, vcc
    v_xor_b32 v53, v53, v54
    v_lshl_add_u32 v52, v52, 6, v53
    v_lshrrev_b32 v51, 2, v51
    v_lshl_add_u32 v52, v51, 3, v52
    v_cmp_gt_u32 vcc, 105, v50
    v_mov_b32 v53, s73
    s_nop 0
    v_cndmask_b32 v52, v53, v52, vcc
    v_add_u32 v242, s72, v52
    s_cmp_ge_u32 s10, 4
    s_cbranch_scc1 L_ldq
    s_mov_b32 s29, 2147483392
    s_add_u32 m0, s80, 36864
    s_nop 0
    buffer_load_dwordx4 v4, s[44:47], s78 offen offset:0 lds
    buffer_load_dwordx4 v5, s[44:47], s78 offen offset:1024 lds
    buffer_load_dwordx4 v6, s[44:47], s78 offen offset:2048 lds
    buffer_load_dwordx4 v7, s[44:47], s78 offen offset:3072 lds
    s_add_u32 m0, s42, 36864
    s_nop 0
    buffer_load_dwordx4 v8, s[48:51], s79 offen offset:0 lds
    buffer_load_dwordx4 v9, s[48:51], s79 offen offset:1024 lds
    s_waitcnt vmcnt(6)
    s_barrier
    buffer_load_dwordx4 v10, s[48:51], s79 offen offset:2048 lds
    buffer_load_dwordx4 v11, s[48:51], s79 offen offset:3072 lds
    s_add_u32 m0, s42, 40960
    s_nop 0
    buffer_load_dwordx4 v12, s[48:51], s79 offen offset:0 lds
    s_and_b32 s78, s76, 15
    s_lshr_b64 s[76:77], s[76:77], 4
    s_mul_i32 s79, s78, 245760
    s_lshl_b32 s78, s78, 7
    s_add_u32 m0, s80, 73728
    s_nop 0
    buffer_load_dwordx4 v4, s[44:47], s78 offen offset:0 lds
    buffer_load_dwordx4 v5, s[44:47], s78 offen offset:1024 lds
    buffer_load_dwordx4 v6, s[44:47], s78 offen offset:2048 lds
    buffer_load_dwordx4 v7, s[44:47], s78 offen offset:3072 lds
    s_add_u32 m0, s42, 73728
    s_nop 0
    buffer_load_dwordx4 v8, s[48:51], s79 offen offset:0 lds
    buffer_load_dwordx4 v9, s[48:51], s79 offen offset:1024 lds
    s_waitcnt vmcnt(6)
    s_barrier
    buffer_load_dwordx4 v10, s[48:51], s79 offen offset:2048 lds
    buffer_load_dwordx4 v11, s[48:51], s79 offen offset:3072 lds
    s_add_u32 m0, s42, 77824
    s_nop 0
    buffer_load_dwordx4 v12, s[48:51], s79 offen offset:0 lds
    s_and_b32 s78, s76, 15
    s_lshr_b64 s[76:77], s[76:77], 4
    s_mul_i32 s79, s78, 245760
    s_lshl_b32 s78, s78, 7
    s_add_u32 m0, s80, 0
    s_nop 0
    buffer_load_dwordx4 v4, s[44:47], s78 offen offset:0 lds
    buffer_load_dwordx4 v5, s[44:47], s78 offen offset:1024 lds
    buffer_load_dwordx4 v6, s[44:47], s78 offen offset:2048 lds
    buffer_load_dwordx4 v7, s[44:47], s78 offen offset:3072 lds
    s_add_u32 m0, s42, 0
    s_nop 0
    buffer_load_dwordx4 v8, s[48:51], s79 offen offset:0 lds
    buffer_load_dwordx4 v9, s[48:51], s79 offen offset:1024 lds
    s_waitcnt vmcnt(6)
    s_barrier
    buffer_load_dwordx4 v10, s[48:51], s79 offen offset:2048 lds
    buffer_load_dwordx4 v11, s[48:51], s79 offen offset:3072 lds
    s_add_u32 m0, s42, 4096
    s_nop 0
    buffer_load_dwordx4 v12, s[48:51], s79 offen offset:0 lds
    s_and_b32 s78, s76, 15
    s_lshr_b64 s[76:77], s[76:77], 4
    s_mul_i32 s79, s78, 245760
    s_lshl_b32 s78, s78, 7
    s_add_u32 m0, s80, 36864
    s_nop 0
    buffer_load_dwordx4 v4, s[44:47], s78 offen offset:0 lds
    buffer_load_dwordx4 v5, s[44:47], s78 offen offset:1024 lds
    buffer_load_dwordx4 v6, s[44:47], s78 offen offset:2048 lds
    buffer_load_dwordx4 v7, s[44:47], s78 offen offset:3072 lds
    s_add_u32 m0, s42, 36864
    s_nop 0
    buffer_load_dwordx4 v8, s[48:51], s79 offen offset:0 lds
    buffer_load_dwordx4 v9, s[48:51], s79 offen offset:1024 lds
    s_waitcnt vmcnt(6)
    s_barrier
    buffer_load_dwordx4 v10, s[48:51], s79 offen offset:2048 lds
    buffer_load_dwordx4 v11, s[48:51], s79 offen offset:3072 lds
    s_add_u32 m0, s42, 40960
    s_nop 0
    buffer_load_dwordx4 v12, s[48:51], s79 offen offset:0 lds
    s_and_b32 s78, s76, 15
    s_lshr_b64 s[76:77], s[76:77], 4
    s_mul_i32 s79, s78, 245760
    s_lshl_b32 s78, s78, 7
    v_lshlrev_b32 v16, 4, v1
    s_lshl_b32 s72, s43, 12
    s_lshl_b32 s73, s28, 11
    s_add_u32 s72, s72, s73
    s_add_u32 s73, s73, s27
    s_add_u32 m0, s73, 32
    s_nop 0
    buffer_load_dwordx4 v16, s[68:71], s72 offen offset:0 nt lds
    buffer_load_dwordx4 v16, s[68:71], s72 offen offset:1024 nt lds
    v_mov_b32 v18, 0
    v_mov_b32 v19, 0
    v_bfe_u32 v16, v1, 4, 1
    v_mul_u32_u24 v16, 1152, v16
    v_and_b32 v17, 15, v1
    v_lshl_add_u32 v16, v17, 3, v16
    s_mul_i32 s72, s28, 2304
    s_add_u32 s72, s72, s27
    v_add_u32 v16, s72, v16
    ds_write_b64 v16, v[18:19] offset:5152
    v_and_b32 v16, 3, v1
    v_lshlrev_b32 v16, 3, v16
    v_add_u32 v16, s27, v16
    ds_write_b64 v16, v[18:19]
    v_and_b32 v16, 1, v1
    v_lshlrev_b32 v16, 3, v16
    v_add_u32 v16, s27, v16
    ds_write_b64 v16, v[18:19] offset:8736
    s_mov_b32 s68, s32
    s_and_b32 s69, s33, 0xffff
    s_mov_b32 s70, 1280
    s_mov_b32 s71, 0x00020000
    s_lshl_b32 s72, s43, 1
    v_mov_b32 v254, 0
    buffer_load_short_d16_hi v254, off, s[68:71], s72
    s_add_u32 m0, s80, 73728
    s_nop 0
    buffer_load_dwordx4 v4, s[44:47], s78 offen offset:0 lds
    buffer_load_dwordx4 v5, s[44:47], s78 offen offset:1024 lds
    buffer_load_dwordx4 v6, s[44:47], s78 offen offset:2048 lds
    buffer_load_dwordx4 v7, s[44:47], s78 offen offset:3072 lds
    s_add_u32 m0, s42, 73728
    s_nop 0
    buffer_load_dwordx4 v8, s[48:51], s79 offen offset:0 lds
    buffer_load_dwordx4 v9, s[48:51], s79 offen offset:1024 lds
    s_waitcnt vmcnt(6)
    s_barrier
    buffer_load_dwordx4 v10, s[48:51], s79 offen offset:2048 lds
    buffer_load_dwordx4 v11, s[48:51], s79 offen offset:3072 lds
    s_add_u32 m0, s42, 77824
    s_nop 0
    buffer_load_dwordx4 v12, s[48:51], s79 offen offset:0 lds
    s_and_b32 s78, s76, 15
    s_lshr_b64 s[76:77], s[76:77], 4
    s_mul_i32 s79, s78, 245760
    s_lshl_b32 s78, s78, 7
    s_add_u32 m0, s80, 0
    s_nop 0
    buffer_load_dwordx4 v4, s[44:47], s78 offen offset:0 lds
    buffer_load_dwordx4 v5, s[44:47], s78 offen offset:1024 lds
    buffer_load_dwordx4 v6, s[44:47], s78 offen offset:2048 lds
    buffer_load_dwordx4 v7, s[44:47], s78 offen offset:3072 lds
    s_add_u32 m0, s42, 0
    s_nop 0
    buffer_load_dwordx4 v8, s[48:51], s79 offen offset:0 lds
    buffer_load_dwordx4 v9, s[48:51], s79 offen offset:1024 lds
    s_waitcnt vmcnt(6)
    s_barrier
    buffer_load_dwordx4 v10, s[48:51], s79 offen offset:2048 lds
    buffer_load_dwordx4 v11, s[48:51], s79 offen offset:3072 lds
    s_add_u32 m0, s42, 4096
    s_nop 0
    buffer_load_dwordx4 v12, s[48:51], s79 offen offset:0 lds
    s_and_b32 s78, s76, 15
    s_lshr_b64 s[76:77], s[76:77], 4
    s_mul_i32 s79, s78, 245760
    s_lshl_b32 s78, s78, 7
    s_add_u32 m0, s80, 36864
    s_nop 0
    buffer_load_dwordx4 v4, s[44:47], s78 offen offset:0 lds
    buffer_load_dwordx4 v5, s[44:47], s78 offen offset:1024 lds
    buffer_load_dwordx4 v6, s[44:47], s78 offen offset:2048 lds
    buffer_load_dwordx4 v7, s[44:47], s78 offen offset:3072 lds
    s_add_u32 m0, s42, 36864
    s_nop 0
    buffer_load_dwordx4 v8, s[48:51], s79 offen offset:0 lds
    buffer_load_dwordx4 v9, s[48:51], s79 offen offset:1024 lds
    s_waitcnt vmcnt(6)
    s_barrier
    buffer_load_dwordx4 v10, s[48:51], s79 offen offset:2048 lds
    buffer_load_dwordx4 v11, s[48:51], s79 offen offset:3072 lds
    s_add_u32 m0, s42, 40960
    s_nop 0
    buffer_load_dwordx4 v12, s[48:51], s79 offen offset:0 lds
    s_and_b32 s78, s76, 15
    s_lshr_b64 s[76:77], s[76:77], 4
    s_mul_i32 s79, s78, 245760
    s_lshl_b32 s78, s78, 7
    s_add_u32 m0, s80, 73728
    s_nop 0
    buffer_load_dwordx4 v4, s[44:47], s78 offen offset:0 lds
    buffer_load_dwordx4 v5, s[44:47], s78 offen offset:1024 lds
    buffer_load_dwordx4 v6, s[44:47], s78 offen offset:2048 lds
    buffer_load_dwordx4 v7, s[44:47], s78 offen offset:3072 lds
    s_add_u32 m0, s42, 73728
    s_nop 0
    buffer_load_dwordx4 v8, s[48:51], s79 offen offset:0 lds
    buffer_load_dwordx4 v9, s[48:51], s79 offen offset:1024 lds
    s_waitcnt vmcnt(6)
    s_barrier
    buffer_load_dwordx4 v10, s[48:51], s79 offen offset:2048 lds
    buffer_load_dwordx4 v11, s[48:51], s79 offen offset:3072 lds
    s_add_u32 m0, s42, 77824
    s_nop 0
    buffer_load_dwordx4 v12, s[48:51], s79 offen offset:0 lds
    s_and_b32 s78, s76, 15
    s_lshr_b64 s[76:77], s[76:77], 4
    s_mul_i32 s79, s78, 245760
    s_lshl_b32 s78, s78, 7
    s_add_u32 m0, s80, 0
    s_nop 0
    buffer_load_dwordx4 v4, s[44:47], s78 offen offset:0 lds
    buffer_load_dwordx4 v5, s[44:47], s78 offen offset:1024 lds
    buffer_load_dwordx4 v6, s[44:47], s78 offen offset:2048 lds
    buffer_load_dwordx4 v7, s[44:47], s78 offen offset:3072 lds
    s_add_u32 m0, s42, 0
    s_nop 0
    buffer_load_dwordx4 v8, s[48:51], s79 offen offset:0 lds
    buffer_load_dwordx4 v9, s[48:51], s79 offen offset:1024 lds
    s_waitcnt vmcnt(6)
    s_barrier
    buffer_load_dwordx4 v10, s[48:51], s79 offen offset:2048 lds
    buffer_load_dwordx4 v11, s[48:51], s79 offen offset:3072 lds
    s_add_u32 m0, s42, 4096
    s_nop 0
    buffer_load_dwordx4 v12, s[48:51], s79 offen offset:0 lds
    s_and_b32 s78, s76, 15
    s_lshr_b64 s[76:77], s[76:77], 4
    s_mul_i32 s79, s78, 245760
    s_lshl_b32 s78, s78, 7
    s_lshl_b32 s72, s4, 7
    s_add_u32 s72, s72, 3956736
    buffer_load_dword v40, off, s[56:59], 0 sc1
    buffer_load_dword v41, off, s[60:63], s72 sc1
    s_waitcnt vmcnt(2)
    s_barrier
    s_add_u32 m0, s22, 40960
    s_nop 0
    buffer_load_dwordx4 v44, s[64:67], s24 offen lds
    s_add_u32 m0, s22, 41984
    s_nop 0
    buffer_load_dwordx4 v45, s[64:67], s24 offen lds
    s_add_u32 m0, s22, 43008
    s_nop 0
    buffer_load_dwordx4 v46, s[64:67], s24 offen lds
    s_add_u32 m0, s22, 44032
    s_nop 0
    buffer_load_dwordx4 v47, s[64:67], s24 offen lds
    s_add_u32 m0, s22, 45056
    s_nop 0
    buffer_load_dwordx4 v48, s[64:67], s24 offen lds
    s_add_u32 s24, s24, 40960
    s_cmp_eq_u32 s24, s26
    s_cselect_b32 s24, s25, s24
    s_branch L_ld2
L_ldq:
    s_lshl_b32 s72, s9, 1
    s_lshr_b32 s73, s15, 1
    s_add_u32 s72, s72, s73
    s_lshl_b32 s72, s72, 4
    s_lshl_b32 s73, s13, 1
    s_add_u32 s72, s72, s73
    s_add_u32 s72, s72, s28
    s_lshl_b32 s72, s72, 7
    s_add_u32 s29, s72, 3998720
    buffer_load_dwordx4 v[24:27], v20, s[52:55], s81 offen
    buffer_load_dwordx4 v[28:31], v20, s[52:55], s78 offen
    s_add_u32 m0, s80, 36864
    s_nop 0
    buffer_load_dwordx4 v4, s[44:47], s78 offen offset:0 lds
    buffer_load_dwordx4 v5, s[44:47], s78 offen offset:1024 lds
    buffer_load_dwordx4 v6, s[44:47], s78 offen offset:2048 lds
    buffer_load_dwordx4 v7, s[44:47], s78 offen offset:3072 lds
    s_add_u32 m0, s42, 36864
    s_nop 0
    buffer_load_dwordx4 v8, s[48:51], s79 offen offset:0 lds
    buffer_load_dwordx4 v9, s[48:51], s79 offen offset:1024 lds
    s_waitcnt vmcnt(7)
    s_barrier
    buffer_load_dwordx4 v10, s[48:51], s79 offen offset:2048 lds
    buffer_load_dwordx4 v11, s[48:51], s79 offen offset:3072 lds
    s_add_u32 m0, s42, 40960
    s_nop 0
    buffer_load_dwordx4 v12, s[48:51], s79 offen offset:0 lds
    s_and_b32 s78, s76, 15
    s_lshr_b64 s[76:77], s[76:77], 4
    s_mul_i32 s79, s78, 245760
    s_lshl_b32 s78, s78, 7
    ds_read_b128 v[36:39], v21 offset:0
    buffer_load_dwordx4 v[32:35], v20, s[52:55], s78 offen
    s_add_u32 m0, s80, 73728
    s_nop 0
    buffer_load_dwordx4 v4, s[44:47], s78 offen offset:0 lds
    buffer_load_dwordx4 v5, s[44:47], s78 offen offset:1024 lds
    buffer_load_dwordx4 v6, s[44:47], s78 offen offset:2048 lds
    buffer_load_dwordx4 v7, s[44:47], s78 offen offset:3072 lds
    s_add_u32 m0, s42, 73728
    s_nop 0
    buffer_load_dwordx4 v8, s[48:51], s79 offen offset:0 lds
    buffer_load_dwordx4 v9, s[48:51], s79 offen offset:1024 lds
    s_waitcnt lgkmcnt(0)
    v_dot2c_f32_bf16 v22, v36, v24
    v_dot2c_f32_bf16 v22, v37, v25
    v_dot2c_f32_bf16 v22, v38, v26
    v_dot2c_f32_bf16 v22, v39, v27
    s_waitcnt vmcnt(7)
    s_barrier
    buffer_load_dwordx4 v10, s[48:51], s79 offen offset:2048 lds
    buffer_load_dwordx4 v11, s[48:51], s79 offen offset:3072 lds
    s_add_u32 m0, s42, 77824
    s_nop 0
    buffer_load_dwordx4 v12, s[48:51], s79 offen offset:0 lds
    s_and_b32 s78, s76, 15
    s_lshr_b64 s[76:77], s[76:77], 4
    s_mul_i32 s79, s78, 245760
    s_lshl_b32 s78, s78, 7
    ds_read_b128 v[36:39], v21 offset:36864
    buffer_load_dwordx4 v[24:27], v20, s[52:55], s78 offen
    s_add_u32 m0, s80, 0
    s_nop 0
    buffer_load_dwordx4 v4, s[44:47], s78 offen offset:0 lds
    buffer_load_dwordx4 v5, s[44:47], s78 offen offset:1024 lds
    buffer_load_dwordx4 v6, s[44:47], s78 offen offset:2048 lds
    buffer_load_dwordx4 v7, s[44:47], s78 offen offset:3072 lds
    s_add_u32 m0, s42, 0
    s_nop 0
    buffer_load_dwordx4 v8, s[48:51], s79 offen offset:0 lds
    buffer_load_dwordx4 v9, s[48:51], s79 offen offset:1024 lds
    s_waitcnt lgkmcnt(0)
    v_dot2c_f32_bf16 v22, v36, v28
    v_dot2c_f32_bf16 v22, v37, v29
    v_dot2c_f32_bf16 v22, v38, v30
    v_dot2c_f32_bf16 v22, v39, v31
    s_waitcnt vmcnt(7)
    s_barrier
    buffer_load_dwordx4 v10, s[48:51], s79 offen offset:2048 lds
    buffer_load_dwordx4 v11, s[48:51], s79 offen offset:3072 lds
    s_add_u32 m0, s42, 4096
    s_nop 0
    buffer_load_dwordx4 v12, s[48:51], s79 offen offset:0 lds
    s_and_b32 s78, s76, 15
    s_lshr_b64 s[76:77], s[76:77], 4
    s_mul_i32 s79, s78, 245760
    s_lshl_b32 s78, s78, 7
    ds_read_b128 v[36:39], v23 offset:0
    buffer_load_dwordx4 v[28:31], v20, s[52:55], s78 offen
    s_add_u32 m0, s80, 36864
    s_nop 0
    buffer_load_dwordx4 v4, s[44:47], s78 offen offset:0 lds
    buffer_load_dwordx4 v5, s[44:47], s78 offen offset:1024 lds
    buffer_load_dwordx4 v6, s[44:47], s78 offen offset:2048 lds
    buffer_load_dwordx4 v7, s[44:47], s78 offen offset:3072 lds
    s_add_u32 m0, s42, 36864
    s_nop 0
    buffer_load_dwordx4 v8, s[48:51], s79 offen offset:0 lds
    buffer_load_dwordx4 v9, s[48:51], s79 offen offset:1024 lds
    s_waitcnt lgkmcnt(0)
    v_dot2c_f32_bf16 v22, v36, v32
    v_dot2c_f32_bf16 v22, v37, v33
    v_dot2c_f32_bf16 v22, v38, v34
    v_dot2c_f32_bf16 v22, v39, v35
    s_waitcnt vmcnt(7)
    s_barrier
    buffer_load_dwordx4 v10, s[48:51], s79 offen offset:2048 lds
    buffer_load_dwordx4 v11, s[48:51], s79 offen offset:3072 lds
    s_add_u32 m0, s42, 40960
    s_nop 0
    buffer_load_dwordx4 v12, s[48:51], s79 offen offset:0 lds
    s_and_b32 s78, s76, 15
    s_lshr_b64 s[76:77], s[76:77], 4
    s_mul_i32 s79, s78, 245760
    s_lshl_b32 s78, s78, 7
    v_lshlrev_b32 v16, 4, v1
    s_lshl_b32 s72, s43, 12
    s_lshl_b32 s73, s28, 11
    s_add_u32 s72, s72, s73
    s_add_u32 s73, s73, s27
    s_add_u32 m0, s73, 32
    s_nop 0
    buffer_load_dwordx4 v16, s[68:71], s72 offen offset:0 nt lds
    buffer_load_dwordx4 v16, s[68:71], s72 offen offset:1024 nt lds
    v_mov_b32 v18, 0
    v_mov_b32 v19, 0
    v_bfe_u32 v16, v1, 4, 1
    v_mul_u32_u24 v16, 1152, v16
    v_and_b32 v17, 15, v1
    v_lshl_add_u32 v16, v17, 3, v16
    s_mul_i32 s72, s28, 2304
    s_add_u32 s72, s72, s27
    v_add_u32 v16, s72, v16
    ds_write_b64 v16, v[18:19] offset:5152
    v_and_b32 v16, 3, v1
    v_lshlrev_b32 v16, 3, v16
    v_add_u32 v16, s27, v16
    ds_write_b64 v16, v[18:19]
    v_and_b32 v16, 1, v1
    v_lshlrev_b32 v16, 3, v16
    v_add_u32 v16, s27, v16
    ds_write_b64 v16, v[18:19] offset:8736
    s_mov_b32 s68, s32
    s_and_b32 s69, s33, 0xffff
    s_mov_b32 s70, 1280
    s_mov_b32 s71, 0x00020000
    s_lshl_b32 s72, s43, 1
    v_mov_b32 v254, 0
    buffer_load_short_d16_hi v254, off, s[68:71], s72
    ds_read_b128 v[36:39], v21 offset:0
    buffer_load_dwordx4 v[32:35], v20, s[52:55], s78 offen
    s_add_u32 m0, s80, 73728
    s_nop 0
    buffer_load_dwordx4 v4, s[44:47], s78 offen offset:0 lds
    buffer_load_dwordx4 v5, s[44:47], s78 offen offset:1024 lds
    buffer_load_dwordx4 v6, s[44:47], s78 offen offset:2048 lds
    buffer_load_dwordx4 v7, s[44:47], s78 offen offset:3072 lds
    s_add_u32 m0, s42, 73728
    s_nop 0
    buffer_load_dwordx4 v8, s[48:51], s79 offen offset:0 lds
    buffer_load_dwordx4 v9, s[48:51], s79 offen offset:1024 lds
    s_waitcnt lgkmcnt(0)
    v_dot2c_f32_bf16 v22, v36, v24
    v_dot2c_f32_bf16 v22, v37, v25
    v_dot2c_f32_bf16 v22, v38, v26
    v_dot2c_f32_bf16 v22, v39, v27
    s_waitcnt vmcnt(7)
    s_barrier
    buffer_load_dwordx4 v10, s[48:51], s79 offen offset:2048 lds
    buffer_load_dwordx4 v11, s[48:51], s79 offen offset:3072 lds
    s_add_u32 m0, s42, 77824
    s_nop 0
    buffer_load_dwordx4 v12, s[48:51], s79 offen offset:0 lds
    s_and_b32 s78, s76, 15
    s_lshr_b64 s[76:77], s[76:77], 4
    s_mul_i32 s79, s78, 245760
    s_lshl_b32 s78, s78, 7
    ds_read_b128 v[36:39], v21 offset:36864
    buffer_load_dwordx4 v[24:27], v20, s[52:55], s78 offen
    s_add_u32 m0, s80, 0
    s_nop 0
    buffer_load_dwordx4 v4, s[44:47], s78 offen offset:0 lds
    buffer_load_dwordx4 v5, s[44:47], s78 offen offset:1024 lds
    buffer_load_dwordx4 v6, s[44:47], s78 offen offset:2048 lds
    buffer_load_dwordx4 v7, s[44:47], s78 offen offset:3072 lds
    s_add_u32 m0, s42, 0
    s_nop 0
    buffer_load_dwordx4 v8, s[48:51], s79 offen offset:0 lds
    buffer_load_dwordx4 v9, s[48:51], s79 offen offset:1024 lds
    s_waitcnt lgkmcnt(0)
    v_dot2c_f32_bf16 v22, v36, v28
    v_dot2c_f32_bf16 v22, v37, v29
    v_dot2c_f32_bf16 v22, v38, v30
    v_dot2c_f32_bf16 v22, v39, v31
    s_waitcnt vmcnt(7)
    s_barrier
    buffer_load_dwordx4 v10, s[48:51], s79 offen offset:2048 lds
    buffer_load_dwordx4 v11, s[48:51], s79 offen offset:3072 lds
    s_add_u32 m0, s42, 4096
    s_nop 0
    buffer_load_dwordx4 v12, s[48:51], s79 offen offset:0 lds
    s_and_b32 s78, s76, 15
    s_lshr_b64 s[76:77], s[76:77], 4
    s_mul_i32 s79, s78, 245760
    s_lshl_b32 s78, s78, 7
    ds_read_b128 v[36:39], v23 offset:0
    buffer_load_dwordx4 v[28:31], v20, s[52:55], s78 offen
    s_add_u32 m0, s80, 36864
    s_nop 0
    buffer_load_dwordx4 v4, s[44:47], s78 offen offset:0 lds
    buffer_load_dwordx4 v5, s[44:47], s78 offen offset:1024 lds
    buffer_load_dwordx4 v6, s[44:47], s78 offen offset:2048 lds
    buffer_load_dwordx4 v7, s[44:47], s78 offen offset:3072 lds
    s_add_u32 m0, s42, 36864
    s_nop 0
    buffer_load_dwordx4 v8, s[48:51], s79 offen offset:0 lds
    buffer_load_dwordx4 v9, s[48:51], s79 offen offset:1024 lds
    s_waitcnt lgkmcnt(0)
    v_dot2c_f32_bf16 v22, v36, v32
    v_dot2c_f32_bf16 v22, v37, v33
    v_dot2c_f32_bf16 v22, v38, v34
    v_dot2c_f32_bf16 v22, v39, v35
    s_waitcnt vmcnt(7)
    s_barrier
    buffer_load_dwordx4 v10, s[48:51], s79 offen offset:2048 lds
    buffer_load_dwordx4 v11, s[48:51], s79 offen offset:3072 lds
    s_add_u32 m0, s42, 40960
    s_nop 0
    buffer_load_dwordx4 v12, s[48:51], s79 offen offset:0 lds
    s_and_b32 s78, s76, 15
    s_lshr_b64 s[76:77], s[76:77], 4
    s_mul_i32 s79, s78, 245760
    s_lshl_b32 s78, s78, 7
    ds_read_b128 v[36:39], v21 offset:0
    buffer_load_dwordx4 v[32:35], v20, s[52:55], s78 offen
    s_add_u32 m0, s80, 73728
    s_nop 0
    buffer_load_dwordx4 v4, s[44:47], s78 offen offset:0 lds
    buffer_load_dwordx4 v5, s[44:47], s78 offen offset:1024 lds
    buffer_load_dwordx4 v6, s[44:47], s78 offen offset:2048 lds
    buffer_load_dwordx4 v7, s[44:47], s78 offen offset:3072 lds
    s_add_u32 m0, s42, 73728
    s_nop 0
    buffer_load_dwordx4 v8, s[48:51], s79 offen offset:0 lds
    buffer_load_dwordx4 v9, s[48:51], s79 offen offset:1024 lds
    s_waitcnt lgkmcnt(0)
    v_dot2c_f32_bf16 v22, v36, v24
    v_dot2c_f32_bf16 v22, v37, v25
    v_dot2c_f32_bf16 v22, v38, v26
    v_dot2c_f32_bf16 v22, v39, v27
    s_waitcnt vmcnt(7)
    s_barrier
    buffer_load_dwordx4 v10, s[48:51], s79 offen offset:2048 lds
    buffer_load_dwordx4 v11, s[48:51], s79 offen offset:3072 lds
    s_add_u32 m0, s42, 77824
    s_nop 0
    buffer_load_dwordx4 v12, s[48:51], s79 offen offset:0 lds
    s_and_b32 s78, s76, 15
    s_lshr_b64 s[76:77], s[76:77], 4
    s_mul_i32 s79, s78, 245760
    s_lshl_b32 s78, s78, 7
    ds_read_b128 v[36:39], v21 offset:36864
    buffer_load_dwordx4 v[24:27], v20, s[52:55], s78 offen
    s_add_u32 m0, s80, 0
    s_nop 0
    buffer_load_dwordx4 v4, s[44:47], s78 offen offset:0 lds
    buffer_load_dwordx4 v5, s[44:47], s78 offen offset:1024 lds
    buffer_load_dwordx4 v6, s[44:47], s78 offen offset:2048 lds
    buffer_load_dwordx4 v7, s[44:47], s78 offen offset:3072 lds
    s_add_u32 m0, s42, 0
    s_nop 0
    buffer_load_dwordx4 v8, s[48:51], s79 offen offset:0 lds
    buffer_load_dwordx4 v9, s[48:51], s79 offen offset:1024 lds
    s_waitcnt lgkmcnt(0)
    v_dot2c_f32_bf16 v22, v36, v28
    v_dot2c_f32_bf16 v22, v37, v29
    v_dot2c_f32_bf16 v22, v38, v30
    v_dot2c_f32_bf16 v22, v39, v31
    s_waitcnt vmcnt(7)
    s_barrier
    buffer_load_dwordx4 v10, s[48:51], s79 offen offset:2048 lds
    buffer_load_dwordx4 v11, s[48:51], s79 offen offset:3072 lds
    s_add_u32 m0, s42, 4096
    s_nop 0
    buffer_load_dwordx4 v12, s[48:51], s79 offen offset:0 lds
    s_and_b32 s78, s76, 15
    s_lshr_b64 s[76:77], s[76:77], 4
    s_mul_i32 s79, s78, 245760
    s_lshl_b32 s78, s78, 7
    ds_read_b128 v[36:39], v23 offset:0
    s_lshl_b32 s72, s4, 7
    s_add_u32 s72, s72, 3956736
    buffer_load_dword v40, off, s[56:59], 0 sc1
    buffer_load_dword v41, off, s[60:63], s72 sc1
    s_waitcnt lgkmcnt(0)
    v_dot2c_f32_bf16 v22, v36, v32
    v_dot2c_f32_bf16 v22, v37, v33
    v_dot2c_f32_bf16 v22, v38, v34
    v_dot2c_f32_bf16 v22, v39, v35
    s_waitcnt vmcnt(2)
    s_barrier
    s_add_u32 m0, s22, 40960
    s_nop 0
    buffer_load_dwordx4 v44, s[64:67], s24 offen lds
    s_add_u32 m0, s22, 41984
    s_nop 0
    buffer_load_dwordx4 v45, s[64:67], s24 offen lds
    s_add_u32 m0, s22, 43008
    s_nop 0
    buffer_load_dwordx4 v46, s[64:67], s24 offen lds
    s_add_u32 m0, s22, 44032
    s_nop 0
    buffer_load_dwordx4 v47, s[64:67], s24 offen lds
    s_add_u32 m0, s22, 45056
    s_nop 0
    buffer_load_dwordx4 v48, s[64:67], s24 offen lds
    s_add_u32 s24, s24, 40960
    s_cmp_eq_u32 s24, s26
    s_cselect_b32 s24, s25, s24
    ds_read_b128 v[36:39], v21 offset:0
    s_waitcnt lgkmcnt(0)
    v_dot2c_f32_bf16 v22, v36, v24
    v_dot2c_f32_bf16 v22, v37, v25
    v_dot2c_f32_bf16 v22, v38, v26
    v_dot2c_f32_bf16 v22, v39, v27
    s_nop 2
    v_add_f32_dpp v22, v22, v22 quad_perm:[1,0,3,2] row_mask:0xf bank_mask:0xf
    s_nop 1
    v_add_f32_dpp v22, v22, v22 quad_perm:[2,3,0,1] row_mask:0xf bank_mask:0xf
    s_nop 1
    v_add_f32_dpp v22, v22, v22 row_half_mirror row_mask:0xf bank_mask:0xf
    v_cvt_pk_bf16_f32 v22, v22, v22
    v_lshlrev_b32 v22, 16, v22
    v_mul_f32 v22, 3216550459, v22
    v_exp_f32 v22, v22
    s_nop 0
    v_add_f32 v22, 1.0, v22
    v_rcp_f32 v22, v22
    s_nop 0
    v_cvt_pk_bf16_f32 v22, v22, v22
    v_lshlrev_b32 v22, 16, v22
    v_lshrrev_b32 v21, 3, v1
    v_lshlrev_b32 v21, 2, v21
    s_lshl_b32 s72, s9, 7
    s_lshl_b32 s73, s15, 5
    s_add_u32 s72, s72, s73
    s_lshl_b32 s73, s13, 3
    s_add_u32 s72, s72, s73
    s_lshl_b32 s72, s72, 2
    s_add_u32 s72, s72, 3948544
    s_mov_b32 exec_lo, 0x01010101
    s_mov_b32 exec_hi, 0x01010101
    buffer_store_dword v22, v21, s[60:63], s72 offen sc1
    s_mov_b64 exec, -1
L_ld2:
    v_mov_b32 v52, 0
    v_mov_b32 v53, 0
    v_mov_b32 v54, 0
    v_mov_b32 v55, 0
    s_and_b32 s1, s3, 3
    s_mul_i32 s1, s1, 1344
    s_add_u32 s1, s1, 102400
    v_add_u32 v50, s1, v251
    ds_write_b128 v50, v[52:55] offset:0
    ds_write_b128 v50, v[52:55] offset:5376
    s_mov_b64 exec, 0xfffff
    ds_write_b128 v50, v[52:55] offset:1024
    ds_write_b128 v50, v[52:55] offset:6400
    s_mov_b64 exec, -1
    s_waitcnt vmcnt(5)
    v_cmp_ne_u32 vcc, v40, v41
    v_cmp_eq_u32 s[72:73], 0, v40
    s_nop 0
    s_or_b64 vcc, vcc, s[72:73]
    s_cbranch_vccz L_uok
    s_add_u32 m0, s22, 46080
    s_nop 0
    buffer_load_dwordx4 v44, s[64:67], s24 offen lds
    s_add_u32 m0, s22, 47104
    s_nop 0
    buffer_load_dwordx4 v45, s[64:67], s24 offen lds
    s_add_u32 m0, s22, 48128
    s_nop 0
    buffer_load_dwordx4 v46, s[64:67], s24 offen lds
    s_add_u32 m0, s22, 49152
    s_nop 0
    buffer_load_dwordx4 v47, s[64:67], s24 offen lds
    s_add_u32 m0, s22, 50176
    s_nop 0
    buffer_load_dwordx4 v48, s[64:67], s24 offen lds
    s_add_u32 s24, s24, 40960
    s_cmp_eq_u32 s24, s26
    s_cselect_b32 s24, s25, s24
    s_lshl_b32 s72, s4, 7
    s_add_u32 s72, s72, 3956736
    buffer_load_dword v40, off, s[56:59], 0 sc1
    buffer_load_dword v41, off, s[60:63], s72 sc1
    s_waitcnt vmcnt(0)
    v_cmp_ne_u32 vcc, v40, v41
    v_cmp_eq_u32 s[72:73], 0, v40
    s_nop 0
    s_or_b64 vcc, vcc, s[72:73]
    s_cbranch_vccz L_uok2
    s_add_u32 s73, s22, 51200
    v_add_u32 v2, s73, v251
    s_waitcnt lgkmcnt(0)
    s_barrier
    s_cmp_ge_u32 s10, 4
    s_cbranch_scc1 Lnokv_1
    s_mov_b32 exec_hi, 0xffffff
    ds_read_b128 v[64:67], v2 offset:0
    ds_read_b128 v[72:75], v2 offset:1792
    ds_read_b128 v[68:71], v2 offset:896
    ds_read_b128 v[76:79], v2 offset:2688
    s_waitcnt lgkmcnt(2)
    v_add_f32 v64, v64, v72
    v_add_f32 v65, v65, v73
    v_add_f32 v66, v66, v74
    v_add_f32 v67, v67, v75
    buffer_store_dwordx4 v[64:67], v251, s[60:63], s11 offen offset:0 sc1
    s_waitcnt lgkmcnt(0)
    v_add_f32 v68, v68, v76
    v_add_f32 v69, v69, v77
    v_add_f32 v70, v70, v78
    v_add_f32 v71, v71, v79
    buffer_store_dwordx4 v[68:71], v251, s[60:63], s11 offen offset:896 sc1
    s_mov_b32 exec_hi, -1
Lnokv_1:
    s_mov_b32 s81, 100000
Lspin_2:
    s_lshl_b32 s72, s4, 7
    s_add_u32 s72, s72, 3956736
    buffer_load_dword v40, off, s[56:59], 0 sc1
    buffer_load_dword v41, off, s[60:63], s72 sc1
    s_waitcnt vmcnt(0)
    v_cmp_ne_u32 vcc, v40, v41
    v_cmp_eq_u32 s[72:73], 0, v40
    s_nop 0
    s_or_b64 vcc, vcc, s[72:73]
    s_cbranch_vccz Lspun_3
    s_sleep 4
    s_sub_u32 s81, s81, 1
    s_cbranch_scc0 Lspin_2
Lspun_3:
    v_readfirstlane_b32 s0, v40
    v_lshlrev_b32 v24, 4, v1
    s_lshr_b32 s72, s43, 1
    s_mul_i32 s72, s72, 8320
    s_and_b32 s73, s43, 1
    s_lshl_b32 s73, s73, 1
    s_add_u32 s73, s73, s28
    s_lshl_b32 s73, s73, 11
    s_add_u32 s72, s72, s73
    buffer_load_dwordx4 v[26:29], v24, s[60:63], s72 offen offset:0 sc1
    buffer_load_dwordx4 v[30:33], v24, s[60:63], s72 offen offset:1024 sc1
    s_and_b32 s73, s43, 1
    s_mul_i32 s72, s73, 9264
    s_sub_u32 s72, s27, s72
    s_lshl_b32 s73, s28, 8
    s_sub_u32 s72, s72, s73
    s_add_u32 s72, s72, 5008
    v_and_b32 v25, 3, v1
    v_mul_u32_u24 v25, 1152, v25
    v_bfe_u32 v24, v1, 2, 1
    v_mul_u32_u24 v24, 8752, v24
    v_add_u32 v25, v25, v24
    v_and_b32 v24, 56, v1
    v_lshlrev_b32 v24, 1, v24
    v_sub_u32 v25, v25, v24
    v_add_u32 v25, s72, v25
    s_cmp_eq_u32 s28, 0
    s_cselect_b32 s72, 32, 0
    s_add_u32 s72, s72, s27
    v_mov_b32 v24, s72
    v_mov_b32 v34, 0
    s_waitcnt vmcnt(0)
    ds_read_u16_d16_hi v34, v24
    ds_write_b128 v25, v[26:29] offset:128
    ds_write_b128 v25, v[30:33] offset:0
    s_waitcnt lgkmcnt(2)
    v_add_f32 v34, v34, v254
    v_cvt_pk_bf16_f32 v34, v34, v34
    ds_write_b16 v24, v34
    v_mov_b32 v24, 162912
    v_mov_b32 v25, 1
    s_mov_b64 exec, 1
    ds_add_u32 v24, v25
    s_mov_b64 exec, -1
    s_branch L_ud
L_uok2:
    v_readfirstlane_b32 s0, v40
    v_lshlrev_b32 v24, 4, v1
    s_lshr_b32 s72, s43, 1
    s_mul_i32 s72, s72, 8320
    s_and_b32 s73, s43, 1
    s_lshl_b32 s73, s73, 1
    s_add_u32 s73, s73, s28
    s_lshl_b32 s73, s73, 11
    s_add_u32 s72, s72, s73
    buffer_load_dwordx4 v[26:29], v24, s[60:63], s72 offen offset:0 sc1
    buffer_load_dwordx4 v[30:33], v24, s[60:63], s72 offen offset:1024 sc1
    s_add_u32 s73, s22, 51200
    v_add_u32 v2, s73, v251
    s_waitcnt lgkmcnt(0)
    s_barrier
    s_cmp_ge_u32 s10, 4
    s_cbranch_scc1 Lnokv_4
    s_mov_b32 exec_hi, 0xffffff
    ds_read_b128 v[64:67], v2 offset:0
    ds_read_b128 v[72:75], v2 offset:1792
    ds_read_b128 v[68:71], v2 offset:896
    ds_read_b128 v[76:79], v2 offset:2688
    s_waitcnt lgkmcnt(2)
    v_add_f32 v64, v64, v72
    v_add_f32 v65, v65, v73
    v_add_f32 v66, v66, v74
    v_add_f32 v67, v67, v75
    buffer_store_dwordx4 v[64:67], v251, s[60:63], s11 offen offset:0 sc1
    s_waitcnt lgkmcnt(0)
    v_add_f32 v68, v68, v76
    v_add_f32 v69, v69, v77
    v_add_f32 v70, v70, v78
    v_add_f32 v71, v71, v79
    buffer_store_dwordx4 v[68:71], v251, s[60:63], s11 offen offset:896 sc1
    s_mov_b32 exec_hi, -1
Lnokv_4:
    s_and_b32 s73, s43, 1
    s_mul_i32 s72, s73, 9264
    s_sub_u32 s72, s27, s72
    s_lshl_b32 s73, s28, 8
    s_sub_u32 s72, s72, s73
    s_add_u32 s72, s72, 5008
    v_and_b32 v25, 3, v1
    v_mul_u32_u24 v25, 1152, v25
    v_bfe_u32 v24, v1, 2, 1
    v_mul_u32_u24 v24, 8752, v24
    v_add_u32 v25, v25, v24
    v_and_b32 v24, 56, v1
    v_lshlrev_b32 v24, 1, v24
    v_sub_u32 v25, v25, v24
    v_add_u32 v25, s72, v25
    s_cmp_eq_u32 s28, 0
    s_cselect_b32 s72, 32, 0
    s_add_u32 s72, s72, s27
    v_mov_b32 v24, s72
    v_mov_b32 v34, 0
    s_waitcnt vmcnt(0)
    ds_read_u16_d16_hi v34, v24
    ds_write_b128 v25, v[26:29] offset:128
    ds_write_b128 v25, v[30:33] offset:0
    s_waitcnt lgkmcnt(2)
    v_add_f32 v34, v34, v254
    v_cvt_pk_bf16_f32 v34, v34, v34
    ds_write_b16 v24, v34
    v_mov_b32 v24, 162912
    v_mov_b32 v25, 1
    s_mov_b64 exec, 1
    ds_add_u32 v24, v25
    s_mov_b64 exec, -1
    s_branch L_ud
L_uok:
    v_readfirstlane_b32 s0, v40
    v_lshlrev_b32 v24, 4, v1
    s_lshr_b32 s72, s43, 1
    s_mul_i32 s72, s72, 8320
    s_and_b32 s73, s43, 1
    s_lshl_b32 s73, s73, 1
    s_add_u32 s73, s73, s28
    s_lshl_b32 s73, s73, 11
    s_add_u32 s72, s72, s73
    buffer_load_dwordx4 v[26:29], v24, s[60:63], s72 offen offset:0 sc1
    buffer_load_dwordx4 v[30:33], v24, s[60:63], s72 offen offset:1024 sc1
    s_add_u32 m0, s22, 46080
    s_nop 0
    buffer_load_dwordx4 v44, s[64:67], s24 offen lds
    s_add_u32 m0, s22, 47104
    s_nop 0
    buffer_load_dwordx4 v45, s[64:67], s24 offen lds
    s_add_u32 m0, s22, 48128
    s_nop 0
    buffer_load_dwordx4 v46, s[64:67], s24 offen lds
    s_add_u32 m0, s22, 49152
    s_nop 0
    buffer_load_dwordx4 v47, s[64:67], s24 offen lds
    s_add_u32 m0, s22, 50176
    s_nop 0
    buffer_load_dwordx4 v48, s[64:67], s24 offen lds
    s_add_u32 s24, s24, 40960
    s_cmp_eq_u32 s24, s26
    s_cselect_b32 s24, s25, s24
    s_and_b32 s73, s43, 1
    s_mul_i32 s72, s73, 9264
    s_sub_u32 s72, s27, s72
    s_lshl_b32 s73, s28, 8
    s_sub_u32 s72, s72, s73
    s_add_u32 s72, s72, 5008
    v_and_b32 v25, 3, v1
    v_mul_u32_u24 v25, 1152, v25
    v_bfe_u32 v24, v1, 2, 1
    v_mul_u32_u24 v24, 8752, v24
    v_add_u32 v25, v25, v24
    v_and_b32 v24, 56, v1
    v_lshlrev_b32 v24, 1, v24
    v_sub_u32 v25, v25, v24
    v_add_u32 v25, s72, v25
    s_cmp_eq_u32 s28, 0
    s_cselect_b32 s72, 32, 0
    s_add_u32 s72, s72, s27
    v_mov_b32 v24, s72
    v_mov_b32 v34, 0
    s_waitcnt vmcnt(5)
    ds_read_u16_d16_hi v34, v24
    ds_write_b128 v25, v[26:29] offset:128
    ds_write_b128 v25, v[30:33] offset:0
    s_waitcnt lgkmcnt(2)
    v_add_f32 v34, v34, v254
    v_cvt_pk_bf16_f32 v34, v34, v34
    ds_write_b16 v24, v34
    v_mov_b32 v24, 162912
    v_mov_b32 v25, 1
    s_mov_b64 exec, 1
    ds_add_u32 v24, v25
    s_mov_b64 exec, -1
    s_add_u32 s73, s22, 51200
    v_add_u32 v2, s73, v251
    s_waitcnt lgkmcnt(0)
    s_barrier
    s_cmp_ge_u32 s10, 4
    s_cbranch_scc1 Lnokv_5
    s_mov_b32 exec_hi, 0xffffff
    ds_read_b128 v[64:67], v2 offset:0
    ds_read_b128 v[72:75], v2 offset:1792
    ds_read_b128 v[68:71], v2 offset:896
    ds_read_b128 v[76:79], v2 offset:2688
    s_waitcnt lgkmcnt(2)
    v_add_f32 v64, v64, v72
    v_add_f32 v65, v65, v73
    v_add_f32 v66, v66, v74
    v_add_f32 v67, v67, v75
    buffer_store_dwordx4 v[64:67], v251, s[60:63], s11 offen offset:0 sc1
    s_waitcnt lgkmcnt(0)
    v_add_f32 v68, v68, v76
    v_add_f32 v69, v69, v77
    v_add_f32 v70, v70, v78
    v_add_f32 v71, v71, v79
    buffer_store_dwordx4 v[68:71], v251, s[60:63], s11 offen offset:896 sc1
    s_mov_b32 exec_hi, -1
Lnokv_5:
L_ud:
    s_add_u32 m0, s22, 51200
    s_nop 0
    buffer_load_dwordx4 v44, s[64:67], s24 offen lds
    s_add_u32 m0, s22, 52224
    s_nop 0
    buffer_load_dwordx4 v45, s[64:67], s24 offen lds
    s_add_u32 m0, s22, 53248
    s_nop 0
    buffer_load_dwordx4 v46, s[64:67], s24 offen lds
    s_add_u32 m0, s22, 54272
    s_nop 0
    buffer_load_dwordx4 v47, s[64:67], s24 offen lds
    s_add_u32 m0, s22, 55296
    s_nop 0
    buffer_load_dwordx4 v48, s[64:67], s24 offen lds
    s_add_u32 s24, s24, 40960
    s_cmp_eq_u32 s24, s26
    s_cselect_b32 s24, s25, s24
    s_add_u32 m0, s23, 0
    s_nop 0
    buffer_load_dwordx4 v44, s[64:67], s24 offen lds
    s_add_u32 m0, s23, 1024
    s_nop 0
    buffer_load_dwordx4 v45, s[64:67], s24 offen lds
    s_add_u32 m0, s23, 2048
    s_nop 0
    buffer_load_dwordx4 v46, s[64:67], s24 offen lds
    s_add_u32 m0, s23, 3072
    s_nop 0
    buffer_load_dwordx4 v47, s[64:67], s24 offen lds
    s_add_u32 m0, s23, 4096
    s_nop 0
    buffer_load_dwordx4 v48, s[64:67], s24 offen lds
    s_add_u32 s24, s24, 40960
    s_cmp_eq_u32 s24, s26
    s_cselect_b32 s24, s25, s24
    s_add_u32 m0, s23, 5120
    s_nop 0
    buffer_load_dwordx4 v44, s[64:67], s24 offen lds
    s_add_u32 m0, s23, 6144
    s_nop 0
    buffer_load_dwordx4 v45, s[64:67], s24 offen lds
    s_add_u32 m0, s23, 7168
    s_nop 0
    buffer_load_dwordx4 v46, s[64:67], s24 offen lds
    s_add_u32 m0, s23, 8192
    s_nop 0
    buffer_load_dwordx4 v47, s[64:67], s24 offen lds
    s_add_u32 m0, s23, 9216
    s_nop 0
    buffer_load_dwordx4 v48, s[64:67], s24 offen lds
    s_lshl_b32 s72, s6, 11
    s_add_u32 s72, s72, 3997696
    v_and_b32 v2, 7, v1
    v_lshlrev_b32 v2, 7, v2
    s_mov_b32 s81, 100000
Lspin_6:
    buffer_load_dword v3, v2, s[60:63], s72 offen sc1
    s_waitcnt vmcnt(0)
    v_cmp_ne_u32 vcc, s0, v3
    s_cbranch_vccz Lspun_7
    s_sleep 2
    s_sub_u32 s81, s81, 1
    s_cbranch_scc0 Lspin_6
Lspun_7:
    v_mov_b32 v5, 162912
    v_mov_b32 v4, 1
    ds_write_b32 v5, v4 offset:4
    s_lshl_b32 s72, s3, 2
    s_add_u32 s72, s72, 162928
    v_mov_b32 v2, s72
    ds_write_b32 v2, v4
    s_mov_b64 exec, 1
    buffer_store_dword v3, off, s[60:63], s29 sc1
    s_mov_b64 exec, -1
    s_lshl_b32 s72, s6, 1
    s_lshr_b32 s73, s3, 2
    s_xor_b32 s73, s73, s7
    s_and_b32 s73, s73, 1
    s_add_u32 s72, s72, s73
    s_mul_i32 s72, s72, 40
    s_and_b32 s73, s3, 3
    s_mul_i32 s73, s73, 10
    s_add_u32 s72, s72, s73
    s_lshl_b32 s72, s72, 10
    s_add_u32 s72, s72, 4194304
    v_lshlrev_b32 v2, 4, v1
    buffer_load_dwordx4 v[116:119], v2, s[60:63], s72 offen offset:0 sc1
    buffer_load_dwordx4 v[120:123], v2, s[60:63], s72 offen offset:1024 sc1
    buffer_load_dwordx4 v[124:127], v2, s[60:63], s72 offen offset:2048 sc1
    buffer_load_dwordx4 v[128:131], v2, s[60:63], s72 offen offset:3072 sc1
    s_add_u32 s72, s72, 4096
    buffer_load_dwordx4 v[132:135], v2, s[60:63], s72 offen offset:0 sc1
    buffer_load_dwordx4 v[136:139], v2, s[60:63], s72 offen offset:1024 sc1
    buffer_load_dwordx4 v[140:143], v2, s[60:63], s72 offen offset:2048 sc1
    buffer_load_dwordx4 v[144:147], v2, s[60:63], s72 offen offset:3072 sc1
    s_add_u32 s72, s72, 4096
    buffer_load_dwordx4 v[148:151], v2, s[60:63], s72 offen offset:0 sc1
    buffer_load_dwordx4 v[152:155], v2, s[60:63], s72 offen offset:1024 sc1
    ds_read_b64_tr_b16 v[16:17], v236 offset:0
    ds_read_b64_tr_b16 v[18:19], v236 offset:2560
    ds_read_b64_tr_b16 v[20:21], v236 offset:32
    ds_read_b64_tr_b16 v[22:23], v236 offset:2592
    ds_read_b64_tr_b16 v[24:25], v236 offset:64
    ds_read_b64_tr_b16 v[26:27], v236 offset:2624
    ds_read_b64_tr_b16 v[28:29], v236 offset:96
    ds_read_b64_tr_b16 v[30:31], v236 offset:2656
    ds_read_b64_tr_b16 v[32:33], v236 offset:128
    ds_read_b64_tr_b16 v[34:35], v236 offset:2688
    ds_read_b64_tr_b16 v[36:37], v237 offset:0
    ds_read_b64_tr_b16 v[38:39], v237 offset:2560
    ds_read_b64_tr_b16 v[40:41], v237 offset:32
    ds_read_b64_tr_b16 v[42:43], v237 offset:2592
    ds_read_b64_tr_b16 v[44:45], v237 offset:64
    ds_read_b64_tr_b16 v[46:47], v237 offset:2624
    ds_read_b64_tr_b16 v[48:49], v237 offset:96
    ds_read_b64_tr_b16 v[50:51], v237 offset:2656
    ds_read_b64_tr_b16 v[52:53], v237 offset:128
    ds_read_b64_tr_b16 v[54:55], v237 offset:2688
    ds_read_b64_tr_b16 v[56:57], v238 offset:0
    ds_read_b64_tr_b16 v[58:59], v238 offset:2560
    ds_read_b64_tr_b16 v[60:61], v238 offset:32
    ds_read_b64_tr_b16 v[62:63], v238 offset:2592
    ds_read_b64_tr_b16 v[64:65], v238 offset:64
    ds_read_b64_tr_b16 v[66:67], v238 offset:2624
    ds_read_b64_tr_b16 v[68:69], v238 offset:96
    ds_read_b64_tr_b16 v[70:71], v238 offset:2656
    ds_read_b64_tr_b16 v[72:73], v238 offset:128
    ds_read_b64_tr_b16 v[74:75], v238 offset:2688
    ds_read_b64_tr_b16 v[76:77], v239 offset:0
    ds_read_b64_tr_b16 v[78:79], v239 offset:2560
    ds_read_b64_tr_b16 v[80:81], v239 offset:32
    ds_read_b64_tr_b16 v[82:83], v239 offset:2592
    ds_read_b64_tr_b16 v[84:85], v239 offset:64
    ds_read_b64_tr_b16 v[86:87], v239 offset:2624
    ds_read_b64_tr_b16 v[88:89], v239 offset:96
    ds_read_b64_tr_b16 v[90:91], v239 offset:2656
    ds_read_b64_tr_b16 v[92:93], v239 offset:128
    ds_read_b64_tr_b16 v[94:95], v239 offset:2688
    ds_read_b64_tr_b16 v[96:97], v240 offset:0
    ds_read_b64_tr_b16 v[98:99], v240 offset:2560
    ds_read_b64_tr_b16 v[100:101], v240 offset:32
    ds_read_b64_tr_b16 v[102:103], v240 offset:2592
    ds_read_b64_tr_b16 v[104:105], v240 offset:64
    ds_read_b64_tr_b16 v[106:107], v240 offset:2624
    ds_read_b64_tr_b16 v[108:109], v240 offset:96
    ds_read_b64_tr_b16 v[110:111], v240 offset:2656
    ds_read_b64_tr_b16 v[112:113], v240 offset:128
    ds_read_b64_tr_b16 v[114:115], v240 offset:2688
    s_waitcnt vmcnt(0)
    s_and_b32 s72, s3, 3
    s_lshl_b32 s72, s72, 10
    s_mul_i32 s73, s4, 32896
    s_add_u32 s72, s72, s73
    v_add_u32 v11, s72, v251
    v_add_u32 v10, 4096, v11
    s_mov_b32 s72, 3670016
    s_mov_b32 s73, 3678208
    s_mov_b32 s74, 3686400
    s_mov_b32 s75, 3694592
    buffer_load_dwordx4 v[156:159], v11, s[60:63], s72 offen sc1
    buffer_load_dwordx4 v[160:163], v10, s[60:63], s72 offen sc1
    buffer_load_dwordx4 v[164:167], v11, s[60:63], s73 offen sc1
    buffer_load_dwordx4 v[168:171], v10, s[60:63], s73 offen sc1
    buffer_load_dwordx4 v[172:175], v11, s[60:63], s74 offen sc1
    buffer_load_dwordx4 v[176:179], v10, s[60:63], s74 offen sc1
    buffer_load_dwordx4 v[180:183], v11, s[60:63], s75 offen sc1
    buffer_load_dwordx4 v[184:187], v10, s[60:63], s75 offen sc1
    v_mov_b64 v[196:197], v[118:119]
    v_mov_b64 v[198:199], v[122:123]
    v_mov_b64 v[200:201], v[126:127]
    v_mov_b64 v[202:203], v[130:131]
    v_mov_b64 v[204:205], v[134:135]
    v_mov_b64 v[206:207], v[138:139]
    v_mov_b64 v[208:209], v[142:143]
    v_mov_b64 v[210:211], v[146:147]
    v_mov_b64 v[212:213], v[150:151]
    v_mov_b64 v[118:119], v[120:121]
    v_mov_b64 v[120:121], v[124:125]
    v_mov_b64 v[122:123], v[128:129]
    v_mov_b64 v[124:125], v[132:133]
    v_mov_b64 v[126:127], v[136:137]
    v_mov_b64 v[128:129], v[140:141]
    v_mov_b64 v[130:131], v[144:145]
    v_mov_b64 v[132:133], v[148:149]
    v_mov_b64 v[134:135], v[152:153]
    v_mov_b64 v[136:137], v[196:197]
    v_mov_b64 v[138:139], v[198:199]
    v_mov_b64 v[140:141], v[200:201]
    v_mov_b64 v[142:143], v[202:203]
    v_mov_b64 v[144:145], v[204:205]
    v_mov_b64 v[146:147], v[206:207]
    v_mov_b64 v[148:149], v[208:209]
    v_mov_b64 v[150:151], v[210:211]
    v_mov_b64 v[152:153], v[212:213]
    s_waitcnt vmcnt(0)
    v_max3_u32 v8, v156, v157, v158
    v_max3_u32 v8, v8, v159, v160
    v_max3_u32 v8, v8, v161, v162
    v_max3_u32 v8, v8, v163, v164
    v_max3_u32 v8, v8, v165, v166
    v_max3_u32 v8, v8, v167, v168
    v_max3_u32 v8, v8, v169, v170
    v_max3_u32 v8, v8, v171, v172
    v_max3_u32 v8, v8, v173, v174
    v_max3_u32 v8, v8, v175, v176
    v_max3_u32 v8, v8, v177, v178
    v_max3_u32 v8, v8, v179, v180
    v_max3_u32 v8, v8, v181, v182
    v_max3_u32 v8, v8, v183, v184
    v_max3_u32 v8, v8, v185, v186
    v_max_u32 v8, v8, v187
    v_cmp_eq_u32 vcc, -1, v8
    s_cbranch_vccz Ltok_8
    s_mov_b32 s81, 100000
Lspin_9:
    buffer_load_dwordx4 v[156:159], v11, s[60:63], s72 offen sc1
    buffer_load_dwordx4 v[160:163], v10, s[60:63], s72 offen sc1
    buffer_load_dwordx4 v[164:167], v11, s[60:63], s73 offen sc1
    buffer_load_dwordx4 v[168:171], v10, s[60:63], s73 offen sc1
    buffer_load_dwordx4 v[172:175], v11, s[60:63], s74 offen sc1
    buffer_load_dwordx4 v[176:179], v10, s[60:63], s74 offen sc1
    buffer_load_dwordx4 v[180:183], v11, s[60:63], s75 offen sc1
    buffer_load_dwordx4 v[184:187], v10, s[60:63], s75 offen sc1
    s_waitcnt vmcnt(0)
    v_max3_u32 v8, v156, v157, v158
    v_max3_u32 v8, v8, v159, v160
    v_max3_u32 v8, v8, v161, v162
    v_max3_u32 v8, v8, v163, v164
    v_max3_u32 v8, v8, v165, v166
    v_max3_u32 v8, v8, v167, v168
    v_max3_u32 v8, v8, v169, v170
    v_max3_u32 v8, v8, v171, v172
    v_max3_u32 v8, v8, v173, v174
    v_max3_u32 v8, v8, v175, v176
    v_max3_u32 v8, v8, v177, v178
    v_max3_u32 v8, v8, v179, v180
    v_max3_u32 v8, v8, v181, v182
    v_max3_u32 v8, v8, v183, v184
    v_max3_u32 v8, v8, v185, v186
    v_max_u32 v8, v8, v187
    v_cmp_eq_u32 vcc, -1, v8
    s_cbranch_vccz Lspun_10
    s_sleep 1
    s_sub_u32 s81, s81, 1
    s_cbranch_scc0 Lspin_9
Lspun_10:
Ltok_8:
L_scat:
    ds_write_b64 v241, v[156:157] offset:0
    ds_write_b64 v242, v[158:159] offset:0
    ds_write_b64 v241, v[160:161] offset:5376
    ds_write_b64 v242, v[162:163] offset:5376
    ds_write_b64 v241, v[164:165] offset:10752
    ds_write_b64 v242, v[166:167] offset:10752
    ds_write_b64 v241, v[168:169] offset:16128
    ds_write_b64 v242, v[170:171] offset:16128
    ds_write_b64 v241, v[172:173] offset:21504
    ds_write_b64 v242, v[174:175] offset:21504
    ds_write_b64 v241, v[176:177] offset:26880
    ds_write_b64 v242, v[178:179] offset:26880
    ds_write_b64 v241, v[180:181] offset:32256
    ds_write_b64 v242, v[182:183] offset:32256
    ds_write_b64 v241, v[184:185] offset:37632
    ds_write_b64 v242, v[186:187] offset:37632
    s_branch L_join2
L_comp:
    s_and_b32 s15, s3, 1
    s_lshr_b32 s42, s3, 1
    v_mov_b32 v2, 162912
    v_mov_b32 v4, 0
    v_mov_b32 v5, 0
    v_mov_b32 v6, 0
    v_mov_b32 v7, 0
    ds_write_b128 v2, v[4:7]
    ds_write_b128 v2, v[4:7] offset:32
    v_and_b32 v9, 15, v1
    v_lshrrev_b32 v10, 4, v1
    v_lshrrev_b32 v11, 1, v9
    v_xor_b32 v11, v11, v10
    v_lshlrev_b32 v11, 4, v11
    v_lshl_add_u32 v11, v9, 7, v11
    s_lshl_b32 s72, s15, 13
    v_add_u32 v12, s72, v11
    v_xor_b32 v13, 64, v12
    v_bfe_u32 v11, v1, 2, 2
    v_lshl_add_u32 v11, v10, 3, v11
    v_mul_u32_u24 v11, 320, v11
    v_and_b32 v14, 3, v1
    v_lshl_add_u32 v11, v14, 3, v11
    s_mul_i32 s72, s42, 160
    s_add_u32 s72, s72, 16384
    v_add_u32 v11, s72, v11
    v_and_b32 v14, 1, v10
    v_lshlrev_b32 v14, 5, v14
    v_add_u32 v15, v11, v14
    v_sub_u32 v16, v11, v14
    s_cmp_eq_u32 s42, 0
    s_cselect_b64 vcc, -1, 0
    v_cndmask_b32 v14, v16, v15, vcc
    v_cndmask_b32 v15, v15, v16, vcc
    v_add_u32 v16, 73728, v12
    v_add_u32 v17, 73728, v13
    v_add_u32 v18, 73728, v14
    v_add_u32 v19, 73728, v15
    s_mov_b32 s76, 1069066811
    s_mov_b32 s77, 897988541
    s_add_u32 s43, s14, s42
    s_waitcnt lgkmcnt(0)
    s_mov_b32 s60, s40
    s_and_b32 s61, s41, 0xffff
    s_mov_b32 s62, 268435456
    s_mov_b32 s63, 0x00020000
    s_mov_b32 s44, s16
    s_and_b32 s45, s17, 0xffff
    s_mov_b32 s46, 2621440
    s_mov_b32 s47, 0x00020000
    s_cmp_ge_u32 s10, 4
    s_cbranch_scc1 L_q
    v_and_b32 v2, 15, v1
    v_lshrrev_b32 v3, 4, v1
    s_and_b32 s75, s5, 7
    s_cmp_ge_u32 s75, 5
    s_cselect_b32 s1, 5, 0
    s_sub_u32 s75, s75, s1
    s_and_b32 s1, s3, 3
    v_lshrrev_b32 v4, 1, v3
    v_lshlrev_b32 v4, 3, v4
    v_bfe_u32 v5, v1, 2, 2
    v_lshl_add_u32 v4, v5, 1, v4
    v_and_b32 v5, 1, v3
    v_add_u32 v4, v4, v5
    v_mul_u32_u24 v4, 160, v4
    v_and_b32 v5, 3, v1
    v_lshl_add_u32 v4, v5, 3, v4
    s_sub_u32 s75, 5, s75
    s_cmp_ge_u32 s75, 5
    s_cselect_b32 s75, 0, s75
    s_mul_i32 s72, s1, 15360
    s_add_u32 s72, s72, 40960
    s_mul_i32 s73, s1, 10240
    s_sub_u32 s73, s73, 15360
    s_cmp_ge_u32 s75, 3
    s_cselect_b32 s72, s73, s72
    s_mul_i32 s73, s75, 5120
    s_add_u32 s72, s72, s73
    v_add_u32 v236, s72, v4
    s_add_u32 s75, s75, 1
    s_cmp_ge_u32 s75, 5
    s_cselect_b32 s75, 0, s75
    s_mul_i32 s72, s1, 15360
    s_add_u32 s72, s72, 40960
    s_mul_i32 s73, s1, 10240
    s_sub_u32 s73, s73, 15360
    s_cmp_ge_u32 s75, 3
    s_cselect_b32 s72, s73, s72
    s_mul_i32 s73, s75, 5120
    s_add_u32 s72, s72, s73
    v_add_u32 v237, s72, v4
    s_add_u32 s75, s75, 1
    s_cmp_ge_u32 s75, 5
    s_cselect_b32 s75, 0, s75
    s_mul_i32 s72, s1, 15360
    s_add_u32 s72, s72, 40960
    s_mul_i32 s73, s1, 10240
    s_sub_u32 s73, s73, 15360
    s_cmp_ge_u32 s75, 3
    s_cselect_b32 s72, s73, s72
    s_mul_i32 s73, s75, 5120
    s_add_u32 s72, s72, s73
    v_add_u32 v238, s72, v4
    s_add_u32 s75, s75, 1
    s_cmp_ge_u32 s75, 5
    s_cselect_b32 s75, 0, s75
    s_mul_i32 s72, s1, 15360
    s_add_u32 s72, s72, 40960
    s_mul_i32 s73, s1, 10240
    s_sub_u32 s73, s73, 15360
    s_cmp_ge_u32 s75, 3
    s_cselect_b32 s72, s73, s72
    s_mul_i32 s73, s75, 5120
    s_add_u32 s72, s72, s73
    v_add_u32 v239, s72, v4
    s_add_u32 s75, s75, 1
    s_cmp_ge_u32 s75, 5
    s_cselect_b32 s75, 0, s75
    s_mul_i32 s72, s1, 15360
    s_add_u32 s72, s72, 40960
    s_mul_i32 s73, s1, 10240
    s_sub_u32 s73, s73, 15360
    s_cmp_ge_u32 s75, 3
    s_cselect_b32 s72, s73, s72
    s_mul_i32 s73, s75, 5120
    s_add_u32 s72, s72, s73
    v_add_u32 v240, s72, v4
    s_add_u32 s75, s75, 1
    v_lshrrev_b32 v4, 2, v1
    v_lshlrev_b32 v4, 7, v4
    v_lshl_add_u32 v4, v5, 3, v4
    s_lshr_b32 s73, s3, 2
    s_lshl_b32 s72, s73, 11
    s_lshl_b32 s74, s1, 5
    s_add_u32 s72, s72, s74
    s_add_u32 s72, s72, 81920
    v_add_u32 v249, s72, v4
    s_mul_i32 s72, s1, 10752
    s_add_u32 s72, s72, 102400
    v_lshlrev_b32 v4, 4, v3
    v_and_b32 v6, 8, v2
    v_lshlrev_b32 v6, 2, v6
    v_xor_b32 v6, v6, v4
    v_lshl_add_u32 v6, v2, 6, v6
    v_add_u32 v244, s72, v6
    v_lshrrev_b32 v6, 2, v2
    v_add_u32 v6, 16, v6
    v_lshl_add_u32 v6, v6, 6, v4
    v_xor_b32 v7, 32, v4
    v_add_u32 v7, 1280, v7
    v_cmp_eq_u32 vcc, 0, v5
    s_nop 1
    v_cndmask_b32 v6, v7, v6, vcc
    v_add_u32 v245, s72, v6
    v_lshlrev_b32 v251, 4, v1
    s_mul_i32 s72, s1, 20480
    s_xor_b32 s74, s73, s7
    s_and_b32 s74, s74, 1
    s_mul_i32 s74, s74, 10240
    s_add_u32 s72, s72, s74
    v_add_u32 v246, s72, v251
    s_mul_i32 s72, s1, 5120
    s_lshl_b32 s74, s73, 10
    s_add_u32 s72, s72, s74
    v_add_u32 v247, s72, v251
    s_lshl_b32 s72, s6, 6
    s_lshl_b32 s74, s1, 4
    s_add_u32 s72, s72, s74
    v_add_u32 v4, s72, v2
    v_mul_u32_u24 v4, 1280, v4
    v_lshl_add_u32 v4, v3, 3, v4
    s_mul_i32 s72, s7, 160
    s_lshl_b32 s74, s73, 5
    s_add_u32 s72, s72, s74
    v_add_u32 v248, s72, v4
    s_mul_i32 s72, s7, 80
    s_lshl_b32 s74, s3, 3
    s_add_u32 s72, s72, s74
    v_lshrrev_b32 v4, 3, v1
    v_add_u32 v4, s72, v4
    v_mul_u32_u24 v4, 4224, v4
    v_and_b32 v6, 7, v1
    v_lshl_add_u32 v4, v6, 4, v4
    s_lshl_b32 s72, s6, 7
    s_add_u32 s72, s72, 6815744
    v_add_u32 v250, s72, v4
    v_lshlrev_b32 v2, 1, v1
    s_add_u32 s72, s1, 5
    s_and_b32 s73, s72, 3
    s_lshl_b32 s73, s73, 4
    s_bfe_u32 s72, s72, 0x10002
    s_lshl_b32 s72, s72, 3
    s_add_u32 s73, s73, s72
    s_mul_i32 s72, s1, 1344
    s_add_u32 s72, s72, 102400
    v_mul_u32_u24 v3, 3121, v2
    v_lshrrev_b32 v3, 16, v3
    v_mul_u32_u24 v4, 21, v3
    v_sub_u32 v4, v2, v4
    v_and_b32 v5, 3, v4
    v_lshrrev_b32 v6, 2, v4
    v_lshl_add_u32 v5, v5, 2, v6
    v_cmp_gt_u32 vcc, 16, v4
    s_nop 1
    v_cndmask_b32 v4, v4, v5, vcc
    v_add_u32 v3, s1, v3
    v_and_b32 v5, 3, v3
    v_lshlrev_b32 v5, 4, v5
    v_and_b32 v6, 8, v4
    v_lshlrev_b32 v6, 2, v6
    v_cmp_eq_u32 vcc, 20, v4
    s_nop 1
    v_cndmask_b32 v6, v6, 32, vcc
    v_xor_b32 v5, v5, v6
    v_lshl_add_u32 v4, v4, 6, v5
    v_lshrrev_b32 v3, 2, v3
    v_lshl_add_u32 v4, v3, 3, v4
    v_cmp_gt_u32 vcc, 105, v2
    v_mov_b32 v5, s73
    s_nop 0
    v_cndmask_b32 v4, v5, v4, vcc
    v_add_u32 v241, s72, v4
    v_add_u32 v2, 1, v2
    v_mul_u32_u24 v3, 3121, v2
    v_lshrrev_b32 v3, 16, v3
    v_mul_u32_u24 v4, 21, v3
    v_sub_u32 v4, v2, v4
    v_and_b32 v5, 3, v4
    v_lshrrev_b32 v6, 2, v4
    v_lshl_add_u32 v5, v5, 2, v6
    v_cmp_gt_u32 vcc, 16, v4
    s_nop 1
    v_cndmask_b32 v4, v4, v5, vcc
    v_add_u32 v3, s1, v3
    v_and_b32 v5, 3, v3
    v_lshlrev_b32 v5, 4, v5
    v_and_b32 v6, 8, v4
    v_lshlrev_b32 v6, 2, v6
    v_cmp_eq_u32 vcc, 20, v4
    s_nop 1
    v_cndmask_b32 v6, v6, 32, vcc
    v_xor_b32 v5, v5, v6
    v_lshl_add_u32 v4, v4, 6, v5
    v_lshrrev_b32 v3, 2, v3
    v_lshl_add_u32 v4, v3, 3, v4
    v_cmp_gt_u32 vcc, 105, v2
    v_mov_b32 v5, s73
    s_nop 0
    v_cndmask_b32 v4, v5, v4, vcc
    v_add_u32 v242, s72, v4
    s_cmp_eq_u32 s3, 0
    s_cbranch_scc1 Lnz_11
    v_mov_b32 v4, 0
    v_mov_b32 v5, 0
    v_mov_b32 v6, 0
    v_mov_b32 v7, 0
    s_mul_i32 s72, s3, 10752
    s_add_u32 s72, s72, 102400
    v_add_u32 v2, s72, v251
    ds_write_b128 v2, v[4:7] offset:0
    ds_write_b128 v2, v[4:7] offset:1024
    ds_write_b128 v2, v[4:7] offset:2048
    ds_write_b128 v2, v[4:7] offset:3072
    ds_write_b128 v2, v[4:7] offset:4096
    ds_write_b128 v2, v[4:7] offset:5120
    ds_write_b128 v2, v[4:7] offset:6144
    ds_write_b128 v2, v[4:7] offset:7168
    ds_write_b128 v2, v[4:7] offset:8192
    ds_write_b128 v2, v[4:7] offset:9216
    s_mov_b32 exec_hi, 0
    ds_write_b128 v2, v[4:7] offset:10240
    s_mov_b32 exec_hi, -1
Lnz_11:
    s_mul_i32 s73, s42, 30720
    s_mul_i32 s72, s15, 1792
    s_add_u32 s73, s73, s72
    s_add_u32 s73, s73, 51200
    s_movk_i32 s72, 960
    v_add_u32 v216, 0, v10
    v_cmp_le_u32 vcc, 5, v216
    s_nop 1
    v_cndmask_b32 v217, 0, 1, vcc
    v_add_u32 v218, -8, v9
    v_mul_u32_u24 v219, 20, v217
    v_sub_u32 v220, v218, v219
    v_cmp_gt_u32 s[78:79], 20, v220
    v_cmp_eq_u32 vcc, -8, v218
    s_nop 1
    v_cndmask_b32 v220, v220, 20, vcc
    s_or_b64 s[78:79], s[78:79], vcc
    v_cmp_gt_u32 vcc, 10, v216
    s_nop 0
    s_and_b64 s[78:79], vcc, s[78:79]
    v_mul_u32_u24 v219, 5, v217
    v_sub_u32 v216, v216, v219
    v_mad_u32_u24 v220, v216, 21, v220
    v_mad_u32_u24 v220, v217, s72, v220
    v_mov_b32 v219, 111
    v_cndmask_b32 v220, v219, v220, s[78:79]
    v_lshl_add_u32 v176, v220, 4, s73
    v_add_u32 v216, 0, v10
    v_cmp_le_u32 vcc, 5, v216
    s_nop 1
    v_cndmask_b32 v217, 0, 1, vcc
    v_add_u32 v218, 8, v9
    v_mul_u32_u24 v219, 20, v217
    v_sub_u32 v220, v218, v219
    v_cmp_gt_u32 s[78:79], 20, v220
    v_cmp_eq_u32 vcc, -8, v218
    s_nop 1
    v_cndmask_b32 v220, v220, 20, vcc
    s_or_b64 s[78:79], s[78:79], vcc
    v_cmp_gt_u32 vcc, 10, v216
    s_nop 0
    s_and_b64 s[78:79], vcc, s[78:79]
    v_mul_u32_u24 v219, 5, v217
    v_sub_u32 v216, v216, v219
    v_mad_u32_u24 v220, v216, 21, v220
    v_mad_u32_u24 v220, v217, s72, v220
    v_mov_b32 v219, 111
    v_cndmask_b32 v220, v219, v220, s[78:79]
    v_lshl_add_u32 v177, v220, 4, s73
    v_add_u32 v216, 4, v10
    v_cmp_le_u32 vcc, 5, v216
    s_nop 1
    v_cndmask_b32 v217, 0, 1, vcc
    v_add_u32 v218, -8, v9
    v_mul_u32_u24 v219, 20, v217
    v_sub_u32 v220, v218, v219
    v_cmp_gt_u32 s[78:79], 20, v220
    v_cmp_eq_u32 vcc, -8, v218
    s_nop 1
    v_cndmask_b32 v220, v220, 20, vcc
    s_or_b64 s[78:79], s[78:79], vcc
    v_cmp_gt_u32 vcc, 10, v216
    s_nop 0
    s_and_b64 s[78:79], vcc, s[78:79]
    v_mul_u32_u24 v219, 5, v217
    v_sub_u32 v216, v216, v219
    v_mad_u32_u24 v220, v216, 21, v220
    v_mad_u32_u24 v220, v217, s72, v220
    v_mov_b32 v219, 111
    v_cndmask_b32 v220, v219, v220, s[78:79]
    v_lshl_add_u32 v178, v220, 4, s73
    v_add_u32 v216, 4, v10
    v_cmp_le_u32 vcc, 5, v216
    s_nop 1
    v_cndmask_b32 v217, 0, 1, vcc
    v_add_u32 v218, 8, v9
    v_mul_u32_u24 v219, 20, v217
    v_sub_u32 v220, v218, v219
    v_cmp_gt_u32 s[78:79], 20, v220
    v_cmp_eq_u32 vcc, -8, v218
    s_nop 1
    v_cndmask_b32 v220, v220, 20, vcc
    s_or_b64 s[78:79], s[78:79], vcc
    v_cmp_gt_u32 vcc, 10, v216
    s_nop 0
    s_and_b64 s[78:79], vcc, s[78:79]
    v_mul_u32_u24 v219, 5, v217
    v_sub_u32 v216, v216, v219
    v_mad_u32_u24 v220, v216, 21, v220
    v_mad_u32_u24 v220, v217, s72, v220
    v_mov_b32 v219, 111
    v_cndmask_b32 v220, v219, v220, s[78:79]
    v_lshl_add_u32 v179, v220, 4, s73
    v_add_u32 v216, 4, v10
    v_cmp_le_u32 vcc, 5, v216
    s_nop 1
    v_cndmask_b32 v217, 0, 1, vcc
    v_add_u32 v218, 24, v9
    v_mul_u32_u24 v219, 20, v217
    v_sub_u32 v220, v218, v219
    v_cmp_gt_u32 s[78:79], 20, v220
    v_cmp_eq_u32 vcc, -8, v218
    s_nop 1
    v_cndmask_b32 v220, v220, 20, vcc
    s_or_b64 s[78:79], s[78:79], vcc
    v_cmp_gt_u32 vcc, 10, v216
    s_nop 0
    s_and_b64 s[78:79], vcc, s[78:79]
    v_mul_u32_u24 v219, 5, v217
    v_sub_u32 v216, v216, v219
    v_mad_u32_u24 v220, v216, 21, v220
    v_mad_u32_u24 v220, v217, s72, v220
    v_mov_b32 v219, 111
    v_cndmask_b32 v220, v219, v220, s[78:79]
    v_lshl_add_u32 v180, v220, 4, s73
    v_add_u32 v216, 8, v10
    v_cmp_le_u32 vcc, 5, v216
    s_nop 1
    v_cndmask_b32 v217, 0, 1, vcc
    v_add_u32 v218, -8, v9
    v_mul_u32_u24 v219, 20, v217
    v_sub_u32 v220, v218, v219
    v_cmp_gt_u32 s[78:79], 20, v220
    v_cmp_eq_u32 vcc, -8, v218
    s_nop 1
    v_cndmask_b32 v220, v220, 20, vcc
    s_or_b64 s[78:79], s[78:79], vcc
    v_cmp_gt_u32 vcc, 10, v216
    s_nop 0
    s_and_b64 s[78:79], vcc, s[78:79]
    v_mul_u32_u24 v219, 5, v217
    v_sub_u32 v216, v216, v219
    v_mad_u32_u24 v220, v216, 21, v220
    v_mad_u32_u24 v220, v217, s72, v220
    v_mov_b32 v219, 111
    v_cndmask_b32 v220, v219, v220, s[78:79]
    v_lshl_add_u32 v181, v220, 4, s73
    v_add_u32 v216, 8, v10
    v_cmp_le_u32 vcc, 5, v216
    s_nop 1
    v_cndmask_b32 v217, 0, 1, vcc
    v_add_u32 v218, 8, v9
    v_mul_u32_u24 v219, 20, v217
    v_sub_u32 v220, v218, v219
    v_cmp_gt_u32 s[78:79], 20, v220
    v_cmp_eq_u32 vcc, -8, v218
    s_nop 1
    v_cndmask_b32 v220, v220, 20, vcc
    s_or_b64 s[78:79], s[78:79], vcc
    v_cmp_gt_u32 vcc, 10, v216
    s_nop 0
    s_and_b64 s[78:79], vcc, s[78:79]
    v_mul_u32_u24 v219, 5, v217
    v_sub_u32 v216, v216, v219
    v_mad_u32_u24 v220, v216, 21, v220
    v_mad_u32_u24 v220, v217, s72, v220
    v_mov_b32 v219, 111
    v_cndmask_b32 v220, v219, v220, s[78:79]
    v_lshl_add_u32 v182, v220, 4, s73
    v_add_u32 v216, 8, v10
    v_cmp_le_u32 vcc, 5, v216
    s_nop 1
    v_cndmask_b32 v217, 0, 1, vcc
    v_add_u32 v218, 24, v9
    v_mul_u32_u24 v219, 20, v217
    v_sub_u32 v220, v218, v219
    v_cmp_gt_u32 s[78:79], 20, v220
    v_cmp_eq_u32 vcc, -8, v218
    s_nop 1
    v_cndmask_b32 v220, v220, 20, vcc
    s_or_b64 s[78:79], s[78:79], vcc
    v_cmp_gt_u32 vcc, 10, v216
    s_nop 0
    s_and_b64 s[78:79], vcc, s[78:79]
    v_mul_u32_u24 v219, 5, v217
    v_sub_u32 v216, v216, v219
    v_mad_u32_u24 v220, v216, 21, v220
    v_mad_u32_u24 v220, v217, s72, v220
    v_mov_b32 v219, 111
    v_cndmask_b32 v220, v219, v220, s[78:79]
    v_lshl_add_u32 v183, v220, 4, s73
    s_waitcnt lgkmcnt(0)
    s_mov_b32 s56, s38
    s_and_b32 s57, s39, 0xffff
    s_mov_b32 s58, 256
    s_mov_b32 s59, 0x00020000
    s_cmp_eq_u32 s3, 0
    s_cbranch_scc0 Lfl_12
    s_mul_i32 s72, s12, 114688
    s_mul_i32 s73, s9, 1792
    s_add_u32 s72, s72, s73
    s_add_u32 s72, s72, 2752512
    v_mov_b32 v4, -1
    v_mov_b32 v5, -1
    v_mov_b32 v6, -1
    v_mov_b32 v7, -1
    v_lshlrev_b32 v2, 4, v1
    s_mov_b32 exec_hi, 0xffffff
    buffer_store_dwordx4 v[4:7], v2, s[60:63], s72 offen offset:0 sc1
    buffer_store_dwordx4 v[4:7], v2, s[60:63], s72 offen offset:896 sc1
    s_add_u32 s72, s72, 28672
    buffer_store_dwordx4 v[4:7], v2, s[60:63], s72 offen offset:0 sc1
    buffer_store_dwordx4 v[4:7], v2, s[60:63], s72 offen offset:896 sc1
    s_add_u32 s72, s72, 28672
    buffer_store_dwordx4 v[4:7], v2, s[60:63], s72 offen offset:0 sc1
    buffer_store_dwordx4 v[4:7], v2, s[60:63], s72 offen offset:896 sc1
    s_add_u32 s72, s72, 28672
    buffer_store_dwordx4 v[4:7], v2, s[60:63], s72 offen offset:0 sc1
    buffer_store_dwordx4 v[4:7], v2, s[60:63], s72 offen offset:896 sc1
    s_mov_b32 exec_hi, -1
    buffer_load_dword v253, off, s[56:59], 0 sc1
Lfl_12:
    s_waitcnt lgkmcnt(0)
    s_barrier
    ds_read_b128 v[104:107], v12 offset:0
    ds_read_b64_tr_b16 v[136:137], v14 offset:0
    ds_read_b64_tr_b16 v[138:139], v14 offset:1280
    ds_read_b128 v[108:111], v12 offset:2048
    ds_read_b128 v[112:115], v12 offset:4096
    ds_read_b128 v[116:119], v12 offset:6144
    ds_read_b64_tr_b16 v[140:141], v15 offset:32
    ds_read_b64_tr_b16 v[142:143], v15 offset:1312
    ds_read_b64_tr_b16 v[144:145], v14 offset:64
    ds_read_b64_tr_b16 v[146:147], v14 offset:1344
    ds_read_b64_tr_b16 v[148:149], v15 offset:96
    ds_read_b64_tr_b16 v[150:151], v15 offset:1376
    ds_read_b64_tr_b16 v[152:153], v14 offset:128
    ds_read_b64_tr_b16 v[154:155], v14 offset:1408
    s_waitcnt lgkmcnt(11)
    v_mfma_f32_16x16x32_bf16 v[24:27], v[104:107], v[136:139], 0
    ds_read_b128 v[120:123], v13 offset:0
    s_waitcnt lgkmcnt(11)
    v_mfma_f32_16x16x32_bf16 v[44:47], v[108:111], v[136:139], 0
    ds_read_b64_tr_b16 v[156:157], v14 offset:10240
    s_waitcnt lgkmcnt(11)
    v_mfma_f32_16x16x32_bf16 v[64:67], v[112:115], v[136:139], 0
    ds_read_b64_tr_b16 v[158:159], v14 offset:11520
    s_waitcnt lgkmcnt(11)
    v_mfma_f32_16x16x32_bf16 v[84:87], v[116:119], v[136:139], 0
    s_waitcnt lgkmcnt(9)
    v_mfma_f32_16x16x32_bf16 v[28:31], v[104:107], v[140:143], 0
    ds_read_b128 v[124:127], v13 offset:2048
    v_mfma_f32_16x16x32_bf16 v[48:51], v[108:111], v[140:143], 0
    ds_read_b128 v[128:131], v13 offset:4096
    v_mfma_f32_16x16x32_bf16 v[68:71], v[112:115], v[140:143], 0
    v_mfma_f32_16x16x32_bf16 v[88:91], v[116:119], v[140:143], 0
    ds_read_b128 v[132:135], v13 offset:6144
    s_waitcnt lgkmcnt(10)
    v_mfma_f32_16x16x32_bf16 v[32:35], v[104:107], v[144:147], 0
    ds_read_b64_tr_b16 v[160:161], v15 offset:10272
    v_mfma_f32_16x16x32_bf16 v[52:55], v[108:111], v[144:147], 0
    v_mfma_f32_16x16x32_bf16 v[72:75], v[112:115], v[144:147], 0
    ds_read_b64_tr_b16 v[162:163], v15 offset:11552
    v_mfma_f32_16x16x32_bf16 v[92:95], v[116:119], v[144:147], 0
    ds_read_b64_tr_b16 v[164:165], v14 offset:10304
    s_waitcnt lgkmcnt(11)
    v_mfma_f32_16x16x32_bf16 v[36:39], v[104:107], v[148:151], 0
    ds_read_b64_tr_b16 v[166:167], v14 offset:11584
    v_mfma_f32_16x16x32_bf16 v[56:59], v[108:111], v[148:151], 0
    v_mfma_f32_16x16x32_bf16 v[76:79], v[112:115], v[148:151], 0
    ds_read_b64_tr_b16 v[168:169], v15 offset:10336
    v_mfma_f32_16x16x32_bf16 v[96:99], v[116:119], v[148:151], 0
    ds_read_b64_tr_b16 v[170:171], v15 offset:11616
    s_waitcnt lgkmcnt(12)
    v_mfma_f32_16x16x32_bf16 v[40:43], v[104:107], v[152:155], 0
    v_mfma_f32_16x16x32_bf16 v[60:63], v[108:111], v[152:155], 0
    ds_read_b64_tr_b16 v[172:173], v14 offset:10368
    v_mfma_f32_16x16x32_bf16 v[80:83], v[112:115], v[152:155], 0
    ds_read_b64_tr_b16 v[174:175], v14 offset:11648
    v_mfma_f32_16x16x32_bf16 v[100:103], v[116:119], v[152:155], 0
    s_waitcnt lgkmcnt(11)
    v_mfma_f32_16x16x32_bf16 v[24:27], v[120:123], v[156:159], v[24:27]
    s_waitcnt lgkmcnt(10)
    v_mfma_f32_16x16x32_bf16 v[44:47], v[124:127], v[156:159], v[44:47]
    s_waitcnt lgkmcnt(9)
    v_mfma_f32_16x16x32_bf16 v[64:67], v[128:131], v[156:159], v[64:67]
    s_waitcnt lgkmcnt(8)
    v_mfma_f32_16x16x32_bf16 v[84:87], v[132:135], v[156:159], v[84:87]
    s_waitcnt lgkmcnt(6)
    v_mfma_f32_16x16x32_bf16 v[28:31], v[120:123], v[160:163], v[28:31]
    v_mfma_f32_16x16x32_bf16 v[48:51], v[124:127], v[160:163], v[48:51]
    v_mfma_f32_16x16x32_bf16 v[68:71], v[128:131], v[160:163], v[68:71]
    v_mfma_f32_16x16x32_bf16 v[88:91], v[132:135], v[160:163], v[88:91]
    s_waitcnt lgkmcnt(0)
    s_barrier
    v_mfma_f32_16x16x32_bf16 v[32:35], v[120:123], v[164:167], v[32:35]
    ds_read_b128 v[104:107], v12 offset:36864
    ds_read_b64_tr_b16 v[136:137], v14 offset:36864
    v_mfma_f32_16x16x32_bf16 v[52:55], v[124:127], v[164:167], v[52:55]
    ds_read_b64_tr_b16 v[138:139], v14 offset:38144
    v_mfma_f32_16x16x32_bf16 v[72:75], v[128:131], v[164:167], v[72:75]
    ds_read_b128 v[108:111], v12 offset:38912
    v_mfma_f32_16x16x32_bf16 v[92:95], v[132:135], v[164:167], v[92:95]
    ds_read_b128 v[112:115], v12 offset:40960
    v_mfma_f32_16x16x32_bf16 v[36:39], v[120:123], v[168:171], v[36:39]
    ds_read_b128 v[116:119], v12 offset:43008
    v_mfma_f32_16x16x32_bf16 v[56:59], v[124:127], v[168:171], v[56:59]
    ds_read_b64_tr_b16 v[140:141], v15 offset:36896
    v_mfma_f32_16x16x32_bf16 v[76:79], v[128:131], v[168:171], v[76:79]
    ds_read_b64_tr_b16 v[142:143], v15 offset:38176
    ds_read_b64_tr_b16 v[144:145], v14 offset:36928
    v_mfma_f32_16x16x32_bf16 v[96:99], v[132:135], v[168:171], v[96:99]
    ds_read_b64_tr_b16 v[146:147], v14 offset:38208
    v_mfma_f32_16x16x32_bf16 v[40:43], v[120:123], v[172:175], v[40:43]
    ds_read_b64_tr_b16 v[148:149], v15 offset:36960
    v_mfma_f32_16x16x32_bf16 v[60:63], v[124:127], v[172:175], v[60:63]
    ds_read_b64_tr_b16 v[150:151], v15 offset:38240
    v_mfma_f32_16x16x32_bf16 v[80:83], v[128:131], v[172:175], v[80:83]
    ds_read_b64_tr_b16 v[152:153], v14 offset:36992
    v_mfma_f32_16x16x32_bf16 v[100:103], v[132:135], v[172:175], v[100:103]
    ds_read_b64_tr_b16 v[154:155], v14 offset:38272
    s_waitcnt lgkmcnt(11)
    v_mfma_f32_16x16x32_bf16 v[24:27], v[104:107], v[136:139], v[24:27]
    ds_read_b128 v[120:123], v13 offset:36864
    s_waitcnt lgkmcnt(11)
    v_mfma_f32_16x16x32_bf16 v[44:47], v[108:111], v[136:139], v[44:47]
    ds_read_b64_tr_b16 v[156:157], v14 offset:47104
    s_waitcnt lgkmcnt(11)
    v_mfma_f32_16x16x32_bf16 v[64:67], v[112:115], v[136:139], v[64:67]
    ds_read_b64_tr_b16 v[158:159], v14 offset:48384
    s_waitcnt lgkmcnt(11)
    v_mfma_f32_16x16x32_bf16 v[84:87], v[116:119], v[136:139], v[84:87]
    s_waitcnt lgkmcnt(9)
    v_mfma_f32_16x16x32_bf16 v[28:31], v[104:107], v[140:143], v[28:31]
    ds_read_b128 v[124:127], v13 offset:38912
    v_mfma_f32_16x16x32_bf16 v[48:51], v[108:111], v[140:143], v[48:51]
    ds_read_b128 v[128:131], v13 offset:40960
    v_mfma_f32_16x16x32_bf16 v[68:71], v[112:115], v[140:143], v[68:71]
    v_mfma_f32_16x16x32_bf16 v[88:91], v[116:119], v[140:143], v[88:91]
    ds_read_b128 v[132:135], v13 offset:43008
    s_waitcnt lgkmcnt(10)
    v_mfma_f32_16x16x32_bf16 v[32:35], v[104:107], v[144:147], v[32:35]
    ds_read_b64_tr_b16 v[160:161], v15 offset:47136
    v_mfma_f32_16x16x32_bf16 v[52:55], v[108:111], v[144:147], v[52:55]
    v_mfma_f32_16x16x32_bf16 v[72:75], v[112:115], v[144:147], v[72:75]
    ds_read_b64_tr_b16 v[162:163], v15 offset:48416
    v_mfma_f32_16x16x32_bf16 v[92:95], v[116:119], v[144:147], v[92:95]
    ds_read_b64_tr_b16 v[164:165], v14 offset:47168
    s_waitcnt lgkmcnt(11)
    v_mfma_f32_16x16x32_bf16 v[36:39], v[104:107], v[148:151], v[36:39]
    ds_read_b64_tr_b16 v[166:167], v14 offset:48448
    v_mfma_f32_16x16x32_bf16 v[56:59], v[108:111], v[148:151], v[56:59]
    v_mfma_f32_16x16x32_bf16 v[76:79], v[112:115], v[148:151], v[76:79]
    ds_read_b64_tr_b16 v[168:169], v15 offset:47200
    v_mfma_f32_16x16x32_bf16 v[96:99], v[116:119], v[148:151], v[96:99]
    ds_read_b64_tr_b16 v[170:171], v15 offset:48480
    s_waitcnt lgkmcnt(12)
    v_mfma_f32_16x16x32_bf16 v[40:43], v[104:107], v[152:155], v[40:43]
    v_mfma_f32_16x16x32_bf16 v[60:63], v[108:111], v[152:155], v[60:63]
    ds_read_b64_tr_b16 v[172:173], v14 offset:47232
    v_mfma_f32_16x16x32_bf16 v[80:83], v[112:115], v[152:155], v[80:83]
    ds_read_b64_tr_b16 v[174:175], v14 offset:48512
    v_mfma_f32_16x16x32_bf16 v[100:103], v[116:119], v[152:155], v[100:103]
    s_waitcnt lgkmcnt(11)
    v_mfma_f32_16x16x32_bf16 v[24:27], v[120:123], v[156:159], v[24:27]
    s_waitcnt lgkmcnt(10)
    v_mfma_f32_16x16x32_bf16 v[44:47], v[124:127], v[156:159], v[44:47]
    s_waitcnt lgkmcnt(9)
    v_mfma_f32_16x16x32_bf16 v[64:67], v[128:131], v[156:159], v[64:67]
    s_waitcnt lgkmcnt(8)
    v_mfma_f32_16x16x32_bf16 v[84:87], v[132:135], v[156:159], v[84:87]
    s_waitcnt lgkmcnt(6)
    v_mfma_f32_16x16x32_bf16 v[28:31], v[120:123], v[160:163], v[28:31]
    v_mfma_f32_16x16x32_bf16 v[48:51], v[124:127], v[160:163], v[48:51]
    v_mfma_f32_16x16x32_bf16 v[68:71], v[128:131], v[160:163], v[68:71]
    v_mfma_f32_16x16x32_bf16 v[88:91], v[132:135], v[160:163], v[88:91]
    s_waitcnt lgkmcnt(0)
    s_barrier
    v_mfma_f32_16x16x32_bf16 v[32:35], v[120:123], v[164:167], v[32:35]
    ds_read_b128 v[104:107], v16 offset:0
    ds_read_b64_tr_b16 v[136:137], v18 offset:0
    v_mfma_f32_16x16x32_bf16 v[52:55], v[124:127], v[164:167], v[52:55]
    ds_read_b64_tr_b16 v[138:139], v18 offset:1280
    v_mfma_f32_16x16x32_bf16 v[72:75], v[128:131], v[164:167], v[72:75]
    ds_read_b128 v[108:111], v16 offset:2048
    v_mfma_f32_16x16x32_bf16 v[92:95], v[132:135], v[164:167], v[92:95]
    ds_read_b128 v[112:115], v16 offset:4096
    v_mfma_f32_16x16x32_bf16 v[36:39], v[120:123], v[168:171], v[36:39]
    ds_read_b128 v[116:119], v16 offset:6144
    v_mfma_f32_16x16x32_bf16 v[56:59], v[124:127], v[168:171], v[56:59]
    ds_read_b64_tr_b16 v[140:141], v19 offset:32
    v_mfma_f32_16x16x32_bf16 v[76:79], v[128:131], v[168:171], v[76:79]
    ds_read_b64_tr_b16 v[142:143], v19 offset:1312
    ds_read_b64_tr_b16 v[144:145], v18 offset:64
    v_mfma_f32_16x16x32_bf16 v[96:99], v[132:135], v[168:171], v[96:99]
    ds_read_b64_tr_b16 v[146:147], v18 offset:1344
    v_mfma_f32_16x16x32_bf16 v[40:43], v[120:123], v[172:175], v[40:43]
    ds_read_b64_tr_b16 v[148:149], v19 offset:96
    v_mfma_f32_16x16x32_bf16 v[60:63], v[124:127], v[172:175], v[60:63]
    ds_read_b64_tr_b16 v[150:151], v19 offset:1376
    v_mfma_f32_16x16x32_bf16 v[80:83], v[128:131], v[172:175], v[80:83]
    ds_read_b64_tr_b16 v[152:153], v18 offset:128
    v_mfma_f32_16x16x32_bf16 v[100:103], v[132:135], v[172:175], v[100:103]
    ds_read_b64_tr_b16 v[154:155], v18 offset:1408
    s_waitcnt lgkmcnt(11)
    v_mfma_f32_16x16x32_bf16 v[24:27], v[104:107], v[136:139], v[24:27]
    ds_read_b128 v[120:123], v17 offset:0
    s_waitcnt lgkmcnt(11)
    v_mfma_f32_16x16x32_bf16 v[44:47], v[108:111], v[136:139], v[44:47]
    ds_read_b64_tr_b16 v[156:157], v18 offset:10240
    s_waitcnt lgkmcnt(11)
    v_mfma_f32_16x16x32_bf16 v[64:67], v[112:115], v[136:139], v[64:67]
    ds_read_b64_tr_b16 v[158:159], v18 offset:11520
    s_waitcnt lgkmcnt(11)
    v_mfma_f32_16x16x32_bf16 v[84:87], v[116:119], v[136:139], v[84:87]
    s_waitcnt lgkmcnt(9)
    v_mfma_f32_16x16x32_bf16 v[28:31], v[104:107], v[140:143], v[28:31]
    ds_read_b128 v[124:127], v17 offset:2048
    v_mfma_f32_16x16x32_bf16 v[48:51], v[108:111], v[140:143], v[48:51]
    ds_read_b128 v[128:131], v17 offset:4096
    v_mfma_f32_16x16x32_bf16 v[68:71], v[112:115], v[140:143], v[68:71]
    v_mfma_f32_16x16x32_bf16 v[88:91], v[116:119], v[140:143], v[88:91]
    ds_read_b128 v[132:135], v17 offset:6144
    s_waitcnt lgkmcnt(10)
    v_mfma_f32_16x16x32_bf16 v[32:35], v[104:107], v[144:147], v[32:35]
    ds_read_b64_tr_b16 v[160:161], v19 offset:10272
    v_mfma_f32_16x16x32_bf16 v[52:55], v[108:111], v[144:147], v[52:55]
    v_mfma_f32_16x16x32_bf16 v[72:75], v[112:115], v[144:147], v[72:75]
    ds_read_b64_tr_b16 v[162:163], v19 offset:11552
    v_mfma_f32_16x16x32_bf16 v[92:95], v[116:119], v[144:147], v[92:95]
    ds_read_b64_tr_b16 v[164:165], v18 offset:10304
    s_waitcnt lgkmcnt(11)
    v_mfma_f32_16x16x32_bf16 v[36:39], v[104:107], v[148:151], v[36:39]
    ds_read_b64_tr_b16 v[166:167], v18 offset:11584
    v_mfma_f32_16x16x32_bf16 v[56:59], v[108:111], v[148:151], v[56:59]
    v_mfma_f32_16x16x32_bf16 v[76:79], v[112:115], v[148:151], v[76:79]
    ds_read_b64_tr_b16 v[168:169], v19 offset:10336
    v_mfma_f32_16x16x32_bf16 v[96:99], v[116:119], v[148:151], v[96:99]
    ds_read_b64_tr_b16 v[170:171], v19 offset:11616
    s_waitcnt lgkmcnt(12)
    v_mfma_f32_16x16x32_bf16 v[40:43], v[104:107], v[152:155], v[40:43]
    v_mfma_f32_16x16x32_bf16 v[60:63], v[108:111], v[152:155], v[60:63]
    ds_read_b64_tr_b16 v[172:173], v18 offset:10368
    v_mfma_f32_16x16x32_bf16 v[80:83], v[112:115], v[152:155], v[80:83]
    ds_read_b64_tr_b16 v[174:175], v18 offset:11648
    v_mfma_f32_16x16x32_bf16 v[100:103], v[116:119], v[152:155], v[100:103]
    s_waitcnt lgkmcnt(11)
    v_mfma_f32_16x16x32_bf16 v[24:27], v[120:123], v[156:159], v[24:27]
    s_waitcnt lgkmcnt(10)
    v_mfma_f32_16x16x32_bf16 v[44:47], v[124:127], v[156:159], v[44:47]
    s_waitcnt lgkmcnt(9)
    v_mfma_f32_16x16x32_bf16 v[64:67], v[128:131], v[156:159], v[64:67]
    s_waitcnt lgkmcnt(8)
    v_mfma_f32_16x16x32_bf16 v[84:87], v[132:135], v[156:159], v[84:87]
    s_waitcnt lgkmcnt(6)
    v_mfma_f32_16x16x32_bf16 v[28:31], v[120:123], v[160:163], v[28:31]
    v_mfma_f32_16x16x32_bf16 v[48:51], v[124:127], v[160:163], v[48:51]
    v_mfma_f32_16x16x32_bf16 v[68:71], v[128:131], v[160:163], v[68:71]
    v_mfma_f32_16x16x32_bf16 v[88:91], v[132:135], v[160:163], v[88:91]
    s_waitcnt lgkmcnt(0)
    s_cmp_eq_u32 s3, 1
    s_cbranch_scc0 Lw1_13
    s_waitcnt vmcnt(0)
Lw1_13:
    s_barrier
    v_mfma_f32_16x16x32_bf16 v[32:35], v[120:123], v[164:167], v[32:35]
    ds_read_b128 v[104:107], v12 offset:0
    ds_read_b64_tr_b16 v[136:137], v14 offset:0
    v_mfma_f32_16x16x32_bf16 v[52:55], v[124:127], v[164:167], v[52:55]
    ds_read_b64_tr_b16 v[138:139], v14 offset:1280
    v_mfma_f32_16x16x32_bf16 v[72:75], v[128:131], v[164:167], v[72:75]
    ds_read_b128 v[108:111], v12 offset:2048
    v_mfma_f32_16x16x32_bf16 v[92:95], v[132:135], v[164:167], v[92:95]
    ds_read_b128 v[112:115], v12 offset:4096
    v_mfma_f32_16x16x32_bf16 v[36:39], v[120:123], v[168:171], v[36:39]
    ds_read_b128 v[116:119], v12 offset:6144
    v_mfma_f32_16x16x32_bf16 v[56:59], v[124:127], v[168:171], v[56:59]
    ds_read_b64_tr_b16 v[140:141], v15 offset:32
    v_mfma_f32_16x16x32_bf16 v[76:79], v[128:131], v[168:171], v[76:79]
    ds_read_b64_tr_b16 v[142:143], v15 offset:1312
    ds_read_b64_tr_b16 v[144:145], v14 offset:64
    v_mfma_f32_16x16x32_bf16 v[96:99], v[132:135], v[168:171], v[96:99]
    ds_read_b64_tr_b16 v[146:147], v14 offset:1344
    v_mfma_f32_16x16x32_bf16 v[40:43], v[120:123], v[172:175], v[40:43]
    ds_read_b64_tr_b16 v[148:149], v15 offset:96
    v_mfma_f32_16x16x32_bf16 v[60:63], v[124:127], v[172:175], v[60:63]
    ds_read_b64_tr_b16 v[150:151], v15 offset:1376
    v_mfma_f32_16x16x32_bf16 v[80:83], v[128:131], v[172:175], v[80:83]
    ds_read_b64_tr_b16 v[152:153], v14 offset:128
    v_mfma_f32_16x16x32_bf16 v[100:103], v[132:135], v[172:175], v[100:103]
    ds_read_b64_tr_b16 v[154:155], v14 offset:1408
    s_waitcnt lgkmcnt(11)
    v_mfma_f32_16x16x32_bf16 v[24:27], v[104:107], v[136:139], v[24:27]
    ds_read_b128 v[120:123], v13 offset:0
    s_waitcnt lgkmcnt(11)
    v_mfma_f32_16x16x32_bf16 v[44:47], v[108:111], v[136:139], v[44:47]
    ds_read_b64_tr_b16 v[156:157], v14 offset:10240
    s_waitcnt lgkmcnt(11)
    v_mfma_f32_16x16x32_bf16 v[64:67], v[112:115], v[136:139], v[64:67]
    ds_read_b64_tr_b16 v[158:159], v14 offset:11520
    s_waitcnt lgkmcnt(11)
    v_mfma_f32_16x16x32_bf16 v[84:87], v[116:119], v[136:139], v[84:87]
    s_waitcnt lgkmcnt(9)
    v_mfma_f32_16x16x32_bf16 v[28:31], v[104:107], v[140:143], v[28:31]
    ds_read_b128 v[124:127], v13 offset:2048
    v_mfma_f32_16x16x32_bf16 v[48:51], v[108:111], v[140:143], v[48:51]
    ds_read_b128 v[128:131], v13 offset:4096
    v_mfma_f32_16x16x32_bf16 v[68:71], v[112:115], v[140:143], v[68:71]
    v_mfma_f32_16x16x32_bf16 v[88:91], v[116:119], v[140:143], v[88:91]
    ds_read_b128 v[132:135], v13 offset:6144
    s_waitcnt lgkmcnt(10)
    v_mfma_f32_16x16x32_bf16 v[32:35], v[104:107], v[144:147], v[32:35]
    ds_read_b64_tr_b16 v[160:161], v15 offset:10272
    v_mfma_f32_16x16x32_bf16 v[52:55], v[108:111], v[144:147], v[52:55]
    v_mfma_f32_16x16x32_bf16 v[72:75], v[112:115], v[144:147], v[72:75]
    ds_read_b64_tr_b16 v[162:163], v15 offset:11552
    v_mfma_f32_16x16x32_bf16 v[92:95], v[116:119], v[144:147], v[92:95]
    ds_read_b64_tr_b16 v[164:165], v14 offset:10304
    s_waitcnt lgkmcnt(11)
    v_mfma_f32_16x16x32_bf16 v[36:39], v[104:107], v[148:151], v[36:39]
    ds_read_b64_tr_b16 v[166:167], v14 offset:11584
    v_mfma_f32_16x16x32_bf16 v[56:59], v[108:111], v[148:151], v[56:59]
    v_mfma_f32_16x16x32_bf16 v[76:79], v[112:115], v[148:151], v[76:79]
    ds_read_b64_tr_b16 v[168:169], v15 offset:10336
    v_mfma_f32_16x16x32_bf16 v[96:99], v[116:119], v[148:151], v[96:99]
    ds_read_b64_tr_b16 v[170:171], v15 offset:11616
    s_waitcnt lgkmcnt(12)
    v_mfma_f32_16x16x32_bf16 v[40:43], v[104:107], v[152:155], v[40:43]
    v_mfma_f32_16x16x32_bf16 v[60:63], v[108:111], v[152:155], v[60:63]
    ds_read_b64_tr_b16 v[172:173], v14 offset:10368
    v_mfma_f32_16x16x32_bf16 v[80:83], v[112:115], v[152:155], v[80:83]
    ds_read_b64_tr_b16 v[174:175], v14 offset:11648
    v_mfma_f32_16x16x32_bf16 v[100:103], v[116:119], v[152:155], v[100:103]
    s_waitcnt lgkmcnt(11)
    v_mfma_f32_16x16x32_bf16 v[24:27], v[120:123], v[156:159], v[24:27]
    s_waitcnt lgkmcnt(10)
    v_mfma_f32_16x16x32_bf16 v[44:47], v[124:127], v[156:159], v[44:47]
    s_waitcnt lgkmcnt(9)
    v_mfma_f32_16x16x32_bf16 v[64:67], v[128:131], v[156:159], v[64:67]
    s_waitcnt lgkmcnt(8)
    v_mfma_f32_16x16x32_bf16 v[84:87], v[132:135], v[156:159], v[84:87]
    s_waitcnt lgkmcnt(6)
    v_mfma_f32_16x16x32_bf16 v[28:31], v[120:123], v[160:163], v[28:31]
    v_mfma_f32_16x16x32_bf16 v[48:51], v[124:127], v[160:163], v[48:51]
    v_mfma_f32_16x16x32_bf16 v[68:71], v[128:131], v[160:163], v[68:71]
    v_mfma_f32_16x16x32_bf16 v[88:91], v[132:135], v[160:163], v[88:91]
    s_waitcnt lgkmcnt(0)
    s_cmp_eq_u32 s3, 0
    s_cbranch_scc0 Lwf_14
    s_waitcnt vmcnt(0)
    v_cmp_eq_u32 vcc, 0, v253
    s_cbranch_vccz Lwn_15
    s_mov_b32 s81, 100000
Lspin_16:
    buffer_load_dword v253, off, s[56:59], 0 sc1
    s_waitcnt vmcnt(0)
    v_cmp_eq_u32 vcc, 0, v253
    s_cbranch_vccz Lspun_17
    s_sleep 8
    s_sub_u32 s81, s81, 1
    s_cbranch_scc0 Lspin_16
Lspun_17:
Lwn_15:
    s_lshl_b32 s72, s2, 7
    s_add_u32 s72, s72, 3964928
    s_mov_b64 exec, 1
    buffer_store_dword v253, off, s[60:63], s72 sc1
    s_mov_b64 exec, -1
Lwf_14:
    buffer_load_dword v253, off, s[56:59], 0 sc1
    s_barrier
    v_mfma_f32_16x16x32_bf16 v[32:35], v[120:123], v[164:167], v[32:35]
    ds_read_b128 v[104:107], v12 offset:36864
    ds_read_b64_tr_b16 v[136:137], v14 offset:36864
    v_mfma_f32_16x16x32_bf16 v[52:55], v[124:127], v[164:167], v[52:55]
    ds_read_b64_tr_b16 v[138:139], v14 offset:38144
    v_mfma_f32_16x16x32_bf16 v[72:75], v[128:131], v[164:167], v[72:75]
    ds_read_b128 v[108:111], v12 offset:38912
    v_mfma_f32_16x16x32_bf16 v[92:95], v[132:135], v[164:167], v[92:95]
    ds_read_b128 v[112:115], v12 offset:40960
    v_mfma_f32_16x16x32_bf16 v[36:39], v[120:123], v[168:171], v[36:39]
    ds_read_b128 v[116:119], v12 offset:43008
    v_mfma_f32_16x16x32_bf16 v[56:59], v[124:127], v[168:171], v[56:59]
    ds_read_b64_tr_b16 v[140:141], v15 offset:36896
    v_mfma_f32_16x16x32_bf16 v[76:79], v[128:131], v[168:171], v[76:79]
    ds_read_b64_tr_b16 v[142:143], v15 offset:38176
    ds_read_b64_tr_b16 v[144:145], v14 offset:36928
    v_mfma_f32_16x16x32_bf16 v[96:99], v[132:135], v[168:171], v[96:99]
    ds_read_b64_tr_b16 v[146:147], v14 offset:38208
    v_mfma_f32_16x16x32_bf16 v[40:43], v[120:123], v[172:175], v[40:43]
    ds_read_b64_tr_b16 v[148:149], v15 offset:36960
    v_mfma_f32_16x16x32_bf16 v[60:63], v[124:127], v[172:175], v[60:63]
    ds_read_b64_tr_b16 v[150:151], v15 offset:38240
    v_mfma_f32_16x16x32_bf16 v[80:83], v[128:131], v[172:175], v[80:83]
    ds_read_b64_tr_b16 v[152:153], v14 offset:36992
    v_mfma_f32_16x16x32_bf16 v[100:103], v[132:135], v[172:175], v[100:103]
    ds_read_b64_tr_b16 v[154:155], v14 offset:38272
    s_waitcnt lgkmcnt(11)
    v_mfma_f32_16x16x32_bf16 v[24:27], v[104:107], v[136:139], v[24:27]
    ds_read_b128 v[120:123], v13 offset:36864
    s_waitcnt lgkmcnt(11)
    v_mfma_f32_16x16x32_bf16 v[44:47], v[108:111], v[136:139], v[44:47]
    ds_read_b64_tr_b16 v[156:157], v14 offset:47104
    s_waitcnt lgkmcnt(11)
    v_mfma_f32_16x16x32_bf16 v[64:67], v[112:115], v[136:139], v[64:67]
    ds_read_b64_tr_b16 v[158:159], v14 offset:48384
    s_waitcnt lgkmcnt(11)
    v_mfma_f32_16x16x32_bf16 v[84:87], v[116:119], v[136:139], v[84:87]
    s_waitcnt lgkmcnt(9)
    v_mfma_f32_16x16x32_bf16 v[28:31], v[104:107], v[140:143], v[28:31]
    ds_read_b128 v[124:127], v13 offset:38912
    v_mfma_f32_16x16x32_bf16 v[48:51], v[108:111], v[140:143], v[48:51]
    ds_read_b128 v[128:131], v13 offset:40960
    v_mfma_f32_16x16x32_bf16 v[68:71], v[112:115], v[140:143], v[68:71]
    v_mfma_f32_16x16x32_bf16 v[88:91], v[116:119], v[140:143], v[88:91]
    ds_read_b128 v[132:135], v13 offset:43008
    s_waitcnt lgkmcnt(10)
    v_mfma_f32_16x16x32_bf16 v[32:35], v[104:107], v[144:147], v[32:35]
    ds_read_b64_tr_b16 v[160:161], v15 offset:47136
    v_mfma_f32_16x16x32_bf16 v[52:55], v[108:111], v[144:147], v[52:55]
    v_mfma_f32_16x16x32_bf16 v[72:75], v[112:115], v[144:147], v[72:75]
    ds_read_b64_tr_b16 v[162:163], v15 offset:48416
    v_mfma_f32_16x16x32_bf16 v[92:95], v[116:119], v[144:147], v[92:95]
    ds_read_b64_tr_b16 v[164:165], v14 offset:47168
    s_waitcnt lgkmcnt(11)
    v_mfma_f32_16x16x32_bf16 v[36:39], v[104:107], v[148:151], v[36:39]
    ds_read_b64_tr_b16 v[166:167], v14 offset:48448
    v_mfma_f32_16x16x32_bf16 v[56:59], v[108:111], v[148:151], v[56:59]
    v_mfma_f32_16x16x32_bf16 v[76:79], v[112:115], v[148:151], v[76:79]
    ds_read_b64_tr_b16 v[168:169], v15 offset:47200
    v_mfma_f32_16x16x32_bf16 v[96:99], v[116:119], v[148:151], v[96:99]
    ds_read_b64_tr_b16 v[170:171], v15 offset:48480
    s_waitcnt lgkmcnt(12)
    v_mfma_f32_16x16x32_bf16 v[40:43], v[104:107], v[152:155], v[40:43]
    v_mfma_f32_16x16x32_bf16 v[60:63], v[108:111], v[152:155], v[60:63]
    ds_read_b64_tr_b16 v[172:173], v14 offset:47232
    v_mfma_f32_16x16x32_bf16 v[80:83], v[112:115], v[152:155], v[80:83]
    ds_read_b64_tr_b16 v[174:175], v14 offset:48512
    v_mfma_f32_16x16x32_bf16 v[100:103], v[116:119], v[152:155], v[100:103]
    s_waitcnt lgkmcnt(11)
    v_mfma_f32_16x16x32_bf16 v[24:27], v[120:123], v[156:159], v[24:27]
    s_waitcnt lgkmcnt(10)
    v_mfma_f32_16x16x32_bf16 v[44:47], v[124:127], v[156:159], v[44:47]
    s_waitcnt lgkmcnt(9)
    v_mfma_f32_16x16x32_bf16 v[64:67], v[128:131], v[156:159], v[64:67]
    s_waitcnt lgkmcnt(8)
    v_mfma_f32_16x16x32_bf16 v[84:87], v[132:135], v[156:159], v[84:87]
    s_waitcnt lgkmcnt(6)
    v_mfma_f32_16x16x32_bf16 v[28:31], v[120:123], v[160:163], v[28:31]
    v_mfma_f32_16x16x32_bf16 v[48:51], v[124:127], v[160:163], v[48:51]
    v_mfma_f32_16x16x32_bf16 v[68:71], v[128:131], v[160:163], v[68:71]
    v_mfma_f32_16x16x32_bf16 v[88:91], v[132:135], v[160:163], v[88:91]
    s_waitcnt lgkmcnt(0)
    s_barrier
    v_mfma_f32_16x16x32_bf16 v[32:35], v[120:123], v[164:167], v[32:35]
    ds_read_b128 v[104:107], v16 offset:0
    ds_read_b64_tr_b16 v[136:137], v18 offset:0
    v_mfma_f32_16x16x32_bf16 v[52:55], v[124:127], v[164:167], v[52:55]
    ds_read_b64_tr_b16 v[138:139], v18 offset:1280
    v_mfma_f32_16x16x32_bf16 v[72:75], v[128:131], v[164:167], v[72:75]
    ds_read_b128 v[108:111], v16 offset:2048
    v_mfma_f32_16x16x32_bf16 v[92:95], v[132:135], v[164:167], v[92:95]
    ds_read_b128 v[112:115], v16 offset:4096
    v_mfma_f32_16x16x32_bf16 v[36:39], v[120:123], v[168:171], v[36:39]
    ds_read_b128 v[116:119], v16 offset:6144
    v_mfma_f32_16x16x32_bf16 v[56:59], v[124:127], v[168:171], v[56:59]
    ds_read_b64_tr_b16 v[140:141], v19 offset:32
    v_mfma_f32_16x16x32_bf16 v[76:79], v[128:131], v[168:171], v[76:79]
    ds_read_b64_tr_b16 v[142:143], v19 offset:1312
    ds_read_b64_tr_b16 v[144:145], v18 offset:64
    v_mfma_f32_16x16x32_bf16 v[96:99], v[132:135], v[168:171], v[96:99]
    ds_read_b64_tr_b16 v[146:147], v18 offset:1344
    v_mfma_f32_16x16x32_bf16 v[40:43], v[120:123], v[172:175], v[40:43]
    ds_read_b64_tr_b16 v[148:149], v19 offset:96
    v_mfma_f32_16x16x32_bf16 v[60:63], v[124:127], v[172:175], v[60:63]
    ds_read_b64_tr_b16 v[150:151], v19 offset:1376
    v_mfma_f32_16x16x32_bf16 v[80:83], v[128:131], v[172:175], v[80:83]
    ds_read_b64_tr_b16 v[152:153], v18 offset:128
    v_mfma_f32_16x16x32_bf16 v[100:103], v[132:135], v[172:175], v[100:103]
    ds_read_b64_tr_b16 v[154:155], v18 offset:1408
    s_waitcnt lgkmcnt(11)
    v_mfma_f32_16x16x32_bf16 v[24:27], v[104:107], v[136:139], v[24:27]
    ds_read_b128 v[120:123], v17 offset:0
    s_waitcnt lgkmcnt(11)
    v_mfma_f32_16x16x32_bf16 v[44:47], v[108:111], v[136:139], v[44:47]
    ds_read_b64_tr_b16 v[156:157], v18 offset:10240
    s_waitcnt lgkmcnt(11)
    v_mfma_f32_16x16x32_bf16 v[64:67], v[112:115], v[136:139], v[64:67]
    ds_read_b64_tr_b16 v[158:159], v18 offset:11520
    s_waitcnt lgkmcnt(11)
    v_mfma_f32_16x16x32_bf16 v[84:87], v[116:119], v[136:139], v[84:87]
    s_waitcnt lgkmcnt(9)
    v_mfma_f32_16x16x32_bf16 v[28:31], v[104:107], v[140:143], v[28:31]
    ds_read_b128 v[124:127], v17 offset:2048
    v_mfma_f32_16x16x32_bf16 v[48:51], v[108:111], v[140:143], v[48:51]
    ds_read_b128 v[128:131], v17 offset:4096
    v_mfma_f32_16x16x32_bf16 v[68:71], v[112:115], v[140:143], v[68:71]
    v_mfma_f32_16x16x32_bf16 v[88:91], v[116:119], v[140:143], v[88:91]
    ds_read_b128 v[132:135], v17 offset:6144
    s_waitcnt lgkmcnt(10)
    v_mfma_f32_16x16x32_bf16 v[32:35], v[104:107], v[144:147], v[32:35]
    ds_read_b64_tr_b16 v[160:161], v19 offset:10272
    v_mfma_f32_16x16x32_bf16 v[52:55], v[108:111], v[144:147], v[52:55]
    v_mfma_f32_16x16x32_bf16 v[72:75], v[112:115], v[144:147], v[72:75]
    ds_read_b64_tr_b16 v[162:163], v19 offset:11552
    v_mfma_f32_16x16x32_bf16 v[92:95], v[116:119], v[144:147], v[92:95]
    ds_read_b64_tr_b16 v[164:165], v18 offset:10304
    s_waitcnt lgkmcnt(11)
    v_mfma_f32_16x16x32_bf16 v[36:39], v[104:107], v[148:151], v[36:39]
    ds_read_b64_tr_b16 v[166:167], v18 offset:11584
    v_mfma_f32_16x16x32_bf16 v[56:59], v[108:111], v[148:151], v[56:59]
    v_mfma_f32_16x16x32_bf16 v[76:79], v[112:115], v[148:151], v[76:79]
    ds_read_b64_tr_b16 v[168:169], v19 offset:10336
    v_mfma_f32_16x16x32_bf16 v[96:99], v[116:119], v[148:151], v[96:99]
    ds_read_b64_tr_b16 v[170:171], v19 offset:11616
    s_waitcnt lgkmcnt(12)
    v_mfma_f32_16x16x32_bf16 v[40:43], v[104:107], v[152:155], v[40:43]
    v_mfma_f32_16x16x32_bf16 v[60:63], v[108:111], v[152:155], v[60:63]
    ds_read_b64_tr_b16 v[172:173], v18 offset:10368
    v_mfma_f32_16x16x32_bf16 v[80:83], v[112:115], v[152:155], v[80:83]
    ds_read_b64_tr_b16 v[174:175], v18 offset:11648
    v_mfma_f32_16x16x32_bf16 v[100:103], v[116:119], v[152:155], v[100:103]
    s_waitcnt lgkmcnt(11)
    v_mfma_f32_16x16x32_bf16 v[24:27], v[120:123], v[156:159], v[24:27]
    s_waitcnt lgkmcnt(10)
    v_mfma_f32_16x16x32_bf16 v[44:47], v[124:127], v[156:159], v[44:47]
    s_waitcnt lgkmcnt(9)
    v_mfma_f32_16x16x32_bf16 v[64:67], v[128:131], v[156:159], v[64:67]
    s_waitcnt lgkmcnt(8)
    v_mfma_f32_16x16x32_bf16 v[84:87], v[132:135], v[156:159], v[84:87]
    s_waitcnt lgkmcnt(6)
    v_mfma_f32_16x16x32_bf16 v[28:31], v[120:123], v[160:163], v[28:31]
    v_mfma_f32_16x16x32_bf16 v[48:51], v[124:127], v[160:163], v[48:51]
    v_mfma_f32_16x16x32_bf16 v[68:71], v[128:131], v[160:163], v[68:71]
    v_mfma_f32_16x16x32_bf16 v[88:91], v[132:135], v[160:163], v[88:91]
    s_waitcnt lgkmcnt(0)
    s_barrier
    v_mfma_f32_16x16x32_bf16 v[32:35], v[120:123], v[164:167], v[32:35]
    ds_read_b128 v[104:107], v12 offset:0
    ds_read_b64_tr_b16 v[136:137], v14 offset:0
    v_mfma_f32_16x16x32_bf16 v[52:55], v[124:127], v[164:167], v[52:55]
    ds_read_b64_tr_b16 v[138:139], v14 offset:1280
    v_mfma_f32_16x16x32_bf16 v[72:75], v[128:131], v[164:167], v[72:75]
    ds_read_b128 v[108:111], v12 offset:2048
    v_mfma_f32_16x16x32_bf16 v[92:95], v[132:135], v[164:167], v[92:95]
    ds_read_b128 v[112:115], v12 offset:4096
    v_mfma_f32_16x16x32_bf16 v[36:39], v[120:123], v[168:171], v[36:39]
    ds_read_b128 v[116:119], v12 offset:6144
    v_mfma_f32_16x16x32_bf16 v[56:59], v[124:127], v[168:171], v[56:59]
    ds_read_b64_tr_b16 v[140:141], v15 offset:32
    v_mfma_f32_16x16x32_bf16 v[76:79], v[128:131], v[168:171], v[76:79]
    ds_read_b64_tr_b16 v[142:143], v15 offset:1312
    ds_read_b64_tr_b16 v[144:145], v14 offset:64
    v_mfma_f32_16x16x32_bf16 v[96:99], v[132:135], v[168:171], v[96:99]
    ds_read_b64_tr_b16 v[146:147], v14 offset:1344
    v_mfma_f32_16x16x32_bf16 v[40:43], v[120:123], v[172:175], v[40:43]
    ds_read_b64_tr_b16 v[148:149], v15 offset:96
    v_mfma_f32_16x16x32_bf16 v[60:63], v[124:127], v[172:175], v[60:63]
    ds_read_b64_tr_b16 v[150:151], v15 offset:1376
    v_mfma_f32_16x16x32_bf16 v[80:83], v[128:131], v[172:175], v[80:83]
    ds_read_b64_tr_b16 v[152:153], v14 offset:128
    v_mfma_f32_16x16x32_bf16 v[100:103], v[132:135], v[172:175], v[100:103]
    ds_read_b64_tr_b16 v[154:155], v14 offset:1408
    s_waitcnt lgkmcnt(11)
    v_mfma_f32_16x16x32_bf16 v[24:27], v[104:107], v[136:139], v[24:27]
    ds_read_b128 v[120:123], v13 offset:0
    s_waitcnt lgkmcnt(11)
    v_mfma_f32_16x16x32_bf16 v[44:47], v[108:111], v[136:139], v[44:47]
    ds_read_b64_tr_b16 v[156:157], v14 offset:10240
    s_waitcnt lgkmcnt(11)
    v_mfma_f32_16x16x32_bf16 v[64:67], v[112:115], v[136:139], v[64:67]
    ds_read_b64_tr_b16 v[158:159], v14 offset:11520
    s_waitcnt lgkmcnt(11)
    v_mfma_f32_16x16x32_bf16 v[84:87], v[116:119], v[136:139], v[84:87]
    s_waitcnt lgkmcnt(9)
    v_mfma_f32_16x16x32_bf16 v[28:31], v[104:107], v[140:143], v[28:31]
    ds_read_b128 v[124:127], v13 offset:2048
    v_mfma_f32_16x16x32_bf16 v[48:51], v[108:111], v[140:143], v[48:51]
    ds_read_b128 v[128:131], v13 offset:4096
    v_mfma_f32_16x16x32_bf16 v[68:71], v[112:115], v[140:143], v[68:71]
    v_mfma_f32_16x16x32_bf16 v[88:91], v[116:119], v[140:143], v[88:91]
    ds_read_b128 v[132:135], v13 offset:6144
    s_waitcnt lgkmcnt(10)
    v_mfma_f32_16x16x32_bf16 v[32:35], v[104:107], v[144:147], v[32:35]
    ds_read_b64_tr_b16 v[160:161], v15 offset:10272
    v_mfma_f32_16x16x32_bf16 v[52:55], v[108:111], v[144:147], v[52:55]
    v_mfma_f32_16x16x32_bf16 v[72:75], v[112:115], v[144:147], v[72:75]
    ds_read_b64_tr_b16 v[162:163], v15 offset:11552
    v_mfma_f32_16x16x32_bf16 v[92:95], v[116:119], v[144:147], v[92:95]
    ds_read_b64_tr_b16 v[164:165], v14 offset:10304
    s_waitcnt lgkmcnt(11)
    v_mfma_f32_16x16x32_bf16 v[36:39], v[104:107], v[148:151], v[36:39]
    ds_read_b64_tr_b16 v[166:167], v14 offset:11584
    v_mfma_f32_16x16x32_bf16 v[56:59], v[108:111], v[148:151], v[56:59]
    v_mfma_f32_16x16x32_bf16 v[76:79], v[112:115], v[148:151], v[76:79]
    ds_read_b64_tr_b16 v[168:169], v15 offset:10336
    v_mfma_f32_16x16x32_bf16 v[96:99], v[116:119], v[148:151], v[96:99]
    ds_read_b64_tr_b16 v[170:171], v15 offset:11616
    s_waitcnt lgkmcnt(12)
    v_mfma_f32_16x16x32_bf16 v[40:43], v[104:107], v[152:155], v[40:43]
    v_mfma_f32_16x16x32_bf16 v[60:63], v[108:111], v[152:155], v[60:63]
    ds_read_b64_tr_b16 v[172:173], v14 offset:10368
    v_mfma_f32_16x16x32_bf16 v[80:83], v[112:115], v[152:155], v[80:83]
    ds_read_b64_tr_b16 v[174:175], v14 offset:11648
    v_mfma_f32_16x16x32_bf16 v[100:103], v[116:119], v[152:155], v[100:103]
    s_waitcnt lgkmcnt(11)
    v_mfma_f32_16x16x32_bf16 v[24:27], v[120:123], v[156:159], v[24:27]
    s_waitcnt lgkmcnt(10)
    v_mfma_f32_16x16x32_bf16 v[44:47], v[124:127], v[156:159], v[44:47]
    s_waitcnt lgkmcnt(9)
    v_mfma_f32_16x16x32_bf16 v[64:67], v[128:131], v[156:159], v[64:67]
    s_waitcnt lgkmcnt(8)
    v_mfma_f32_16x16x32_bf16 v[84:87], v[132:135], v[156:159], v[84:87]
    s_waitcnt lgkmcnt(6)
    v_mfma_f32_16x16x32_bf16 v[28:31], v[120:123], v[160:163], v[28:31]
    v_mfma_f32_16x16x32_bf16 v[48:51], v[124:127], v[160:163], v[48:51]
    v_mfma_f32_16x16x32_bf16 v[68:71], v[128:131], v[160:163], v[68:71]
    v_mfma_f32_16x16x32_bf16 v[88:91], v[132:135], v[160:163], v[88:91]
    s_waitcnt lgkmcnt(0)
    s_barrier
    v_mfma_f32_16x16x32_bf16 v[32:35], v[120:123], v[164:167], v[32:35]
    ds_read_b128 v[104:107], v12 offset:36864
    ds_read_b64_tr_b16 v[136:137], v14 offset:36864
    v_mfma_f32_16x16x32_bf16 v[52:55], v[124:127], v[164:167], v[52:55]
    ds_read_b64_tr_b16 v[138:139], v14 offset:38144
    v_mfma_f32_16x16x32_bf16 v[72:75], v[128:131], v[164:167], v[72:75]
    ds_read_b128 v[108:111], v12 offset:38912
    v_mfma_f32_16x16x32_bf16 v[92:95], v[132:135], v[164:167], v[92:95]
    ds_read_b128 v[112:115], v12 offset:40960
    v_mfma_f32_16x16x32_bf16 v[36:39], v[120:123], v[168:171], v[36:39]
    ds_read_b128 v[116:119], v12 offset:43008
    v_mfma_f32_16x16x32_bf16 v[56:59], v[124:127], v[168:171], v[56:59]
    ds_read_b64_tr_b16 v[140:141], v15 offset:36896
    v_mfma_f32_16x16x32_bf16 v[76:79], v[128:131], v[168:171], v[76:79]
    ds_read_b64_tr_b16 v[142:143], v15 offset:38176
    ds_read_b64_tr_b16 v[144:145], v14 offset:36928
    v_mfma_f32_16x16x32_bf16 v[96:99], v[132:135], v[168:171], v[96:99]
    ds_read_b64_tr_b16 v[146:147], v14 offset:38208
    v_mfma_f32_16x16x32_bf16 v[40:43], v[120:123], v[172:175], v[40:43]
    ds_read_b64_tr_b16 v[148:149], v15 offset:36960
    v_mfma_f32_16x16x32_bf16 v[60:63], v[124:127], v[172:175], v[60:63]
    ds_read_b64_tr_b16 v[150:151], v15 offset:38240
    v_mfma_f32_16x16x32_bf16 v[80:83], v[128:131], v[172:175], v[80:83]
    ds_read_b64_tr_b16 v[152:153], v14 offset:36992
    v_mfma_f32_16x16x32_bf16 v[100:103], v[132:135], v[172:175], v[100:103]
    ds_read_b64_tr_b16 v[154:155], v14 offset:38272
    s_waitcnt lgkmcnt(11)
    v_mfma_f32_16x16x32_bf16 v[24:27], v[104:107], v[136:139], v[24:27]
    ds_read_b128 v[120:123], v13 offset:36864
    s_waitcnt lgkmcnt(11)
    v_mfma_f32_16x16x32_bf16 v[44:47], v[108:111], v[136:139], v[44:47]
    ds_read_b64_tr_b16 v[156:157], v14 offset:47104
    s_waitcnt lgkmcnt(11)
    v_mfma_f32_16x16x32_bf16 v[64:67], v[112:115], v[136:139], v[64:67]
    ds_read_b64_tr_b16 v[158:159], v14 offset:48384
    s_waitcnt lgkmcnt(11)
    v_mfma_f32_16x16x32_bf16 v[84:87], v[116:119], v[136:139], v[84:87]
    s_waitcnt lgkmcnt(9)
    v_mfma_f32_16x16x32_bf16 v[28:31], v[104:107], v[140:143], v[28:31]
    ds_read_b128 v[124:127], v13 offset:38912
    v_mfma_f32_16x16x32_bf16 v[48:51], v[108:111], v[140:143], v[48:51]
    ds_read_b128 v[128:131], v13 offset:40960
    v_mfma_f32_16x16x32_bf16 v[68:71], v[112:115], v[140:143], v[68:71]
    v_mfma_f32_16x16x32_bf16 v[88:91], v[116:119], v[140:143], v[88:91]
    ds_read_b128 v[132:135], v13 offset:43008
    s_waitcnt lgkmcnt(10)
    v_mfma_f32_16x16x32_bf16 v[32:35], v[104:107], v[144:147], v[32:35]
    ds_read_b64_tr_b16 v[160:161], v15 offset:47136
    v_mfma_f32_16x16x32_bf16 v[52:55], v[108:111], v[144:147], v[52:55]
    v_mfma_f32_16x16x32_bf16 v[72:75], v[112:115], v[144:147], v[72:75]
    ds_read_b64_tr_b16 v[162:163], v15 offset:48416
    v_mfma_f32_16x16x32_bf16 v[92:95], v[116:119], v[144:147], v[92:95]
    ds_read_b64_tr_b16 v[164:165], v14 offset:47168
    s_waitcnt lgkmcnt(11)
    v_mfma_f32_16x16x32_bf16 v[36:39], v[104:107], v[148:151], v[36:39]
    ds_read_b64_tr_b16 v[166:167], v14 offset:48448
    v_mfma_f32_16x16x32_bf16 v[56:59], v[108:111], v[148:151], v[56:59]
    v_mfma_f32_16x16x32_bf16 v[76:79], v[112:115], v[148:151], v[76:79]
    ds_read_b64_tr_b16 v[168:169], v15 offset:47200
    v_mfma_f32_16x16x32_bf16 v[96:99], v[116:119], v[148:151], v[96:99]
    ds_read_b64_tr_b16 v[170:171], v15 offset:48480
    s_waitcnt lgkmcnt(12)
    v_mfma_f32_16x16x32_bf16 v[40:43], v[104:107], v[152:155], v[40:43]
    v_mfma_f32_16x16x32_bf16 v[60:63], v[108:111], v[152:155], v[60:63]
    ds_read_b64_tr_b16 v[172:173], v14 offset:47232
    v_mfma_f32_16x16x32_bf16 v[80:83], v[112:115], v[152:155], v[80:83]
    ds_read_b64_tr_b16 v[174:175], v14 offset:48512
    v_mfma_f32_16x16x32_bf16 v[100:103], v[116:119], v[152:155], v[100:103]
    s_waitcnt lgkmcnt(11)
    v_mfma_f32_16x16x32_bf16 v[24:27], v[120:123], v[156:159], v[24:27]
    s_waitcnt lgkmcnt(10)
    v_mfma_f32_16x16x32_bf16 v[44:47], v[124:127], v[156:159], v[44:47]
    s_waitcnt lgkmcnt(9)
    v_mfma_f32_16x16x32_bf16 v[64:67], v[128:131], v[156:159], v[64:67]
    s_waitcnt lgkmcnt(8)
    v_mfma_f32_16x16x32_bf16 v[84:87], v[132:135], v[156:159], v[84:87]
    s_waitcnt lgkmcnt(6)
    v_mfma_f32_16x16x32_bf16 v[28:31], v[120:123], v[160:163], v[28:31]
    v_mfma_f32_16x16x32_bf16 v[48:51], v[124:127], v[160:163], v[48:51]
    v_mfma_f32_16x16x32_bf16 v[68:71], v[128:131], v[160:163], v[68:71]
    v_mfma_f32_16x16x32_bf16 v[88:91], v[132:135], v[160:163], v[88:91]
    s_waitcnt lgkmcnt(0)
    s_barrier
    v_mfma_f32_16x16x32_bf16 v[32:35], v[120:123], v[164:167], v[32:35]
    ds_read_b128 v[104:107], v16 offset:0
    ds_read_b64_tr_b16 v[136:137], v18 offset:0
    v_mfma_f32_16x16x32_bf16 v[52:55], v[124:127], v[164:167], v[52:55]
    ds_read_b64_tr_b16 v[138:139], v18 offset:1280
    v_mfma_f32_16x16x32_bf16 v[72:75], v[128:131], v[164:167], v[72:75]
    ds_read_b128 v[108:111], v16 offset:2048
    v_mfma_f32_16x16x32_bf16 v[92:95], v[132:135], v[164:167], v[92:95]
    ds_read_b128 v[112:115], v16 offset:4096
    v_mfma_f32_16x16x32_bf16 v[36:39], v[120:123], v[168:171], v[36:39]
    ds_read_b128 v[116:119], v16 offset:6144
    v_mfma_f32_16x16x32_bf16 v[56:59], v[124:127], v[168:171], v[56:59]
    ds_read_b64_tr_b16 v[140:141], v19 offset:32
    v_mfma_f32_16x16x32_bf16 v[76:79], v[128:131], v[168:171], v[76:79]
    ds_read_b64_tr_b16 v[142:143], v19 offset:1312
    ds_read_b64_tr_b16 v[144:145], v18 offset:64
    v_mfma_f32_16x16x32_bf16 v[96:99], v[132:135], v[168:171], v[96:99]
    ds_read_b64_tr_b16 v[146:147], v18 offset:1344
    v_mfma_f32_16x16x32_bf16 v[40:43], v[120:123], v[172:175], v[40:43]
    ds_read_b64_tr_b16 v[148:149], v19 offset:96
    v_mfma_f32_16x16x32_bf16 v[60:63], v[124:127], v[172:175], v[60:63]
    ds_read_b64_tr_b16 v[150:151], v19 offset:1376
    v_mfma_f32_16x16x32_bf16 v[80:83], v[128:131], v[172:175], v[80:83]
    ds_read_b64_tr_b16 v[152:153], v18 offset:128
    v_mfma_f32_16x16x32_bf16 v[100:103], v[132:135], v[172:175], v[100:103]
    ds_read_b64_tr_b16 v[154:155], v18 offset:1408
    s_waitcnt lgkmcnt(11)
    v_mfma_f32_16x16x32_bf16 v[24:27], v[104:107], v[136:139], v[24:27]
    ds_read_b128 v[120:123], v17 offset:0
    s_waitcnt lgkmcnt(11)
    v_mfma_f32_16x16x32_bf16 v[44:47], v[108:111], v[136:139], v[44:47]
    ds_read_b64_tr_b16 v[156:157], v18 offset:10240
    s_waitcnt lgkmcnt(11)
    v_mfma_f32_16x16x32_bf16 v[64:67], v[112:115], v[136:139], v[64:67]
    ds_read_b64_tr_b16 v[158:159], v18 offset:11520
    s_waitcnt lgkmcnt(11)
    v_mfma_f32_16x16x32_bf16 v[84:87], v[116:119], v[136:139], v[84:87]
    s_waitcnt lgkmcnt(9)
    v_mfma_f32_16x16x32_bf16 v[28:31], v[104:107], v[140:143], v[28:31]
    ds_read_b128 v[124:127], v17 offset:2048
    v_mfma_f32_16x16x32_bf16 v[48:51], v[108:111], v[140:143], v[48:51]
    ds_read_b128 v[128:131], v17 offset:4096
    v_mfma_f32_16x16x32_bf16 v[68:71], v[112:115], v[140:143], v[68:71]
    v_mfma_f32_16x16x32_bf16 v[88:91], v[116:119], v[140:143], v[88:91]
    ds_read_b128 v[132:135], v17 offset:6144
    s_waitcnt lgkmcnt(10)
    v_mfma_f32_16x16x32_bf16 v[32:35], v[104:107], v[144:147], v[32:35]
    ds_read_b64_tr_b16 v[160:161], v19 offset:10272
    v_mfma_f32_16x16x32_bf16 v[52:55], v[108:111], v[144:147], v[52:55]
    v_mfma_f32_16x16x32_bf16 v[72:75], v[112:115], v[144:147], v[72:75]
    ds_read_b64_tr_b16 v[162:163], v19 offset:11552
    v_mfma_f32_16x16x32_bf16 v[92:95], v[116:119], v[144:147], v[92:95]
    ds_read_b64_tr_b16 v[164:165], v18 offset:10304
    s_waitcnt lgkmcnt(11)
    v_mfma_f32_16x16x32_bf16 v[36:39], v[104:107], v[148:151], v[36:39]
    ds_read_b64_tr_b16 v[166:167], v18 offset:11584
    v_mfma_f32_16x16x32_bf16 v[56:59], v[108:111], v[148:151], v[56:59]
    v_mfma_f32_16x16x32_bf16 v[76:79], v[112:115], v[148:151], v[76:79]
    ds_read_b64_tr_b16 v[168:169], v19 offset:10336
    v_mfma_f32_16x16x32_bf16 v[96:99], v[116:119], v[148:151], v[96:99]
    ds_read_b64_tr_b16 v[170:171], v19 offset:11616
    s_waitcnt lgkmcnt(12)
    v_mfma_f32_16x16x32_bf16 v[40:43], v[104:107], v[152:155], v[40:43]
    v_mfma_f32_16x16x32_bf16 v[60:63], v[108:111], v[152:155], v[60:63]
    ds_read_b64_tr_b16 v[172:173], v18 offset:10368
    v_mfma_f32_16x16x32_bf16 v[80:83], v[112:115], v[152:155], v[80:83]
    ds_read_b64_tr_b16 v[174:175], v18 offset:11648
    v_mfma_f32_16x16x32_bf16 v[100:103], v[116:119], v[152:155], v[100:103]
    s_waitcnt lgkmcnt(11)
    v_mfma_f32_16x16x32_bf16 v[24:27], v[120:123], v[156:159], v[24:27]
    s_waitcnt lgkmcnt(10)
    v_mfma_f32_16x16x32_bf16 v[44:47], v[124:127], v[156:159], v[44:47]
    s_waitcnt lgkmcnt(9)
    v_mfma_f32_16x16x32_bf16 v[64:67], v[128:131], v[156:159], v[64:67]
    s_waitcnt lgkmcnt(8)
    v_mfma_f32_16x16x32_bf16 v[84:87], v[132:135], v[156:159], v[84:87]
    s_waitcnt lgkmcnt(6)
    v_mfma_f32_16x16x32_bf16 v[28:31], v[120:123], v[160:163], v[28:31]
    v_mfma_f32_16x16x32_bf16 v[48:51], v[124:127], v[160:163], v[48:51]
    v_mfma_f32_16x16x32_bf16 v[68:71], v[128:131], v[160:163], v[68:71]
    v_mfma_f32_16x16x32_bf16 v[88:91], v[132:135], v[160:163], v[88:91]
    s_waitcnt lgkmcnt(0)
    s_barrier
    v_mfma_f32_16x16x32_bf16 v[32:35], v[120:123], v[164:167], v[32:35]
    ds_read_b128 v[104:107], v12 offset:0
    ds_read_b64_tr_b16 v[136:137], v14 offset:0
    v_mfma_f32_16x16x32_bf16 v[52:55], v[124:127], v[164:167], v[52:55]
    ds_read_b64_tr_b16 v[138:139], v14 offset:1280
    v_mfma_f32_16x16x32_bf16 v[72:75], v[128:131], v[164:167], v[72:75]
    ds_read_b128 v[108:111], v12 offset:2048
    v_mfma_f32_16x16x32_bf16 v[92:95], v[132:135], v[164:167], v[92:95]
    ds_read_b128 v[112:115], v12 offset:4096
    v_mfma_f32_16x16x32_bf16 v[36:39], v[120:123], v[168:171], v[36:39]
    ds_read_b128 v[116:119], v12 offset:6144
    v_mfma_f32_16x16x32_bf16 v[56:59], v[124:127], v[168:171], v[56:59]
    ds_read_b64_tr_b16 v[140:141], v15 offset:32
    v_mfma_f32_16x16x32_bf16 v[76:79], v[128:131], v[168:171], v[76:79]
    ds_read_b64_tr_b16 v[142:143], v15 offset:1312
    ds_read_b64_tr_b16 v[144:145], v14 offset:64
    v_mfma_f32_16x16x32_bf16 v[96:99], v[132:135], v[168:171], v[96:99]
    ds_read_b64_tr_b16 v[146:147], v14 offset:1344
    v_mfma_f32_16x16x32_bf16 v[40:43], v[120:123], v[172:175], v[40:43]
    ds_read_b64_tr_b16 v[148:149], v15 offset:96
    v_mfma_f32_16x16x32_bf16 v[60:63], v[124:127], v[172:175], v[60:63]
    ds_read_b64_tr_b16 v[150:151], v15 offset:1376
    v_mfma_f32_16x16x32_bf16 v[80:83], v[128:131], v[172:175], v[80:83]
    ds_read_b64_tr_b16 v[152:153], v14 offset:128
    v_mfma_f32_16x16x32_bf16 v[100:103], v[132:135], v[172:175], v[100:103]
    ds_read_b64_tr_b16 v[154:155], v14 offset:1408
    s_waitcnt lgkmcnt(11)
    v_mfma_f32_16x16x32_bf16 v[24:27], v[104:107], v[136:139], v[24:27]
    ds_read_b128 v[120:123], v13 offset:0
    s_waitcnt lgkmcnt(11)
    v_mfma_f32_16x16x32_bf16 v[44:47], v[108:111], v[136:139], v[44:47]
    ds_read_b64_tr_b16 v[156:157], v14 offset:10240
    s_waitcnt lgkmcnt(11)
    v_mfma_f32_16x16x32_bf16 v[64:67], v[112:115], v[136:139], v[64:67]
    ds_read_b64_tr_b16 v[158:159], v14 offset:11520
    s_waitcnt lgkmcnt(11)
    v_mfma_f32_16x16x32_bf16 v[84:87], v[116:119], v[136:139], v[84:87]
    ds_read_b128 v[124:127], v13 offset:2048
    s_waitcnt lgkmcnt(10)
    v_mfma_f32_16x16x32_bf16 v[28:31], v[104:107], v[140:143], v[28:31]
    ds_read_b128 v[128:131], v13 offset:4096
    v_mfma_f32_16x16x32_bf16 v[48:51], v[108:111], v[140:143], v[48:51]
    ds_read_b128 v[132:135], v13 offset:6144
    v_mfma_f32_16x16x32_bf16 v[68:71], v[112:115], v[140:143], v[68:71]
    ds_read_b64_tr_b16 v[160:161], v15 offset:10272
    v_mfma_f32_16x16x32_bf16 v[88:91], v[116:119], v[140:143], v[88:91]
    ds_read_b64_tr_b16 v[162:163], v15 offset:11552
    s_waitcnt lgkmcnt(12)
    v_mfma_f32_16x16x32_bf16 v[32:35], v[104:107], v[144:147], v[32:35]
    ds_read_b64_tr_b16 v[164:165], v14 offset:10304
    v_mfma_f32_16x16x32_bf16 v[52:55], v[108:111], v[144:147], v[52:55]
    ds_read_b64_tr_b16 v[166:167], v14 offset:11584
    v_mfma_f32_16x16x32_bf16 v[72:75], v[112:115], v[144:147], v[72:75]
    ds_read_b64_tr_b16 v[168:169], v15 offset:10336
    v_mfma_f32_16x16x32_bf16 v[92:95], v[116:119], v[144:147], v[92:95]
    ds_read_b64_tr_b16 v[170:171], v15 offset:11616
    s_waitcnt lgkmcnt(9)
    v_mfma_f32_16x16x32_bf16 v[24:27], v[120:123], v[156:159], v[24:27]
    ds_read_b64_tr_b16 v[172:173], v14 offset:10368
    s_waitcnt lgkmcnt(9)
    v_mfma_f32_16x16x32_bf16 v[44:47], v[124:127], v[156:159], v[44:47]
    ds_read_b64_tr_b16 v[174:175], v14 offset:11648
    s_waitcnt lgkmcnt(9)
    v_mfma_f32_16x16x32_bf16 v[64:67], v[128:131], v[156:159], v[64:67]
    s_waitcnt lgkmcnt(8)
    v_mfma_f32_16x16x32_bf16 v[84:87], v[132:135], v[156:159], v[84:87]
    s_waitcnt lgkmcnt(6)
    v_mfma_f32_16x16x32_bf16 v[28:31], v[120:123], v[160:163], v[28:31]
    v_mfma_f32_16x16x32_bf16 v[48:51], v[124:127], v[160:163], v[48:51]
    v_mfma_f32_16x16x32_bf16 v[68:71], v[128:131], v[160:163], v[68:71]
    v_mul_f32 v216, s76, v24
    v_mul_f32 v217, s76, v25
    v_mul_f32 v218, s76, v26
    v_mfma_f32_16x16x32_bf16 v[88:91], v[132:135], v[160:163], v[88:91]
    v_mul_f32 v219, s76, v27
    v_mul_f32 v220, s76, v44
    v_mul_f32 v221, s76, v45
    s_waitcnt lgkmcnt(4)
    v_mfma_f32_16x16x32_bf16 v[32:35], v[120:123], v[164:167], v[32:35]
    v_mul_f32 v222, s76, v46
    v_mul_f32 v223, s76, v47
    v_exp_f32_e64 v216, v216 clamp
    v_mfma_f32_16x16x32_bf16 v[52:55], v[124:127], v[164:167], v[52:55]
    v_exp_f32_e64 v217, v217 clamp
    v_exp_f32_e64 v218, v218 clamp
    v_mfma_f32_16x16x32_bf16 v[72:75], v[128:131], v[164:167], v[72:75]
    v_exp_f32_e64 v219, v219 clamp
    v_exp_f32_e64 v220, v220 clamp
    v_mfma_f32_16x16x32_bf16 v[92:95], v[132:135], v[164:167], v[92:95]
    v_exp_f32_e64 v221, v221 clamp
    v_exp_f32_e64 v222, v222 clamp
    v_mfma_f32_16x16x32_bf16 v[36:39], v[104:107], v[148:151], v[36:39]
    v_exp_f32_e64 v223, v223 clamp
    v_max_f32 v24, s77, v24
    v_mfma_f32_16x16x32_bf16 v[56:59], v[108:111], v[148:151], v[56:59]
    v_max_f32 v25, s77, v25
    v_max_f32 v26, s77, v26
    v_max_f32 v27, s77, v27
    v_mfma_f32_16x16x32_bf16 v[76:79], v[112:115], v[148:151], v[76:79]
    v_max_f32 v44, s77, v44
    v_max_f32 v45, s77, v45
    v_max_f32 v46, s77, v46
    v_mfma_f32_16x16x32_bf16 v[96:99], v[116:119], v[148:151], v[96:99]
    v_max_f32 v47, s77, v47
    v_add_f32 v24, v24, v216
    v_add_f32 v25, v25, v217
    v_mfma_f32_16x16x32_bf16 v[40:43], v[104:107], v[152:155], v[40:43]
    v_add_f32 v26, v26, v218
    v_add_f32 v27, v27, v219
    v_add_f32 v44, v44, v220
    v_mfma_f32_16x16x32_bf16 v[60:63], v[108:111], v[152:155], v[60:63]
    v_add_f32 v45, v45, v221
    v_add_f32 v46, v46, v222
    v_add_f32 v47, v47, v223
    v_mfma_f32_16x16x32_bf16 v[80:83], v[112:115], v[152:155], v[80:83]
    v_mul_f32 v216, s76, v64
    v_mul_f32 v217, s76, v65
    v_mul_f32 v218, s76, v66
    v_mfma_f32_16x16x32_bf16 v[100:103], v[116:119], v[152:155], v[100:103]
    v_mul_f32 v219, s76, v67
    v_mul_f32 v220, s76, v84
    v_mul_f32 v221, s76, v85
    s_waitcnt lgkmcnt(2)
    v_mfma_f32_16x16x32_bf16 v[36:39], v[120:123], v[168:171], v[36:39]
    v_mul_f32 v222, s76, v86
    v_mul_f32 v223, s76, v87
    v_exp_f32_e64 v216, v216 clamp
    v_mfma_f32_16x16x32_bf16 v[56:59], v[124:127], v[168:171], v[56:59]
    v_exp_f32_e64 v217, v217 clamp
    v_exp_f32_e64 v218, v218 clamp
    v_mfma_f32_16x16x32_bf16 v[76:79], v[128:131], v[168:171], v[76:79]
    v_exp_f32_e64 v219, v219 clamp
    v_exp_f32_e64 v220, v220 clamp
    v_mfma_f32_16x16x32_bf16 v[96:99], v[132:135], v[168:171], v[96:99]
    v_exp_f32_e64 v221, v221 clamp
    v_exp_f32_e64 v222, v222 clamp
    s_waitcnt lgkmcnt(0)
    v_mfma_f32_16x16x32_bf16 v[40:43], v[120:123], v[172:175], v[40:43]
    v_exp_f32_e64 v223, v223 clamp
    v_max_f32 v64, s77, v64
    v_mfma_f32_16x16x32_bf16 v[60:63], v[124:127], v[172:175], v[60:63]
    v_max_f32 v65, s77, v65
    v_max_f32 v66, s77, v66
    v_max_f32 v67, s77, v67
    v_mfma_f32_16x16x32_bf16 v[80:83], v[128:131], v[172:175], v[80:83]
    v_max_f32 v84, s77, v84
    v_max_f32 v85, s77, v85
    v_max_f32 v86, s77, v86
    v_mfma_f32_16x16x32_bf16 v[100:103], v[132:135], v[172:175], v[100:103]
    v_max_f32 v87, s77, v87
    v_add_f32 v64, v64, v216
    v_add_f32 v65, v65, v217
    v_add_f32 v66, v66, v218
    v_add_f32 v67, v67, v219
    v_add_f32 v84, v84, v220
    v_add_f32 v85, v85, v221
    v_add_f32 v86, v86, v222
    v_add_f32 v87, v87, v223
    v_cvt_pk_bf16_f32 v104, v24, v25
    v_cvt_pk_bf16_f32 v105, v26, v27
    v_cvt_pk_bf16_f32 v106, v44, v45
    v_cvt_pk_bf16_f32 v107, v46, v47
    v_cvt_pk_bf16_f32 v128, v64, v65
    v_cvt_pk_bf16_f32 v129, v66, v67
    v_cvt_pk_bf16_f32 v130, v84, v85
    v_cvt_pk_bf16_f32 v131, v86, v87
    v_cvt_pk_bf16_f32 v124, v32, v33
    v_cvt_pk_bf16_f32 v125, v34, v35
    v_cvt_pk_bf16_f32 v126, v52, v53
    v_cvt_pk_bf16_f32 v127, v54, v55
    v_cvt_pk_bf16_f32 v148, v72, v73
    v_cvt_pk_bf16_f32 v149, v74, v75
    v_cvt_pk_bf16_f32 v150, v92, v93
    v_cvt_pk_bf16_f32 v151, v94, v95
    v_cmp_gt_u32 vcc, 8, v9
    v_mov_b32 v224, 0x3f803f80
    s_nop 0
    v_cndmask_b32 v124, v124, v224, vcc
    v_cndmask_b32 v125, v125, v224, vcc
    v_cndmask_b32 v126, v126, v224, vcc
    v_cndmask_b32 v127, v127, v224, vcc
    v_cndmask_b32 v148, v148, v224, vcc
    v_cndmask_b32 v149, v149, v224, vcc
    v_cndmask_b32 v150, v150, v224, vcc
    v_cndmask_b32 v151, v151, v224, vcc
    v_cvt_pk_bf16_f32 v116, v36, v37
    v_cvt_pk_bf16_f32 v117, v38, v39
    v_cvt_pk_bf16_f32 v118, v56, v57
    v_cvt_pk_bf16_f32 v119, v58, v59
    v_cvt_pk_bf16_f32 v140, v76, v77
    v_cvt_pk_bf16_f32 v141, v78, v79
    v_cvt_pk_bf16_f32 v142, v96, v97
    v_cvt_pk_bf16_f32 v143, v98, v99
    v_mfma_f32_16x16x32_bf16 v[184:187], v[104:107], v[124:127], 0
    v_mfma_f32_16x16x32_bf16 v[184:187], v[128:131], v[148:151], v[184:187]
    v_mfma_f32_16x16x32_bf16 v[188:191], v[104:107], v[116:119], 0
    v_mfma_f32_16x16x32_bf16 v[188:191], v[128:131], v[140:143], v[188:191]
    v_cvt_pk_bf16_f32 v120, v40, v41
    v_cvt_pk_bf16_f32 v121, v42, v43
    v_cvt_pk_bf16_f32 v122, v60, v61
    v_cvt_pk_bf16_f32 v123, v62, v63
    v_cvt_pk_bf16_f32 v144, v80, v81
    v_cvt_pk_bf16_f32 v145, v82, v83
    v_cvt_pk_bf16_f32 v146, v100, v101
    v_cvt_pk_bf16_f32 v147, v102, v103
    v_mul_f32 v216, s76, v28
    v_mul_f32 v217, s76, v29
    v_mul_f32 v218, s76, v30
    v_mul_f32 v219, s76, v31
    v_mul_f32 v220, s76, v48
    v_mul_f32 v221, s76, v49
    v_mul_f32 v222, s76, v50
    v_mul_f32 v223, s76, v51
    v_exp_f32_e64 v216, v216 clamp
    v_exp_f32_e64 v217, v217 clamp
    v_exp_f32_e64 v218, v218 clamp
    v_exp_f32_e64 v219, v219 clamp
    v_exp_f32_e64 v220, v220 clamp
    v_exp_f32_e64 v221, v221 clamp
    v_exp_f32_e64 v222, v222 clamp
    v_exp_f32_e64 v223, v223 clamp
    v_max_f32 v28, s77, v28
    v_max_f32 v29, s77, v29
    v_max_f32 v30, s77, v30
    v_max_f32 v31, s77, v31
    v_max_f32 v48, s77, v48
    v_max_f32 v49, s77, v49
    v_max_f32 v50, s77, v50
    v_max_f32 v51, s77, v51
    v_add_f32 v28, v28, v216
    v_add_f32 v29, v29, v217
    v_add_f32 v30, v30, v218
    v_add_f32 v31, v31, v219
    v_add_f32 v48, v48, v220
    v_add_f32 v49, v49, v221
    v_add_f32 v50, v50, v222
    v_add_f32 v51, v51, v223
    v_mul_f32 v216, s76, v68
    v_mul_f32 v217, s76, v69
    v_mul_f32 v218, s76, v70
    v_mul_f32 v219, s76, v71
    v_mul_f32 v220, s76, v88
    v_mul_f32 v221, s76, v89
    v_mul_f32 v222, s76, v90
    v_mul_f32 v223, s76, v91
    v_exp_f32_e64 v216, v216 clamp
    v_exp_f32_e64 v217, v217 clamp
    v_exp_f32_e64 v218, v218 clamp
    v_exp_f32_e64 v219, v219 clamp
    v_exp_f32_e64 v220, v220 clamp
    v_exp_f32_e64 v221, v221 clamp
    v_exp_f32_e64 v222, v222 clamp
    v_exp_f32_e64 v223, v223 clamp
    v_max_f32 v68, s77, v68
    v_max_f32 v69, s77, v69
    v_max_f32 v70, s77, v70
    v_max_f32 v71, s77, v71
    v_max_f32 v88, s77, v88
    v_max_f32 v89, s77, v89
    v_max_f32 v90, s77, v90
    v_max_f32 v91, s77, v91
    v_add_f32 v68, v68, v216
    v_add_f32 v69, v69, v217
    v_add_f32 v70, v70, v218
    v_add_f32 v71, v71, v219
    v_add_f32 v88, v88, v220
    v_add_f32 v89, v89, v221
    v_add_f32 v90, v90, v222
    v_add_f32 v91, v91, v223
    v_cvt_pk_bf16_f32 v108, v28, v29
    v_cvt_pk_bf16_f32 v109, v30, v31
    v_cvt_pk_bf16_f32 v110, v48, v49
    v_cvt_pk_bf16_f32 v111, v50, v51
    v_cvt_pk_bf16_f32 v132, v68, v69
    v_cvt_pk_bf16_f32 v133, v70, v71
    v_cvt_pk_bf16_f32 v134, v88, v89
    v_cvt_pk_bf16_f32 v135, v90, v91
    v_mfma_f32_16x16x32_bf16 v[192:195], v[108:111], v[124:127], 0
    s_nop 0
    v_mfma_f32_16x16x32_bf16 v[192:195], v[132:135], v[148:151], v[192:195]
    v_mfma_f32_16x16x32_bf16 v[196:199], v[108:111], v[116:119], 0
    v_mfma_f32_16x16x32_bf16 v[196:199], v[132:135], v[140:143], v[196:199]
    v_mfma_f32_16x16x32_bf16 v[200:203], v[108:111], v[120:123], 0
    v_mfma_f32_16x16x32_bf16 v[200:203], v[132:135], v[144:147], v[200:203]
    ds_write_b128 v176, v[184:187]
    ds_write_b128 v177, v[188:191]
    v_mul_f32 v216, s76, v32
    v_mul_f32 v217, s76, v33
    v_mul_f32 v218, s76, v34
    v_mul_f32 v219, s76, v35
    v_mul_f32 v220, s76, v52
    v_mul_f32 v221, s76, v53
    v_mul_f32 v222, s76, v54
    v_mul_f32 v223, s76, v55
    v_exp_f32_e64 v216, v216 clamp
    v_exp_f32_e64 v217, v217 clamp
    v_exp_f32_e64 v218, v218 clamp
    v_exp_f32_e64 v219, v219 clamp
    v_exp_f32_e64 v220, v220 clamp
    v_exp_f32_e64 v221, v221 clamp
    v_exp_f32_e64 v222, v222 clamp
    v_exp_f32_e64 v223, v223 clamp
    v_max_f32 v32, s77, v32
    v_max_f32 v33, s77, v33
    v_max_f32 v34, s77, v34
    v_max_f32 v35, s77, v35
    v_max_f32 v52, s77, v52
    v_max_f32 v53, s77, v53
    v_max_f32 v54, s77, v54
    v_max_f32 v55, s77, v55
    v_add_f32 v32, v32, v216
    v_add_f32 v33, v33, v217
    v_add_f32 v34, v34, v218
    v_add_f32 v35, v35, v219
    v_add_f32 v52, v52, v220
    v_add_f32 v53, v53, v221
    v_add_f32 v54, v54, v222
    v_add_f32 v55, v55, v223
    v_mul_f32 v216, s76, v72
    v_mul_f32 v217, s76, v73
    v_mul_f32 v218, s76, v74
    v_mul_f32 v219, s76, v75
    v_mul_f32 v220, s76, v92
    v_mul_f32 v221, s76, v93
    v_mul_f32 v222, s76, v94
    v_mul_f32 v223, s76, v95
    v_exp_f32_e64 v216, v216 clamp
    v_exp_f32_e64 v217, v217 clamp
    v_exp_f32_e64 v218, v218 clamp
    v_exp_f32_e64 v219, v219 clamp
    v_exp_f32_e64 v220, v220 clamp
    v_exp_f32_e64 v221, v221 clamp
    v_exp_f32_e64 v222, v222 clamp
    v_exp_f32_e64 v223, v223 clamp
    v_max_f32 v72, s77, v72
    v_max_f32 v73, s77, v73
    v_max_f32 v74, s77, v74
    v_max_f32 v75, s77, v75
    v_max_f32 v92, s77, v92
    v_max_f32 v93, s77, v93
    v_max_f32 v94, s77, v94
    v_max_f32 v95, s77, v95
    v_add_f32 v72, v72, v216
    v_add_f32 v73, v73, v217
    v_add_f32 v74, v74, v218
    v_add_f32 v75, v75, v219
    v_add_f32 v92, v92, v220
    v_add_f32 v93, v93, v221
    v_add_f32 v94, v94, v222
    v_add_f32 v95, v95, v223
    ds_write_b128 v178, v[192:195]
    ds_write_b128 v179, v[196:199]
    ds_write_b128 v180, v[200:203]
    v_cvt_pk_bf16_f32 v112, v32, v33
    v_cvt_pk_bf16_f32 v113, v34, v35
    v_cvt_pk_bf16_f32 v114, v52, v53
    v_cvt_pk_bf16_f32 v115, v54, v55
    v_cvt_pk_bf16_f32 v136, v72, v73
    v_cvt_pk_bf16_f32 v137, v74, v75
    v_cvt_pk_bf16_f32 v138, v92, v93
    v_cvt_pk_bf16_f32 v139, v94, v95
    v_mfma_f32_16x16x32_bf16 v[204:207], v[112:115], v[124:127], 0
    s_nop 0
    v_mfma_f32_16x16x32_bf16 v[204:207], v[136:139], v[148:151], v[204:207]
    v_mfma_f32_16x16x32_bf16 v[208:211], v[112:115], v[116:119], 0
    v_mfma_f32_16x16x32_bf16 v[208:211], v[136:139], v[140:143], v[208:211]
    v_mfma_f32_16x16x32_bf16 v[212:215], v[112:115], v[120:123], 0
    v_mfma_f32_16x16x32_bf16 v[212:215], v[136:139], v[144:147], v[212:215]
    s_waitcnt vmcnt(0)
    v_cmp_eq_u32 vcc, 0, v253
    s_cbranch_vccz L_kn
    s_mov_b32 s81, 100000
Lspin_18:
    buffer_load_dword v253, off, s[56:59], 0 sc1
    s_waitcnt vmcnt(0)
    v_cmp_eq_u32 vcc, 0, v253
    s_cbranch_vccz Lspun_19
    s_sleep 8
    s_sub_u32 s81, s81, 1
    s_cbranch_scc0 Lspin_18
Lspun_19:
L_kn:
    v_readfirstlane_b32 s0, v253
    ds_write_b128 v181, v[204:207]
    ds_write_b128 v182, v[208:211]
    ds_write_b128 v183, v[212:215]
    s_waitcnt lgkmcnt(0)
    s_barrier
    s_branch L_gconv
L_q:
    s_lshl_b32 s72, s9, 2
    s_lshl_b32 s73, s15, 1
    s_add_u32 s72, s72, s73
    s_mul_i32 s72, s72, 40
    s_mul_i32 s73, s13, 10
    s_add_u32 s72, s72, s73
    s_mul_i32 s73, s42, 5
    s_add_u32 s72, s72, s73
    s_lshl_b32 s72, s72, 10
    s_add_u32 s78, s72, 4194304
    s_add_u32 s79, s78, 4096
    v_lshlrev_b32 v20, 4, v1
    v_add_u32 v21, 40960, v20
    v_and_b32 v2, 15, v1
    v_lshrrev_b32 v3, 4, v1
    s_and_b32 s75, s5, 7
    s_cmp_ge_u32 s75, 5
    s_cselect_b32 s1, 5, 0
    s_sub_u32 s75, s75, s1
    s_and_b32 s1, s3, 3
    v_lshrrev_b32 v4, 1, v3
    v_lshlrev_b32 v4, 3, v4
    v_bfe_u32 v5, v1, 2, 2
    v_lshl_add_u32 v4, v5, 1, v4
    v_and_b32 v5, 1, v3
    v_add_u32 v4, v4, v5
    v_mul_u32_u24 v4, 160, v4
    v_and_b32 v5, 3, v1
    v_lshl_add_u32 v4, v5, 3, v4
    s_sub_u32 s75, 5, s75
    s_cmp_ge_u32 s75, 5
    s_cselect_b32 s75, 0, s75
    s_mul_i32 s72, s1, 15360
    s_add_u32 s72, s72, 40960
    s_mul_i32 s73, s1, 10240
    s_sub_u32 s73, s73, 15360
    s_cmp_ge_u32 s75, 3
    s_cselect_b32 s72, s73, s72
    s_mul_i32 s73, s75, 5120
    s_add_u32 s72, s72, s73
    v_add_u32 v236, s72, v4
    s_add_u32 s75, s75, 1
    s_cmp_ge_u32 s75, 5
    s_cselect_b32 s75, 0, s75
    s_mul_i32 s72, s1, 15360
    s_add_u32 s72, s72, 40960
    s_mul_i32 s73, s1, 10240
    s_sub_u32 s73, s73, 15360
    s_cmp_ge_u32 s75, 3
    s_cselect_b32 s72, s73, s72
    s_mul_i32 s73, s75, 5120
    s_add_u32 s72, s72, s73
    v_add_u32 v237, s72, v4
    s_add_u32 s75, s75, 1
    s_cmp_ge_u32 s75, 5
    s_cselect_b32 s75, 0, s75
    s_mul_i32 s72, s1, 15360
    s_add_u32 s72, s72, 40960
    s_mul_i32 s73, s1, 10240
    s_sub_u32 s73, s73, 15360
    s_cmp_ge_u32 s75, 3
    s_cselect_b32 s72, s73, s72
    s_mul_i32 s73, s75, 5120
    s_add_u32 s72, s72, s73
    v_add_u32 v238, s72, v4
    s_add_u32 s75, s75, 1
    s_cmp_ge_u32 s75, 5
    s_cselect_b32 s75, 0, s75
    s_mul_i32 s72, s1, 15360
    s_add_u32 s72, s72, 40960
    s_mul_i32 s73, s1, 10240
    s_sub_u32 s73, s73, 15360
    s_cmp_ge_u32 s75, 3
    s_cselect_b32 s72, s73, s72
    s_mul_i32 s73, s75, 5120
    s_add_u32 s72, s72, s73
    v_add_u32 v239, s72, v4
    s_add_u32 s75, s75, 1
    s_cmp_ge_u32 s75, 5
    s_cselect_b32 s75, 0, s75
    s_mul_i32 s72, s1, 15360
    s_add_u32 s72, s72, 40960
    s_mul_i32 s73, s1, 10240
    s_sub_u32 s73, s73, 15360
    s_cmp_ge_u32 s75, 3
    s_cselect_b32 s72, s73, s72
    s_mul_i32 s73, s75, 5120
    s_add_u32 s72, s72, s73
    v_add_u32 v240, s72, v4
    s_add_u32 s75, s75, 1
    v_lshrrev_b32 v4, 2, v1
    v_lshlrev_b32 v4, 7, v4
    v_lshl_add_u32 v4, v5, 3, v4
    s_lshr_b32 s73, s3, 2
    s_lshl_b32 s72, s73, 11
    s_lshl_b32 s74, s1, 5
    s_add_u32 s72, s72, s74
    s_add_u32 s72, s72, 81920
    v_add_u32 v249, s72, v4
    s_mul_i32 s72, s1, 10752
    s_add_u32 s72, s72, 102400
    v_lshlrev_b32 v4, 4, v3
    v_and_b32 v6, 8, v2
    v_lshlrev_b32 v6, 2, v6
    v_xor_b32 v6, v6, v4
    v_lshl_add_u32 v6, v2, 6, v6
    v_add_u32 v244, s72, v6
    v_lshrrev_b32 v6, 2, v2
    v_add_u32 v6, 16, v6
    v_lshl_add_u32 v6, v6, 6, v4
    v_xor_b32 v7, 32, v4
    v_add_u32 v7, 1280, v7
    v_cmp_eq_u32 vcc, 0, v5
    s_nop 1
    v_cndmask_b32 v6, v7, v6, vcc
    v_add_u32 v245, s72, v6
    v_lshlrev_b32 v251, 4, v1
    s_mul_i32 s72, s1, 20480
    s_xor_b32 s74, s73, s7
    s_and_b32 s74, s74, 1
    s_mul_i32 s74, s74, 10240
    s_add_u32 s72, s72, s74
    v_add_u32 v246, s72, v251
    s_mul_i32 s72, s1, 5120
    s_lshl_b32 s74, s73, 10
    s_add_u32 s72, s72, s74
    v_add_u32 v247, s72, v251
    s_lshl_b32 s72, s6, 6
    s_lshl_b32 s74, s1, 4
    s_add_u32 s72, s72, s74
    v_add_u32 v4, s72, v2
    v_mul_u32_u24 v4, 1280, v4
    v_lshl_add_u32 v4, v3, 3, v4
    s_mul_i32 s72, s7, 160
    s_lshl_b32 s74, s73, 5
    s_add_u32 s72, s72, s74
    v_add_u32 v248, s72, v4
    s_mul_i32 s72, s7, 80
    s_lshl_b32 s74, s3, 3
    s_add_u32 s72, s72, s74
    v_lshrrev_b32 v4, 3, v1
    v_add_u32 v4, s72, v4
    v_mul_u32_u24 v4, 4224, v4
    v_and_b32 v6, 7, v1
    v_lshl_add_u32 v4, v6, 4, v4
    s_lshl_b32 s72, s6, 7
    s_add_u32 s72, s72, 6815744
    v_add_u32 v250, s72, v4
    v_lshlrev_b32 v2, 1, v1
    s_add_u32 s72, s1, 5
    s_and_b32 s73, s72, 3
    s_lshl_b32 s73, s73, 4
    s_bfe_u32 s72, s72, 0x10002
    s_lshl_b32 s72, s72, 3
    s_add_u32 s73, s73, s72
    s_mul_i32 s72, s1, 1344
    s_add_u32 s72, s72, 102400
    v_mul_u32_u24 v3, 3121, v2
    v_lshrrev_b32 v3, 16, v3
    v_mul_u32_u24 v4, 21, v3
    v_sub_u32 v4, v2, v4
    v_and_b32 v5, 3, v4
    v_lshrrev_b32 v6, 2, v4
    v_lshl_add_u32 v5, v5, 2, v6
    v_cmp_gt_u32 vcc, 16, v4
    s_nop 1
    v_cndmask_b32 v4, v4, v5, vcc
    v_add_u32 v3, s1, v3
    v_and_b32 v5, 3, v3
    v_lshlrev_b32 v5, 4, v5
    v_and_b32 v6, 8, v4
    v_lshlrev_b32 v6, 2, v6
    v_cmp_eq_u32 vcc, 20, v4
    s_nop 1
    v_cndmask_b32 v6, v6, 32, vcc
    v_xor_b32 v5, v5, v6
    v_lshl_add_u32 v4, v4, 6, v5
    v_lshrrev_b32 v3, 2, v3
    v_lshl_add_u32 v4, v3, 3, v4
    v_cmp_gt_u32 vcc, 105, v2
    v_mov_b32 v5, s73
    s_nop 0
    v_cndmask_b32 v4, v5, v4, vcc
    v_add_u32 v241, s72, v4
    v_add_u32 v2, 1, v2
    v_mul_u32_u24 v3, 3121, v2
    v_lshrrev_b32 v3, 16, v3
    v_mul_u32_u24 v4, 21, v3
    v_sub_u32 v4, v2, v4
    v_and_b32 v5, 3, v4
    v_lshrrev_b32 v6, 2, v4
    v_lshl_add_u32 v5, v5, 2, v6
    v_cmp_gt_u32 vcc, 16, v4
    s_nop 1
    v_cndmask_b32 v4, v4, v5, vcc
    v_add_u32 v3, s1, v3
    v_and_b32 v5, 3, v3
    v_lshlrev_b32 v5, 4, v5
    v_and_b32 v6, 8, v4
    v_lshlrev_b32 v6, 2, v6
    v_cmp_eq_u32 vcc, 20, v4
    s_nop 1
    v_cndmask_b32 v6, v6, 32, vcc
    v_xor_b32 v5, v5, v6
    v_lshl_add_u32 v4, v4, 6, v5
    v_lshrrev_b32 v3, 2, v3
    v_lshl_add_u32 v4, v3, 3, v4
    v_cmp_gt_u32 vcc, 105, v2
    v_mov_b32 v5, s73
    s_nop 0
    v_cndmask_b32 v4, v5, v4, vcc
    v_add_u32 v242, s72, v4
    s_cmp_eq_u32 s3, 0
    s_cbranch_scc1 Lnz_20
    v_mov_b32 v4, 0
    v_mov_b32 v5, 0
    v_mov_b32 v6, 0
    v_mov_b32 v7, 0
    s_mul_i32 s72, s3, 10752
    s_add_u32 s72, s72, 102400
    v_add_u32 v2, s72, v251
    ds_write_b128 v2, v[4:7] offset:0
    ds_write_b128 v2, v[4:7] offset:1024
    ds_write_b128 v2, v[4:7] offset:2048
    ds_write_b128 v2, v[4:7] offset:3072
    ds_write_b128 v2, v[4:7] offset:4096
    ds_write_b128 v2, v[4:7] offset:5120
    ds_write_b128 v2, v[4:7] offset:6144
    ds_write_b128 v2, v[4:7] offset:7168
    ds_write_b128 v2, v[4:7] offset:8192
    ds_write_b128 v2, v[4:7] offset:9216
    s_mov_b32 exec_hi, 0
    ds_write_b128 v2, v[4:7] offset:10240
    s_mov_b32 exec_hi, -1
Lnz_20:
    s_waitcnt lgkmcnt(0)
    s_cmp_ge_u32 s3, 2
    s_cbranch_scc1 Lpp_21
    s_waitcnt vmcnt(16)
    s_mov_b32 s72, 0xffff0000
    v_lshlrev_b32 v72, 16, v64
    v_lshlrev_b32 v73, 16, v66
    v_lshlrev_b32 v74, 16, v68
    v_lshlrev_b32 v75, 16, v70
    v_and_b32 v76, s72, v64
    v_and_b32 v77, s72, v66
    v_and_b32 v78, s72, v68
    v_and_b32 v79, s72, v70
    v_lshlrev_b32 v80, 16, v65
    v_lshlrev_b32 v81, 16, v67
    v_lshlrev_b32 v82, 16, v69
    v_lshlrev_b32 v83, 16, v71
    v_and_b32 v84, s72, v65
    v_and_b32 v85, s72, v67
    v_and_b32 v86, s72, v69
    v_and_b32 v87, s72, v71
    v_lshlrev_b32 v88, 16, v24
    v_and_b32 v89, s72, v24
    v_lshlrev_b32 v90, 16, v25
    v_and_b32 v91, s72, v25
    v_lshlrev_b32 v92, 16, v26
    v_and_b32 v93, s72, v26
    v_lshlrev_b32 v94, 16, v27
    v_and_b32 v95, s72, v27
    v_lshlrev_b32 v96, 16, v28
    v_and_b32 v97, s72, v28
    v_lshlrev_b32 v98, 16, v29
    v_and_b32 v99, s72, v29
    v_pk_mul_f32 v[104:105], v[88:89], v[84:85]
    v_pk_mul_f32 v[106:107], v[90:91], v[86:87]
    v_pk_fma_f32 v[104:105], v[92:93], v[80:81], v[104:105]
    v_pk_fma_f32 v[106:107], v[94:95], v[82:83], v[106:107]
    v_pk_fma_f32 v[104:105], v[96:97], v[76:77], v[104:105]
    v_pk_fma_f32 v[106:107], v[98:99], v[78:79], v[106:107]
    s_waitcnt vmcnt(15)
    v_lshlrev_b32 v100, 16, v30
    v_and_b32 v101, s72, v30
    v_lshlrev_b32 v102, 16, v31
    v_and_b32 v103, s72, v31
    v_pk_fma_f32 v[104:105], v[100:101], v[72:73], v[104:105]
    v_pk_fma_f32 v[106:107], v[102:103], v[74:75], v[106:107]
    s_waitcnt vmcnt(11)
    v_lshlrev_b32 v136, 16, v46
    v_and_b32 v137, s72, v46
    v_lshlrev_b32 v138, 16, v47
    v_and_b32 v139, s72, v47
    v_pk_mul_f32 v[104:105], v[104:105], v[136:137]
    v_pk_mul_f32 v[106:107], v[106:107], v[138:139]
    v_pk_mul_f32 v[108:109], v[92:93], v[84:85]
    v_pk_mul_f32 v[110:111], v[94:95], v[86:87]
    v_pk_fma_f32 v[108:109], v[96:97], v[80:81], v[108:109]
    v_pk_fma_f32 v[110:111], v[98:99], v[82:83], v[110:111]
    v_pk_fma_f32 v[108:109], v[100:101], v[76:77], v[108:109]
    v_pk_fma_f32 v[110:111], v[102:103], v[78:79], v[110:111]
    v_lshlrev_b32 v88, 16, v32
    v_and_b32 v89, s72, v32
    v_lshlrev_b32 v90, 16, v33
    v_and_b32 v91, s72, v33
    v_pk_fma_f32 v[108:109], v[88:89], v[72:73], v[108:109]
    v_pk_fma_f32 v[110:111], v[90:91], v[74:75], v[110:111]
    s_waitcnt vmcnt(10)
    v_lshlrev_b32 v136, 16, v48
    v_and_b32 v137, s72, v48
    v_lshlrev_b32 v138, 16, v49
    v_and_b32 v139, s72, v49
    v_pk_mul_f32 v[108:109], v[108:109], v[136:137]
    v_pk_mul_f32 v[110:111], v[110:111], v[138:139]
    v_pk_mul_f32 v[112:113], v[96:97], v[84:85]
    v_pk_mul_f32 v[114:115], v[98:99], v[86:87]
    v_pk_fma_f32 v[112:113], v[100:101], v[80:81], v[112:113]
    v_pk_fma_f32 v[114:115], v[102:103], v[82:83], v[114:115]
    v_pk_fma_f32 v[112:113], v[88:89], v[76:77], v[112:113]
    v_pk_fma_f32 v[114:115], v[90:91], v[78:79], v[114:115]
    v_lshlrev_b32 v92, 16, v34
    v_and_b32 v93, s72, v34
    v_lshlrev_b32 v94, 16, v35
    v_and_b32 v95, s72, v35
    v_pk_fma_f32 v[112:113], v[92:93], v[72:73], v[112:113]
    v_pk_fma_f32 v[114:115], v[94:95], v[74:75], v[114:115]
    s_waitcnt vmcnt(9)
    v_lshlrev_b32 v136, 16, v50
    v_and_b32 v137, s72, v50
    v_lshlrev_b32 v138, 16, v51
    v_and_b32 v139, s72, v51
    v_pk_mul_f32 v[112:113], v[112:113], v[136:137]
    v_pk_mul_f32 v[114:115], v[114:115], v[138:139]
    v_pk_mul_f32 v[116:117], v[100:101], v[84:85]
    v_pk_mul_f32 v[118:119], v[102:103], v[86:87]
    v_pk_fma_f32 v[116:117], v[88:89], v[80:81], v[116:117]
    v_pk_fma_f32 v[118:119], v[90:91], v[82:83], v[118:119]
    v_pk_fma_f32 v[116:117], v[92:93], v[76:77], v[116:117]
    v_pk_fma_f32 v[118:119], v[94:95], v[78:79], v[118:119]
    v_lshlrev_b32 v96, 16, v36
    v_and_b32 v97, s72, v36
    v_lshlrev_b32 v98, 16, v37
    v_and_b32 v99, s72, v37
    v_pk_fma_f32 v[116:117], v[96:97], v[72:73], v[116:117]
    v_pk_fma_f32 v[118:119], v[98:99], v[74:75], v[118:119]
    s_waitcnt vmcnt(8)
    v_lshlrev_b32 v136, 16, v52
    v_and_b32 v137, s72, v52
    v_lshlrev_b32 v138, 16, v53
    v_and_b32 v139, s72, v53
    v_pk_mul_f32 v[116:117], v[116:117], v[136:137]
    v_pk_mul_f32 v[118:119], v[118:119], v[138:139]
    v_pk_mul_f32 v[120:121], v[88:89], v[84:85]
    v_pk_mul_f32 v[122:123], v[90:91], v[86:87]
    v_pk_fma_f32 v[120:121], v[92:93], v[80:81], v[120:121]
    v_pk_fma_f32 v[122:123], v[94:95], v[82:83], v[122:123]
    v_pk_fma_f32 v[120:121], v[96:97], v[76:77], v[120:121]
    v_pk_fma_f32 v[122:123], v[98:99], v[78:79], v[122:123]
    s_waitcnt vmcnt(7)
    v_lshlrev_b32 v100, 16, v38
    v_and_b32 v101, s72, v38
    v_lshlrev_b32 v102, 16, v39
    v_and_b32 v103, s72, v39
    v_pk_fma_f32 v[120:121], v[100:101], v[72:73], v[120:121]
    v_pk_fma_f32 v[122:123], v[102:103], v[74:75], v[122:123]
    s_waitcnt vmcnt(3)
    v_lshlrev_b32 v136, 16, v54
    v_and_b32 v137, s72, v54
    v_lshlrev_b32 v138, 16, v55
    v_and_b32 v139, s72, v55
    v_pk_mul_f32 v[120:121], v[120:121], v[136:137]
    v_pk_mul_f32 v[122:123], v[122:123], v[138:139]
    v_cvt_pk_bf16_f32 v140, v120, v104
    ds_write_b32 v156, v140 offset:0
    v_cvt_pk_bf16_f32 v141, v121, v105
    ds_write_b32 v156, v141 offset:64
    v_cvt_pk_bf16_f32 v142, v122, v106
    ds_write_b32 v156, v142 offset:128
    v_cvt_pk_bf16_f32 v143, v123, v107
    ds_write_b32 v156, v143 offset:192
    v_pk_mul_f32 v[124:125], v[92:93], v[84:85]
    v_pk_mul_f32 v[126:127], v[94:95], v[86:87]
    v_pk_fma_f32 v[124:125], v[96:97], v[80:81], v[124:125]
    v_pk_fma_f32 v[126:127], v[98:99], v[82:83], v[126:127]
    v_pk_fma_f32 v[124:125], v[100:101], v[76:77], v[124:125]
    v_pk_fma_f32 v[126:127], v[102:103], v[78:79], v[126:127]
    v_lshlrev_b32 v88, 16, v40
    v_and_b32 v89, s72, v40
    v_lshlrev_b32 v90, 16, v41
    v_and_b32 v91, s72, v41
    v_pk_fma_f32 v[124:125], v[88:89], v[72:73], v[124:125]
    v_pk_fma_f32 v[126:127], v[90:91], v[74:75], v[126:127]
    s_waitcnt vmcnt(2)
    v_lshlrev_b32 v136, 16, v56
    v_and_b32 v137, s72, v56
    v_lshlrev_b32 v138, 16, v57
    v_and_b32 v139, s72, v57
    v_pk_mul_f32 v[124:125], v[124:125], v[136:137]
    v_pk_mul_f32 v[126:127], v[126:127], v[138:139]
    v_cvt_pk_bf16_f32 v144, v124, v108
    ds_write_b32 v156, v144 offset:16
    v_cvt_pk_bf16_f32 v145, v125, v109
    ds_write_b32 v156, v145 offset:80
    v_cvt_pk_bf16_f32 v146, v126, v110
    ds_write_b32 v156, v146 offset:144
    v_cvt_pk_bf16_f32 v147, v127, v111
    ds_write_b32 v156, v147 offset:208
    v_pk_mul_f32 v[128:129], v[96:97], v[84:85]
    v_pk_mul_f32 v[130:131], v[98:99], v[86:87]
    v_pk_fma_f32 v[128:129], v[100:101], v[80:81], v[128:129]
    v_pk_fma_f32 v[130:131], v[102:103], v[82:83], v[130:131]
    v_pk_fma_f32 v[128:129], v[88:89], v[76:77], v[128:129]
    v_pk_fma_f32 v[130:131], v[90:91], v[78:79], v[130:131]
    v_lshlrev_b32 v92, 16, v42
    v_and_b32 v93, s72, v42
    v_lshlrev_b32 v94, 16, v43
    v_and_b32 v95, s72, v43
    v_pk_fma_f32 v[128:129], v[92:93], v[72:73], v[128:129]
    v_pk_fma_f32 v[130:131], v[94:95], v[74:75], v[130:131]
    s_waitcnt vmcnt(1)
    v_lshlrev_b32 v136, 16, v58
    v_and_b32 v137, s72, v58
    v_lshlrev_b32 v138, 16, v59
    v_and_b32 v139, s72, v59
    v_pk_mul_f32 v[128:129], v[128:129], v[136:137]
    v_pk_mul_f32 v[130:131], v[130:131], v[138:139]
    v_cvt_pk_bf16_f32 v148, v128, v112
    ds_write_b32 v156, v148 offset:32
    v_cvt_pk_bf16_f32 v149, v129, v113
    ds_write_b32 v156, v149 offset:96
    v_cvt_pk_bf16_f32 v150, v130, v114
    ds_write_b32 v156, v150 offset:160
    v_cvt_pk_bf16_f32 v151, v131, v115
    ds_write_b32 v156, v151 offset:224
    v_pk_mul_f32 v[132:133], v[100:101], v[84:85]
    v_pk_mul_f32 v[134:135], v[102:103], v[86:87]
    v_pk_fma_f32 v[132:133], v[88:89], v[80:81], v[132:133]
    v_pk_fma_f32 v[134:135], v[90:91], v[82:83], v[134:135]
    v_pk_fma_f32 v[132:133], v[92:93], v[76:77], v[132:133]
    v_pk_fma_f32 v[134:135], v[94:95], v[78:79], v[134:135]
    v_lshlrev_b32 v96, 16, v44
    v_and_b32 v97, s72, v44
    v_lshlrev_b32 v98, 16, v45
    v_and_b32 v99, s72, v45
    v_pk_fma_f32 v[132:133], v[96:97], v[72:73], v[132:133]
    v_pk_fma_f32 v[134:135], v[98:99], v[74:75], v[134:135]
    s_waitcnt vmcnt(0)
    v_lshlrev_b32 v136, 16, v60
    v_and_b32 v137, s72, v60
    v_lshlrev_b32 v138, 16, v61
    v_and_b32 v139, s72, v61
    v_pk_mul_f32 v[132:133], v[132:133], v[136:137]
    v_pk_mul_f32 v[134:135], v[134:135], v[138:139]
    v_cvt_pk_bf16_f32 v152, v132, v116
    ds_write_b32 v156, v152 offset:48
    v_cvt_pk_bf16_f32 v153, v133, v117
    ds_write_b32 v156, v153 offset:112
    v_cvt_pk_bf16_f32 v154, v134, v118
    ds_write_b32 v156, v154 offset:176
    v_cvt_pk_bf16_f32 v155, v135, v119
    ds_write_b32 v156, v155 offset:240
    ds_read_b128 v[24:27], v157 offset:0
    ds_read_b128 v[28:31], v157 offset:1088
    ds_read_b128 v[32:35], v157 offset:2176
    ds_read_b128 v[36:39], v157 offset:3264
    s_mov_b32 s72, 0
    s_waitcnt lgkmcnt(3)
    buffer_store_dwordx4 v[24:27], v158, s[60:63], s72 offen sc1
    s_add_u32 s72, s72, 66560
    s_waitcnt lgkmcnt(2)
    buffer_store_dwordx4 v[28:31], v158, s[60:63], s72 offen sc1
    s_add_u32 s72, s72, 66560
    s_waitcnt lgkmcnt(1)
    buffer_store_dwordx4 v[32:35], v158, s[60:63], s72 offen sc1
    s_add_u32 s72, s72, 66560
    s_waitcnt lgkmcnt(0)
    buffer_store_dwordx4 v[36:39], v158, s[60:63], s72 offen sc1
    s_mov_b32 s56, s38
    s_and_b32 s57, s39, 0xffff
    s_mov_b32 s58, 256
    s_mov_b32 s59, 0x00020000
    buffer_load_dword v253, off, s[56:59], 0 sc1
Lpp_21:
    s_mov_b32 s56, s38
    s_and_b32 s57, s39, 0xffff
    s_mov_b32 s58, 256
    s_mov_b32 s59, 0x00020000
    s_waitcnt lgkmcnt(0)
    s_barrier
    ds_read_b128 v[104:107], v12 offset:0
    ds_read_b64_tr_b16 v[136:137], v14 offset:0
    ds_read_b64_tr_b16 v[138:139], v14 offset:1280
    ds_read_b128 v[108:111], v12 offset:2048
    ds_read_b128 v[112:115], v12 offset:4096
    ds_read_b128 v[116:119], v12 offset:6144
    ds_read_b64_tr_b16 v[140:141], v15 offset:32
    ds_read_b64_tr_b16 v[142:143], v15 offset:1312
    ds_read_b64_tr_b16 v[144:145], v14 offset:64
    ds_read_b64_tr_b16 v[146:147], v14 offset:1344
    ds_read_b64_tr_b16 v[148:149], v15 offset:96
    ds_read_b64_tr_b16 v[150:151], v15 offset:1376
    ds_read_b64_tr_b16 v[152:153], v14 offset:128
    ds_read_b64_tr_b16 v[154:155], v14 offset:1408
    s_waitcnt lgkmcnt(11)
    v_mfma_f32_16x16x32_bf16 v[24:27], v[136:139], v[104:107], 0
    ds_read_b128 v[120:123], v13 offset:0
    s_waitcnt lgkmcnt(11)
    v_mfma_f32_16x16x32_bf16 v[44:47], v[136:139], v[108:111], 0
    ds_read_b64_tr_b16 v[156:157], v14 offset:10240
    s_waitcnt lgkmcnt(11)
    v_mfma_f32_16x16x32_bf16 v[64:67], v[136:139], v[112:115], 0
    ds_read_b64_tr_b16 v[158:159], v14 offset:11520
    s_waitcnt lgkmcnt(11)
    v_mfma_f32_16x16x32_bf16 v[84:87], v[136:139], v[116:119], 0
    s_waitcnt lgkmcnt(9)
    v_mfma_f32_16x16x32_bf16 v[28:31], v[140:143], v[104:107], 0
    ds_read_b128 v[124:127], v13 offset:2048
    v_mfma_f32_16x16x32_bf16 v[48:51], v[140:143], v[108:111], 0
    ds_read_b128 v[128:131], v13 offset:4096
    v_mfma_f32_16x16x32_bf16 v[68:71], v[140:143], v[112:115], 0
    v_mfma_f32_16x16x32_bf16 v[88:91], v[140:143], v[116:119], 0
    ds_read_b128 v[132:135], v13 offset:6144
    s_waitcnt lgkmcnt(10)
    v_mfma_f32_16x16x32_bf16 v[32:35], v[144:147], v[104:107], 0
    ds_read_b64_tr_b16 v[160:161], v15 offset:10272
    v_mfma_f32_16x16x32_bf16 v[52:55], v[144:147], v[108:111], 0
    v_mfma_f32_16x16x32_bf16 v[72:75], v[144:147], v[112:115], 0
    ds_read_b64_tr_b16 v[162:163], v15 offset:11552
    v_mfma_f32_16x16x32_bf16 v[92:95], v[144:147], v[116:119], 0
    ds_read_b64_tr_b16 v[164:165], v14 offset:10304
    s_waitcnt lgkmcnt(11)
    v_mfma_f32_16x16x32_bf16 v[36:39], v[148:151], v[104:107], 0
    ds_read_b64_tr_b16 v[166:167], v14 offset:11584
    v_mfma_f32_16x16x32_bf16 v[56:59], v[148:151], v[108:111], 0
    v_mfma_f32_16x16x32_bf16 v[76:79], v[148:151], v[112:115], 0
    ds_read_b64_tr_b16 v[168:169], v15 offset:10336
    v_mfma_f32_16x16x32_bf16 v[96:99], v[148:151], v[116:119], 0
    ds_read_b64_tr_b16 v[170:171], v15 offset:11616
    s_waitcnt lgkmcnt(12)
    v_mfma_f32_16x16x32_bf16 v[40:43], v[152:155], v[104:107], 0
    v_mfma_f32_16x16x32_bf16 v[60:63], v[152:155], v[108:111], 0
    ds_read_b64_tr_b16 v[172:173], v14 offset:10368
    v_mfma_f32_16x16x32_bf16 v[80:83], v[152:155], v[112:115], 0
    ds_read_b64_tr_b16 v[174:175], v14 offset:11648
    v_mfma_f32_16x16x32_bf16 v[100:103], v[152:155], v[116:119], 0
    s_waitcnt lgkmcnt(11)
    v_mfma_f32_16x16x32_bf16 v[24:27], v[156:159], v[120:123], v[24:27]
    s_waitcnt lgkmcnt(10)
    v_mfma_f32_16x16x32_bf16 v[44:47], v[156:159], v[124:127], v[44:47]
    s_waitcnt lgkmcnt(9)
    v_mfma_f32_16x16x32_bf16 v[64:67], v[156:159], v[128:131], v[64:67]
    s_waitcnt lgkmcnt(8)
    v_mfma_f32_16x16x32_bf16 v[84:87], v[156:159], v[132:135], v[84:87]
    s_waitcnt lgkmcnt(6)
    v_mfma_f32_16x16x32_bf16 v[28:31], v[160:163], v[120:123], v[28:31]
    v_mfma_f32_16x16x32_bf16 v[48:51], v[160:163], v[124:127], v[48:51]
    v_mfma_f32_16x16x32_bf16 v[68:71], v[160:163], v[128:131], v[68:71]
    v_mfma_f32_16x16x32_bf16 v[88:91], v[160:163], v[132:135], v[88:91]
    s_waitcnt lgkmcnt(0)
    s_barrier
    v_mfma_f32_16x16x32_bf16 v[32:35], v[164:167], v[120:123], v[32:35]
    ds_read_b128 v[104:107], v12 offset:36864
    ds_read_b64_tr_b16 v[136:137], v14 offset:36864
    v_mfma_f32_16x16x32_bf16 v[52:55], v[164:167], v[124:127], v[52:55]
    ds_read_b64_tr_b16 v[138:139], v14 offset:38144
    v_mfma_f32_16x16x32_bf16 v[72:75], v[164:167], v[128:131], v[72:75]
    ds_read_b128 v[108:111], v12 offset:38912
    v_mfma_f32_16x16x32_bf16 v[92:95], v[164:167], v[132:135], v[92:95]
    ds_read_b128 v[112:115], v12 offset:40960
    v_mfma_f32_16x16x32_bf16 v[36:39], v[168:171], v[120:123], v[36:39]
    ds_read_b128 v[116:119], v12 offset:43008
    v_mfma_f32_16x16x32_bf16 v[56:59], v[168:171], v[124:127], v[56:59]
    ds_read_b64_tr_b16 v[140:141], v15 offset:36896
    v_mfma_f32_16x16x32_bf16 v[76:79], v[168:171], v[128:131], v[76:79]
    ds_read_b64_tr_b16 v[142:143], v15 offset:38176
    ds_read_b64_tr_b16 v[144:145], v14 offset:36928
    v_mfma_f32_16x16x32_bf16 v[96:99], v[168:171], v[132:135], v[96:99]
    ds_read_b64_tr_b16 v[146:147], v14 offset:38208
    v_mfma_f32_16x16x32_bf16 v[40:43], v[172:175], v[120:123], v[40:43]
    ds_read_b64_tr_b16 v[148:149], v15 offset:36960
    v_mfma_f32_16x16x32_bf16 v[60:63], v[172:175], v[124:127], v[60:63]
    ds_read_b64_tr_b16 v[150:151], v15 offset:38240
    v_mfma_f32_16x16x32_bf16 v[80:83], v[172:175], v[128:131], v[80:83]
    ds_read_b64_tr_b16 v[152:153], v14 offset:36992
    v_mfma_f32_16x16x32_bf16 v[100:103], v[172:175], v[132:135], v[100:103]
    ds_read_b64_tr_b16 v[154:155], v14 offset:38272
    s_waitcnt lgkmcnt(11)
    v_mfma_f32_16x16x32_bf16 v[24:27], v[136:139], v[104:107], v[24:27]
    ds_read_b128 v[120:123], v13 offset:36864
    s_waitcnt lgkmcnt(11)
    v_mfma_f32_16x16x32_bf16 v[44:47], v[136:139], v[108:111], v[44:47]
    ds_read_b64_tr_b16 v[156:157], v14 offset:47104
    s_waitcnt lgkmcnt(11)
    v_mfma_f32_16x16x32_bf16 v[64:67], v[136:139], v[112:115], v[64:67]
    ds_read_b64_tr_b16 v[158:159], v14 offset:48384
    s_waitcnt lgkmcnt(11)
    v_mfma_f32_16x16x32_bf16 v[84:87], v[136:139], v[116:119], v[84:87]
    s_waitcnt lgkmcnt(9)
    v_mfma_f32_16x16x32_bf16 v[28:31], v[140:143], v[104:107], v[28:31]
    ds_read_b128 v[124:127], v13 offset:38912
    v_mfma_f32_16x16x32_bf16 v[48:51], v[140:143], v[108:111], v[48:51]
    ds_read_b128 v[128:131], v13 offset:40960
    v_mfma_f32_16x16x32_bf16 v[68:71], v[140:143], v[112:115], v[68:71]
    v_mfma_f32_16x16x32_bf16 v[88:91], v[140:143], v[116:119], v[88:91]
    ds_read_b128 v[132:135], v13 offset:43008
    s_waitcnt lgkmcnt(10)
    v_mfma_f32_16x16x32_bf16 v[32:35], v[144:147], v[104:107], v[32:35]
    ds_read_b64_tr_b16 v[160:161], v15 offset:47136
    v_mfma_f32_16x16x32_bf16 v[52:55], v[144:147], v[108:111], v[52:55]
    v_mfma_f32_16x16x32_bf16 v[72:75], v[144:147], v[112:115], v[72:75]
    ds_read_b64_tr_b16 v[162:163], v15 offset:48416
    v_mfma_f32_16x16x32_bf16 v[92:95], v[144:147], v[116:119], v[92:95]
    ds_read_b64_tr_b16 v[164:165], v14 offset:47168
    s_waitcnt lgkmcnt(11)
    v_mfma_f32_16x16x32_bf16 v[36:39], v[148:151], v[104:107], v[36:39]
    ds_read_b64_tr_b16 v[166:167], v14 offset:48448
    v_mfma_f32_16x16x32_bf16 v[56:59], v[148:151], v[108:111], v[56:59]
    v_mfma_f32_16x16x32_bf16 v[76:79], v[148:151], v[112:115], v[76:79]
    ds_read_b64_tr_b16 v[168:169], v15 offset:47200
    v_mfma_f32_16x16x32_bf16 v[96:99], v[148:151], v[116:119], v[96:99]
    ds_read_b64_tr_b16 v[170:171], v15 offset:48480
    s_waitcnt lgkmcnt(12)
    v_mfma_f32_16x16x32_bf16 v[40:43], v[152:155], v[104:107], v[40:43]
    v_mfma_f32_16x16x32_bf16 v[60:63], v[152:155], v[108:111], v[60:63]
    ds_read_b64_tr_b16 v[172:173], v14 offset:47232
    v_mfma_f32_16x16x32_bf16 v[80:83], v[152:155], v[112:115], v[80:83]
    ds_read_b64_tr_b16 v[174:175], v14 offset:48512
    v_mfma_f32_16x16x32_bf16 v[100:103], v[152:155], v[116:119], v[100:103]
    s_waitcnt lgkmcnt(11)
    v_mfma_f32_16x16x32_bf16 v[24:27], v[156:159], v[120:123], v[24:27]
    s_waitcnt lgkmcnt(10)
    v_mfma_f32_16x16x32_bf16 v[44:47], v[156:159], v[124:127], v[44:47]
    s_waitcnt lgkmcnt(9)
    v_mfma_f32_16x16x32_bf16 v[64:67], v[156:159], v[128:131], v[64:67]
    s_waitcnt lgkmcnt(8)
    v_mfma_f32_16x16x32_bf16 v[84:87], v[156:159], v[132:135], v[84:87]
    s_waitcnt lgkmcnt(6)
    v_mfma_f32_16x16x32_bf16 v[28:31], v[160:163], v[120:123], v[28:31]
    v_mfma_f32_16x16x32_bf16 v[48:51], v[160:163], v[124:127], v[48:51]
    v_mfma_f32_16x16x32_bf16 v[68:71], v[160:163], v[128:131], v[68:71]
    v_mfma_f32_16x16x32_bf16 v[88:91], v[160:163], v[132:135], v[88:91]
    s_waitcnt lgkmcnt(0)
    s_barrier
    v_mfma_f32_16x16x32_bf16 v[32:35], v[164:167], v[120:123], v[32:35]
    ds_read_b128 v[104:107], v16 offset:0
    ds_read_b64_tr_b16 v[136:137], v18 offset:0
    v_mfma_f32_16x16x32_bf16 v[52:55], v[164:167], v[124:127], v[52:55]
    ds_read_b64_tr_b16 v[138:139], v18 offset:1280
    v_mfma_f32_16x16x32_bf16 v[72:75], v[164:167], v[128:131], v[72:75]
    ds_read_b128 v[108:111], v16 offset:2048
    v_mfma_f32_16x16x32_bf16 v[92:95], v[164:167], v[132:135], v[92:95]
    ds_read_b128 v[112:115], v16 offset:4096
    v_mfma_f32_16x16x32_bf16 v[36:39], v[168:171], v[120:123], v[36:39]
    ds_read_b128 v[116:119], v16 offset:6144
    v_mfma_f32_16x16x32_bf16 v[56:59], v[168:171], v[124:127], v[56:59]
    ds_read_b64_tr_b16 v[140:141], v19 offset:32
    v_mfma_f32_16x16x32_bf16 v[76:79], v[168:171], v[128:131], v[76:79]
    ds_read_b64_tr_b16 v[142:143], v19 offset:1312
    ds_read_b64_tr_b16 v[144:145], v18 offset:64
    v_mfma_f32_16x16x32_bf16 v[96:99], v[168:171], v[132:135], v[96:99]
    ds_read_b64_tr_b16 v[146:147], v18 offset:1344
    v_mfma_f32_16x16x32_bf16 v[40:43], v[172:175], v[120:123], v[40:43]
    ds_read_b64_tr_b16 v[148:149], v19 offset:96
    v_mfma_f32_16x16x32_bf16 v[60:63], v[172:175], v[124:127], v[60:63]
    ds_read_b64_tr_b16 v[150:151], v19 offset:1376
    v_mfma_f32_16x16x32_bf16 v[80:83], v[172:175], v[128:131], v[80:83]
    ds_read_b64_tr_b16 v[152:153], v18 offset:128
    v_mfma_f32_16x16x32_bf16 v[100:103], v[172:175], v[132:135], v[100:103]
    ds_read_b64_tr_b16 v[154:155], v18 offset:1408
    s_waitcnt lgkmcnt(11)
    v_mfma_f32_16x16x32_bf16 v[24:27], v[136:139], v[104:107], v[24:27]
    ds_read_b128 v[120:123], v17 offset:0
    s_waitcnt lgkmcnt(11)
    v_mfma_f32_16x16x32_bf16 v[44:47], v[136:139], v[108:111], v[44:47]
    ds_read_b64_tr_b16 v[156:157], v18 offset:10240
    s_waitcnt lgkmcnt(11)
    v_mfma_f32_16x16x32_bf16 v[64:67], v[136:139], v[112:115], v[64:67]
    ds_read_b64_tr_b16 v[158:159], v18 offset:11520
    s_waitcnt lgkmcnt(11)
    v_mfma_f32_16x16x32_bf16 v[84:87], v[136:139], v[116:119], v[84:87]
    s_waitcnt lgkmcnt(9)
    v_mfma_f32_16x16x32_bf16 v[28:31], v[140:143], v[104:107], v[28:31]
    ds_read_b128 v[124:127], v17 offset:2048
    v_mfma_f32_16x16x32_bf16 v[48:51], v[140:143], v[108:111], v[48:51]
    ds_read_b128 v[128:131], v17 offset:4096
    v_mfma_f32_16x16x32_bf16 v[68:71], v[140:143], v[112:115], v[68:71]
    v_mfma_f32_16x16x32_bf16 v[88:91], v[140:143], v[116:119], v[88:91]
    ds_read_b128 v[132:135], v17 offset:6144
    s_waitcnt lgkmcnt(10)
    v_mfma_f32_16x16x32_bf16 v[32:35], v[144:147], v[104:107], v[32:35]
    ds_read_b64_tr_b16 v[160:161], v19 offset:10272
    v_mfma_f32_16x16x32_bf16 v[52:55], v[144:147], v[108:111], v[52:55]
    v_mfma_f32_16x16x32_bf16 v[72:75], v[144:147], v[112:115], v[72:75]
    ds_read_b64_tr_b16 v[162:163], v19 offset:11552
    v_mfma_f32_16x16x32_bf16 v[92:95], v[144:147], v[116:119], v[92:95]
    ds_read_b64_tr_b16 v[164:165], v18 offset:10304
    s_waitcnt lgkmcnt(11)
    v_mfma_f32_16x16x32_bf16 v[36:39], v[148:151], v[104:107], v[36:39]
    ds_read_b64_tr_b16 v[166:167], v18 offset:11584
    v_mfma_f32_16x16x32_bf16 v[56:59], v[148:151], v[108:111], v[56:59]
    v_mfma_f32_16x16x32_bf16 v[76:79], v[148:151], v[112:115], v[76:79]
    ds_read_b64_tr_b16 v[168:169], v19 offset:10336
    v_mfma_f32_16x16x32_bf16 v[96:99], v[148:151], v[116:119], v[96:99]
    ds_read_b64_tr_b16 v[170:171], v19 offset:11616
    s_waitcnt lgkmcnt(12)
    v_mfma_f32_16x16x32_bf16 v[40:43], v[152:155], v[104:107], v[40:43]
    v_mfma_f32_16x16x32_bf16 v[60:63], v[152:155], v[108:111], v[60:63]
    ds_read_b64_tr_b16 v[172:173], v18 offset:10368
    v_mfma_f32_16x16x32_bf16 v[80:83], v[152:155], v[112:115], v[80:83]
    ds_read_b64_tr_b16 v[174:175], v18 offset:11648
    v_mfma_f32_16x16x32_bf16 v[100:103], v[152:155], v[116:119], v[100:103]
    s_waitcnt lgkmcnt(11)
    v_mfma_f32_16x16x32_bf16 v[24:27], v[156:159], v[120:123], v[24:27]
    s_waitcnt lgkmcnt(10)
    v_mfma_f32_16x16x32_bf16 v[44:47], v[156:159], v[124:127], v[44:47]
    s_waitcnt lgkmcnt(9)
    v_mfma_f32_16x16x32_bf16 v[64:67], v[156:159], v[128:131], v[64:67]
    s_waitcnt lgkmcnt(8)
    v_mfma_f32_16x16x32_bf16 v[84:87], v[156:159], v[132:135], v[84:87]
    s_waitcnt lgkmcnt(6)
    v_mfma_f32_16x16x32_bf16 v[28:31], v[160:163], v[120:123], v[28:31]
    v_mfma_f32_16x16x32_bf16 v[48:51], v[160:163], v[124:127], v[48:51]
    v_mfma_f32_16x16x32_bf16 v[68:71], v[160:163], v[128:131], v[68:71]
    v_mfma_f32_16x16x32_bf16 v[88:91], v[160:163], v[132:135], v[88:91]
    s_waitcnt lgkmcnt(0)
    s_cmp_eq_u32 s3, 1
    s_cbranch_scc0 Lw1_22
    s_waitcnt vmcnt(0)
Lw1_22:
    s_barrier
    v_mfma_f32_16x16x32_bf16 v[32:35], v[164:167], v[120:123], v[32:35]
    ds_read_b128 v[104:107], v12 offset:0
    ds_read_b64_tr_b16 v[136:137], v14 offset:0
    v_mfma_f32_16x16x32_bf16 v[52:55], v[164:167], v[124:127], v[52:55]
    ds_read_b64_tr_b16 v[138:139], v14 offset:1280
    v_mfma_f32_16x16x32_bf16 v[72:75], v[164:167], v[128:131], v[72:75]
    ds_read_b128 v[108:111], v12 offset:2048
    v_mfma_f32_16x16x32_bf16 v[92:95], v[164:167], v[132:135], v[92:95]
    ds_read_b128 v[112:115], v12 offset:4096
    v_mfma_f32_16x16x32_bf16 v[36:39], v[168:171], v[120:123], v[36:39]
    ds_read_b128 v[116:119], v12 offset:6144
    v_mfma_f32_16x16x32_bf16 v[56:59], v[168:171], v[124:127], v[56:59]
    ds_read_b64_tr_b16 v[140:141], v15 offset:32
    v_mfma_f32_16x16x32_bf16 v[76:79], v[168:171], v[128:131], v[76:79]
    ds_read_b64_tr_b16 v[142:143], v15 offset:1312
    ds_read_b64_tr_b16 v[144:145], v14 offset:64
    v_mfma_f32_16x16x32_bf16 v[96:99], v[168:171], v[132:135], v[96:99]
    ds_read_b64_tr_b16 v[146:147], v14 offset:1344
    v_mfma_f32_16x16x32_bf16 v[40:43], v[172:175], v[120:123], v[40:43]
    ds_read_b64_tr_b16 v[148:149], v15 offset:96
    v_mfma_f32_16x16x32_bf16 v[60:63], v[172:175], v[124:127], v[60:63]
    ds_read_b64_tr_b16 v[150:151], v15 offset:1376
    v_mfma_f32_16x16x32_bf16 v[80:83], v[172:175], v[128:131], v[80:83]
    ds_read_b64_tr_b16 v[152:153], v14 offset:128
    v_mfma_f32_16x16x32_bf16 v[100:103], v[172:175], v[132:135], v[100:103]
    ds_read_b64_tr_b16 v[154:155], v14 offset:1408
    s_waitcnt lgkmcnt(11)
    v_mfma_f32_16x16x32_bf16 v[24:27], v[136:139], v[104:107], v[24:27]
    ds_read_b128 v[120:123], v13 offset:0
    s_waitcnt lgkmcnt(11)
    v_mfma_f32_16x16x32_bf16 v[44:47], v[136:139], v[108:111], v[44:47]
    ds_read_b64_tr_b16 v[156:157], v14 offset:10240
    s_waitcnt lgkmcnt(11)
    v_mfma_f32_16x16x32_bf16 v[64:67], v[136:139], v[112:115], v[64:67]
    ds_read_b64_tr_b16 v[158:159], v14 offset:11520
    s_waitcnt lgkmcnt(11)
    v_mfma_f32_16x16x32_bf16 v[84:87], v[136:139], v[116:119], v[84:87]
    s_waitcnt lgkmcnt(9)
    v_mfma_f32_16x16x32_bf16 v[28:31], v[140:143], v[104:107], v[28:31]
    ds_read_b128 v[124:127], v13 offset:2048
    v_mfma_f32_16x16x32_bf16 v[48:51], v[140:143], v[108:111], v[48:51]
    ds_read_b128 v[128:131], v13 offset:4096
    v_mfma_f32_16x16x32_bf16 v[68:71], v[140:143], v[112:115], v[68:71]
    v_mfma_f32_16x16x32_bf16 v[88:91], v[140:143], v[116:119], v[88:91]
    ds_read_b128 v[132:135], v13 offset:6144
    s_waitcnt lgkmcnt(10)
    v_mfma_f32_16x16x32_bf16 v[32:35], v[144:147], v[104:107], v[32:35]
    ds_read_b64_tr_b16 v[160:161], v15 offset:10272
    v_mfma_f32_16x16x32_bf16 v[52:55], v[144:147], v[108:111], v[52:55]
    v_mfma_f32_16x16x32_bf16 v[72:75], v[144:147], v[112:115], v[72:75]
    ds_read_b64_tr_b16 v[162:163], v15 offset:11552
    v_mfma_f32_16x16x32_bf16 v[92:95], v[144:147], v[116:119], v[92:95]
    ds_read_b64_tr_b16 v[164:165], v14 offset:10304
    s_waitcnt lgkmcnt(11)
    v_mfma_f32_16x16x32_bf16 v[36:39], v[148:151], v[104:107], v[36:39]
    ds_read_b64_tr_b16 v[166:167], v14 offset:11584
    v_mfma_f32_16x16x32_bf16 v[56:59], v[148:151], v[108:111], v[56:59]
    v_mfma_f32_16x16x32_bf16 v[76:79], v[148:151], v[112:115], v[76:79]
    ds_read_b64_tr_b16 v[168:169], v15 offset:10336
    v_mfma_f32_16x16x32_bf16 v[96:99], v[148:151], v[116:119], v[96:99]
    ds_read_b64_tr_b16 v[170:171], v15 offset:11616
    s_waitcnt lgkmcnt(12)
    v_mfma_f32_16x16x32_bf16 v[40:43], v[152:155], v[104:107], v[40:43]
    v_mfma_f32_16x16x32_bf16 v[60:63], v[152:155], v[108:111], v[60:63]
    ds_read_b64_tr_b16 v[172:173], v14 offset:10368
    v_mfma_f32_16x16x32_bf16 v[80:83], v[152:155], v[112:115], v[80:83]
    ds_read_b64_tr_b16 v[174:175], v14 offset:11648
    v_mfma_f32_16x16x32_bf16 v[100:103], v[152:155], v[116:119], v[100:103]
    s_waitcnt lgkmcnt(11)
    v_mfma_f32_16x16x32_bf16 v[24:27], v[156:159], v[120:123], v[24:27]
    s_waitcnt lgkmcnt(10)
    v_mfma_f32_16x16x32_bf16 v[44:47], v[156:159], v[124:127], v[44:47]
    s_waitcnt lgkmcnt(9)
    v_mfma_f32_16x16x32_bf16 v[64:67], v[156:159], v[128:131], v[64:67]
    s_waitcnt lgkmcnt(8)
    v_mfma_f32_16x16x32_bf16 v[84:87], v[156:159], v[132:135], v[84:87]
    s_waitcnt lgkmcnt(6)
    v_mfma_f32_16x16x32_bf16 v[28:31], v[160:163], v[120:123], v[28:31]
    v_mfma_f32_16x16x32_bf16 v[48:51], v[160:163], v[124:127], v[48:51]
    v_mfma_f32_16x16x32_bf16 v[68:71], v[160:163], v[128:131], v[68:71]
    v_mfma_f32_16x16x32_bf16 v[88:91], v[160:163], v[132:135], v[88:91]
    s_waitcnt lgkmcnt(0)
    s_cmp_eq_u32 s3, 0
    s_cbranch_scc0 Lwf_23
    s_waitcnt vmcnt(0)
    v_cmp_eq_u32 vcc, 0, v253
    s_cbranch_vccz Lwn_24
    s_mov_b32 s81, 100000
Lspin_25:
    buffer_load_dword v253, off, s[56:59], 0 sc1
    s_waitcnt vmcnt(0)
    v_cmp_eq_u32 vcc, 0, v253
    s_cbranch_vccz Lspun_26
    s_sleep 8
    s_sub_u32 s81, s81, 1
    s_cbranch_scc0 Lspin_25
Lspun_26:
Lwn_24:
    s_lshl_b32 s72, s2, 7
    s_add_u32 s72, s72, 3964928
    s_mov_b64 exec, 1
    buffer_store_dword v253, off, s[60:63], s72 sc1
    s_mov_b64 exec, -1
Lwf_23:
    buffer_load_dword v253, off, s[56:59], 0 sc1
    s_barrier
    v_mfma_f32_16x16x32_bf16 v[32:35], v[164:167], v[120:123], v[32:35]
    ds_read_b128 v[104:107], v12 offset:36864
    ds_read_b64_tr_b16 v[136:137], v14 offset:36864
    v_mfma_f32_16x16x32_bf16 v[52:55], v[164:167], v[124:127], v[52:55]
    ds_read_b64_tr_b16 v[138:139], v14 offset:38144
    v_mfma_f32_16x16x32_bf16 v[72:75], v[164:167], v[128:131], v[72:75]
    ds_read_b128 v[108:111], v12 offset:38912
    v_mfma_f32_16x16x32_bf16 v[92:95], v[164:167], v[132:135], v[92:95]
    ds_read_b128 v[112:115], v12 offset:40960
    v_mfma_f32_16x16x32_bf16 v[36:39], v[168:171], v[120:123], v[36:39]
    ds_read_b128 v[116:119], v12 offset:43008
    v_mfma_f32_16x16x32_bf16 v[56:59], v[168:171], v[124:127], v[56:59]
    ds_read_b64_tr_b16 v[140:141], v15 offset:36896
    v_mfma_f32_16x16x32_bf16 v[76:79], v[168:171], v[128:131], v[76:79]
    ds_read_b64_tr_b16 v[142:143], v15 offset:38176
    ds_read_b64_tr_b16 v[144:145], v14 offset:36928
    v_mfma_f32_16x16x32_bf16 v[96:99], v[168:171], v[132:135], v[96:99]
    ds_read_b64_tr_b16 v[146:147], v14 offset:38208
    v_mfma_f32_16x16x32_bf16 v[40:43], v[172:175], v[120:123], v[40:43]
    ds_read_b64_tr_b16 v[148:149], v15 offset:36960
    v_mfma_f32_16x16x32_bf16 v[60:63], v[172:175], v[124:127], v[60:63]
    ds_read_b64_tr_b16 v[150:151], v15 offset:38240
    v_mfma_f32_16x16x32_bf16 v[80:83], v[172:175], v[128:131], v[80:83]
    ds_read_b64_tr_b16 v[152:153], v14 offset:36992
    v_mfma_f32_16x16x32_bf16 v[100:103], v[172:175], v[132:135], v[100:103]
    ds_read_b64_tr_b16 v[154:155], v14 offset:38272
    s_waitcnt lgkmcnt(11)
    v_mfma_f32_16x16x32_bf16 v[24:27], v[136:139], v[104:107], v[24:27]
    ds_read_b128 v[120:123], v13 offset:36864
    s_waitcnt lgkmcnt(11)
    v_mfma_f32_16x16x32_bf16 v[44:47], v[136:139], v[108:111], v[44:47]
    ds_read_b64_tr_b16 v[156:157], v14 offset:47104
    s_waitcnt lgkmcnt(11)
    v_mfma_f32_16x16x32_bf16 v[64:67], v[136:139], v[112:115], v[64:67]
    ds_read_b64_tr_b16 v[158:159], v14 offset:48384
    s_waitcnt lgkmcnt(11)
    v_mfma_f32_16x16x32_bf16 v[84:87], v[136:139], v[116:119], v[84:87]
    s_waitcnt lgkmcnt(9)
    v_mfma_f32_16x16x32_bf16 v[28:31], v[140:143], v[104:107], v[28:31]
    ds_read_b128 v[124:127], v13 offset:38912
    v_mfma_f32_16x16x32_bf16 v[48:51], v[140:143], v[108:111], v[48:51]
    ds_read_b128 v[128:131], v13 offset:40960
    v_mfma_f32_16x16x32_bf16 v[68:71], v[140:143], v[112:115], v[68:71]
    v_mfma_f32_16x16x32_bf16 v[88:91], v[140:143], v[116:119], v[88:91]
    ds_read_b128 v[132:135], v13 offset:43008
    s_waitcnt lgkmcnt(10)
    v_mfma_f32_16x16x32_bf16 v[32:35], v[144:147], v[104:107], v[32:35]
    ds_read_b64_tr_b16 v[160:161], v15 offset:47136
    v_mfma_f32_16x16x32_bf16 v[52:55], v[144:147], v[108:111], v[52:55]
    v_mfma_f32_16x16x32_bf16 v[72:75], v[144:147], v[112:115], v[72:75]
    ds_read_b64_tr_b16 v[162:163], v15 offset:48416
    v_mfma_f32_16x16x32_bf16 v[92:95], v[144:147], v[116:119], v[92:95]
    ds_read_b64_tr_b16 v[164:165], v14 offset:47168
    s_waitcnt lgkmcnt(11)
    v_mfma_f32_16x16x32_bf16 v[36:39], v[148:151], v[104:107], v[36:39]
    ds_read_b64_tr_b16 v[166:167], v14 offset:48448
    v_mfma_f32_16x16x32_bf16 v[56:59], v[148:151], v[108:111], v[56:59]
    v_mfma_f32_16x16x32_bf16 v[76:79], v[148:151], v[112:115], v[76:79]
    ds_read_b64_tr_b16 v[168:169], v15 offset:47200
    v_mfma_f32_16x16x32_bf16 v[96:99], v[148:151], v[116:119], v[96:99]
    ds_read_b64_tr_b16 v[170:171], v15 offset:48480
    s_waitcnt lgkmcnt(12)
    v_mfma_f32_16x16x32_bf16 v[40:43], v[152:155], v[104:107], v[40:43]
    v_mfma_f32_16x16x32_bf16 v[60:63], v[152:155], v[108:111], v[60:63]
    ds_read_b64_tr_b16 v[172:173], v14 offset:47232
    v_mfma_f32_16x16x32_bf16 v[80:83], v[152:155], v[112:115], v[80:83]
    ds_read_b64_tr_b16 v[174:175], v14 offset:48512
    v_mfma_f32_16x16x32_bf16 v[100:103], v[152:155], v[116:119], v[100:103]
    s_waitcnt lgkmcnt(11)
    v_mfma_f32_16x16x32_bf16 v[24:27], v[156:159], v[120:123], v[24:27]
    s_waitcnt lgkmcnt(10)
    v_mfma_f32_16x16x32_bf16 v[44:47], v[156:159], v[124:127], v[44:47]
    s_waitcnt lgkmcnt(9)
    v_mfma_f32_16x16x32_bf16 v[64:67], v[156:159], v[128:131], v[64:67]
    s_waitcnt lgkmcnt(8)
    v_mfma_f32_16x16x32_bf16 v[84:87], v[156:159], v[132:135], v[84:87]
    s_waitcnt lgkmcnt(6)
    v_mfma_f32_16x16x32_bf16 v[28:31], v[160:163], v[120:123], v[28:31]
    v_mfma_f32_16x16x32_bf16 v[48:51], v[160:163], v[124:127], v[48:51]
    v_mfma_f32_16x16x32_bf16 v[68:71], v[160:163], v[128:131], v[68:71]
    v_mfma_f32_16x16x32_bf16 v[88:91], v[160:163], v[132:135], v[88:91]
    s_waitcnt lgkmcnt(0)
    s_barrier
    v_mfma_f32_16x16x32_bf16 v[32:35], v[164:167], v[120:123], v[32:35]
    ds_read_b128 v[104:107], v16 offset:0
    ds_read_b64_tr_b16 v[136:137], v18 offset:0
    v_mfma_f32_16x16x32_bf16 v[52:55], v[164:167], v[124:127], v[52:55]
    ds_read_b64_tr_b16 v[138:139], v18 offset:1280
    v_mfma_f32_16x16x32_bf16 v[72:75], v[164:167], v[128:131], v[72:75]
    ds_read_b128 v[108:111], v16 offset:2048
    v_mfma_f32_16x16x32_bf16 v[92:95], v[164:167], v[132:135], v[92:95]
    ds_read_b128 v[112:115], v16 offset:4096
    v_mfma_f32_16x16x32_bf16 v[36:39], v[168:171], v[120:123], v[36:39]
    ds_read_b128 v[116:119], v16 offset:6144
    v_mfma_f32_16x16x32_bf16 v[56:59], v[168:171], v[124:127], v[56:59]
    ds_read_b64_tr_b16 v[140:141], v19 offset:32
    v_mfma_f32_16x16x32_bf16 v[76:79], v[168:171], v[128:131], v[76:79]
    ds_read_b64_tr_b16 v[142:143], v19 offset:1312
    ds_read_b64_tr_b16 v[144:145], v18 offset:64
    v_mfma_f32_16x16x32_bf16 v[96:99], v[168:171], v[132:135], v[96:99]
    ds_read_b64_tr_b16 v[146:147], v18 offset:1344
    v_mfma_f32_16x16x32_bf16 v[40:43], v[172:175], v[120:123], v[40:43]
    ds_read_b64_tr_b16 v[148:149], v19 offset:96
    v_mfma_f32_16x16x32_bf16 v[60:63], v[172:175], v[124:127], v[60:63]
    ds_read_b64_tr_b16 v[150:151], v19 offset:1376
    v_mfma_f32_16x16x32_bf16 v[80:83], v[172:175], v[128:131], v[80:83]
    ds_read_b64_tr_b16 v[152:153], v18 offset:128
    v_mfma_f32_16x16x32_bf16 v[100:103], v[172:175], v[132:135], v[100:103]
    ds_read_b64_tr_b16 v[154:155], v18 offset:1408
    s_waitcnt lgkmcnt(11)
    v_mfma_f32_16x16x32_bf16 v[24:27], v[136:139], v[104:107], v[24:27]
    ds_read_b128 v[120:123], v17 offset:0
    s_waitcnt lgkmcnt(11)
    v_mfma_f32_16x16x32_bf16 v[44:47], v[136:139], v[108:111], v[44:47]
    ds_read_b64_tr_b16 v[156:157], v18 offset:10240
    s_waitcnt lgkmcnt(11)
    v_mfma_f32_16x16x32_bf16 v[64:67], v[136:139], v[112:115], v[64:67]
    ds_read_b64_tr_b16 v[158:159], v18 offset:11520
    s_waitcnt lgkmcnt(11)
    v_mfma_f32_16x16x32_bf16 v[84:87], v[136:139], v[116:119], v[84:87]
    s_waitcnt lgkmcnt(9)
    v_mfma_f32_16x16x32_bf16 v[28:31], v[140:143], v[104:107], v[28:31]
    ds_read_b128 v[124:127], v17 offset:2048
    v_mfma_f32_16x16x32_bf16 v[48:51], v[140:143], v[108:111], v[48:51]
    ds_read_b128 v[128:131], v17 offset:4096
    v_mfma_f32_16x16x32_bf16 v[68:71], v[140:143], v[112:115], v[68:71]
    v_mfma_f32_16x16x32_bf16 v[88:91], v[140:143], v[116:119], v[88:91]
    ds_read_b128 v[132:135], v17 offset:6144
    s_waitcnt lgkmcnt(10)
    v_mfma_f32_16x16x32_bf16 v[32:35], v[144:147], v[104:107], v[32:35]
    ds_read_b64_tr_b16 v[160:161], v19 offset:10272
    v_mfma_f32_16x16x32_bf16 v[52:55], v[144:147], v[108:111], v[52:55]
    v_mfma_f32_16x16x32_bf16 v[72:75], v[144:147], v[112:115], v[72:75]
    ds_read_b64_tr_b16 v[162:163], v19 offset:11552
    v_mfma_f32_16x16x32_bf16 v[92:95], v[144:147], v[116:119], v[92:95]
    ds_read_b64_tr_b16 v[164:165], v18 offset:10304
    s_waitcnt lgkmcnt(11)
    v_mfma_f32_16x16x32_bf16 v[36:39], v[148:151], v[104:107], v[36:39]
    ds_read_b64_tr_b16 v[166:167], v18 offset:11584
    v_mfma_f32_16x16x32_bf16 v[56:59], v[148:151], v[108:111], v[56:59]
    v_mfma_f32_16x16x32_bf16 v[76:79], v[148:151], v[112:115], v[76:79]
    ds_read_b64_tr_b16 v[168:169], v19 offset:10336
    v_mfma_f32_16x16x32_bf16 v[96:99], v[148:151], v[116:119], v[96:99]
    ds_read_b64_tr_b16 v[170:171], v19 offset:11616
    s_waitcnt lgkmcnt(12)
    v_mfma_f32_16x16x32_bf16 v[40:43], v[152:155], v[104:107], v[40:43]
    v_mfma_f32_16x16x32_bf16 v[60:63], v[152:155], v[108:111], v[60:63]
    ds_read_b64_tr_b16 v[172:173], v18 offset:10368
    v_mfma_f32_16x16x32_bf16 v[80:83], v[152:155], v[112:115], v[80:83]
    ds_read_b64_tr_b16 v[174:175], v18 offset:11648
    v_mfma_f32_16x16x32_bf16 v[100:103], v[152:155], v[116:119], v[100:103]
    s_waitcnt lgkmcnt(11)
    v_mfma_f32_16x16x32_bf16 v[24:27], v[156:159], v[120:123], v[24:27]
    s_waitcnt lgkmcnt(10)
    v_mfma_f32_16x16x32_bf16 v[44:47], v[156:159], v[124:127], v[44:47]
    s_waitcnt lgkmcnt(9)
    v_mfma_f32_16x16x32_bf16 v[64:67], v[156:159], v[128:131], v[64:67]
    s_waitcnt lgkmcnt(8)
    v_mfma_f32_16x16x32_bf16 v[84:87], v[156:159], v[132:135], v[84:87]
    s_waitcnt lgkmcnt(6)
    v_mfma_f32_16x16x32_bf16 v[28:31], v[160:163], v[120:123], v[28:31]
    v_mfma_f32_16x16x32_bf16 v[48:51], v[160:163], v[124:127], v[48:51]
    v_mfma_f32_16x16x32_bf16 v[68:71], v[160:163], v[128:131], v[68:71]
    v_mfma_f32_16x16x32_bf16 v[88:91], v[160:163], v[132:135], v[88:91]
    s_waitcnt lgkmcnt(0)
    s_barrier
    v_mfma_f32_16x16x32_bf16 v[32:35], v[164:167], v[120:123], v[32:35]
    ds_read_b128 v[104:107], v12 offset:0
    ds_read_b64_tr_b16 v[136:137], v14 offset:0
    v_mfma_f32_16x16x32_bf16 v[52:55], v[164:167], v[124:127], v[52:55]
    ds_read_b64_tr_b16 v[138:139], v14 offset:1280
    v_mfma_f32_16x16x32_bf16 v[72:75], v[164:167], v[128:131], v[72:75]
    ds_read_b128 v[108:111], v12 offset:2048
    v_mfma_f32_16x16x32_bf16 v[92:95], v[164:167], v[132:135], v[92:95]
    ds_read_b128 v[112:115], v12 offset:4096
    v_mfma_f32_16x16x32_bf16 v[36:39], v[168:171], v[120:123], v[36:39]
    ds_read_b128 v[116:119], v12 offset:6144
    v_mfma_f32_16x16x32_bf16 v[56:59], v[168:171], v[124:127], v[56:59]
    ds_read_b64_tr_b16 v[140:141], v15 offset:32
    v_mfma_f32_16x16x32_bf16 v[76:79], v[168:171], v[128:131], v[76:79]
    ds_read_b64_tr_b16 v[142:143], v15 offset:1312
    ds_read_b64_tr_b16 v[144:145], v14 offset:64
    v_mfma_f32_16x16x32_bf16 v[96:99], v[168:171], v[132:135], v[96:99]
    ds_read_b64_tr_b16 v[146:147], v14 offset:1344
    v_mfma_f32_16x16x32_bf16 v[40:43], v[172:175], v[120:123], v[40:43]
    ds_read_b64_tr_b16 v[148:149], v15 offset:96
    v_mfma_f32_16x16x32_bf16 v[60:63], v[172:175], v[124:127], v[60:63]
    ds_read_b64_tr_b16 v[150:151], v15 offset:1376
    v_mfma_f32_16x16x32_bf16 v[80:83], v[172:175], v[128:131], v[80:83]
    ds_read_b64_tr_b16 v[152:153], v14 offset:128
    v_mfma_f32_16x16x32_bf16 v[100:103], v[172:175], v[132:135], v[100:103]
    ds_read_b64_tr_b16 v[154:155], v14 offset:1408
    s_waitcnt lgkmcnt(11)
    v_mfma_f32_16x16x32_bf16 v[24:27], v[136:139], v[104:107], v[24:27]
    ds_read_b128 v[120:123], v13 offset:0
    s_waitcnt lgkmcnt(11)
    v_mfma_f32_16x16x32_bf16 v[44:47], v[136:139], v[108:111], v[44:47]
    ds_read_b64_tr_b16 v[156:157], v14 offset:10240
    s_waitcnt lgkmcnt(11)
    v_mfma_f32_16x16x32_bf16 v[64:67], v[136:139], v[112:115], v[64:67]
    ds_read_b64_tr_b16 v[158:159], v14 offset:11520
    s_waitcnt lgkmcnt(11)
    v_mfma_f32_16x16x32_bf16 v[84:87], v[136:139], v[116:119], v[84:87]
    s_waitcnt lgkmcnt(9)
    v_mfma_f32_16x16x32_bf16 v[28:31], v[140:143], v[104:107], v[28:31]
    ds_read_b128 v[124:127], v13 offset:2048
    v_mfma_f32_16x16x32_bf16 v[48:51], v[140:143], v[108:111], v[48:51]
    ds_read_b128 v[128:131], v13 offset:4096
    v_mfma_f32_16x16x32_bf16 v[68:71], v[140:143], v[112:115], v[68:71]
    v_mfma_f32_16x16x32_bf16 v[88:91], v[140:143], v[116:119], v[88:91]
    ds_read_b128 v[132:135], v13 offset:6144
    s_waitcnt lgkmcnt(10)
    v_mfma_f32_16x16x32_bf16 v[32:35], v[144:147], v[104:107], v[32:35]
    ds_read_b64_tr_b16 v[160:161], v15 offset:10272
    v_mfma_f32_16x16x32_bf16 v[52:55], v[144:147], v[108:111], v[52:55]
    v_mfma_f32_16x16x32_bf16 v[72:75], v[144:147], v[112:115], v[72:75]
    ds_read_b64_tr_b16 v[162:163], v15 offset:11552
    v_mfma_f32_16x16x32_bf16 v[92:95], v[144:147], v[116:119], v[92:95]
    ds_read_b64_tr_b16 v[164:165], v14 offset:10304
    s_waitcnt lgkmcnt(11)
    v_mfma_f32_16x16x32_bf16 v[36:39], v[148:151], v[104:107], v[36:39]
    ds_read_b64_tr_b16 v[166:167], v14 offset:11584
    v_mfma_f32_16x16x32_bf16 v[56:59], v[148:151], v[108:111], v[56:59]
    v_mfma_f32_16x16x32_bf16 v[76:79], v[148:151], v[112:115], v[76:79]
    ds_read_b64_tr_b16 v[168:169], v15 offset:10336
    v_mfma_f32_16x16x32_bf16 v[96:99], v[148:151], v[116:119], v[96:99]
    ds_read_b64_tr_b16 v[170:171], v15 offset:11616
    s_waitcnt lgkmcnt(12)
    v_mfma_f32_16x16x32_bf16 v[40:43], v[152:155], v[104:107], v[40:43]
    v_mfma_f32_16x16x32_bf16 v[60:63], v[152:155], v[108:111], v[60:63]
    ds_read_b64_tr_b16 v[172:173], v14 offset:10368
    v_mfma_f32_16x16x32_bf16 v[80:83], v[152:155], v[112:115], v[80:83]
    ds_read_b64_tr_b16 v[174:175], v14 offset:11648
    v_mfma_f32_16x16x32_bf16 v[100:103], v[152:155], v[116:119], v[100:103]
    s_waitcnt lgkmcnt(11)
    v_mfma_f32_16x16x32_bf16 v[24:27], v[156:159], v[120:123], v[24:27]
    s_waitcnt lgkmcnt(10)
    v_mfma_f32_16x16x32_bf16 v[44:47], v[156:159], v[124:127], v[44:47]
    s_waitcnt lgkmcnt(9)
    v_mfma_f32_16x16x32_bf16 v[64:67], v[156:159], v[128:131], v[64:67]
    s_waitcnt lgkmcnt(8)
    v_mfma_f32_16x16x32_bf16 v[84:87], v[156:159], v[132:135], v[84:87]
    s_waitcnt lgkmcnt(6)
    v_mfma_f32_16x16x32_bf16 v[28:31], v[160:163], v[120:123], v[28:31]
    v_mfma_f32_16x16x32_bf16 v[48:51], v[160:163], v[124:127], v[48:51]
    v_mfma_f32_16x16x32_bf16 v[68:71], v[160:163], v[128:131], v[68:71]
    v_mfma_f32_16x16x32_bf16 v[88:91], v[160:163], v[132:135], v[88:91]
    s_waitcnt lgkmcnt(0)
    s_barrier
    v_mfma_f32_16x16x32_bf16 v[32:35], v[164:167], v[120:123], v[32:35]
    ds_read_b128 v[104:107], v12 offset:36864
    ds_read_b64_tr_b16 v[136:137], v14 offset:36864
    v_mfma_f32_16x16x32_bf16 v[52:55], v[164:167], v[124:127], v[52:55]
    ds_read_b64_tr_b16 v[138:139], v14 offset:38144
    v_mfma_f32_16x16x32_bf16 v[72:75], v[164:167], v[128:131], v[72:75]
    ds_read_b128 v[108:111], v12 offset:38912
    v_mfma_f32_16x16x32_bf16 v[92:95], v[164:167], v[132:135], v[92:95]
    ds_read_b128 v[112:115], v12 offset:40960
    v_mfma_f32_16x16x32_bf16 v[36:39], v[168:171], v[120:123], v[36:39]
    ds_read_b128 v[116:119], v12 offset:43008
    v_mfma_f32_16x16x32_bf16 v[56:59], v[168:171], v[124:127], v[56:59]
    ds_read_b64_tr_b16 v[140:141], v15 offset:36896
    v_mfma_f32_16x16x32_bf16 v[76:79], v[168:171], v[128:131], v[76:79]
    ds_read_b64_tr_b16 v[142:143], v15 offset:38176
    ds_read_b64_tr_b16 v[144:145], v14 offset:36928
    v_mfma_f32_16x16x32_bf16 v[96:99], v[168:171], v[132:135], v[96:99]
    ds_read_b64_tr_b16 v[146:147], v14 offset:38208
    v_mfma_f32_16x16x32_bf16 v[40:43], v[172:175], v[120:123], v[40:43]
    ds_read_b64_tr_b16 v[148:149], v15 offset:36960
    v_mfma_f32_16x16x32_bf16 v[60:63], v[172:175], v[124:127], v[60:63]
    ds_read_b64_tr_b16 v[150:151], v15 offset:38240
    v_mfma_f32_16x16x32_bf16 v[80:83], v[172:175], v[128:131], v[80:83]
    ds_read_b64_tr_b16 v[152:153], v14 offset:36992
    v_mfma_f32_16x16x32_bf16 v[100:103], v[172:175], v[132:135], v[100:103]
    ds_read_b64_tr_b16 v[154:155], v14 offset:38272
    s_waitcnt lgkmcnt(11)
    v_mfma_f32_16x16x32_bf16 v[24:27], v[136:139], v[104:107], v[24:27]
    ds_read_b128 v[120:123], v13 offset:36864
    s_waitcnt lgkmcnt(11)
    v_mfma_f32_16x16x32_bf16 v[44:47], v[136:139], v[108:111], v[44:47]
    ds_read_b64_tr_b16 v[156:157], v14 offset:47104
    s_waitcnt lgkmcnt(11)
    v_mfma_f32_16x16x32_bf16 v[64:67], v[136:139], v[112:115], v[64:67]
    ds_read_b64_tr_b16 v[158:159], v14 offset:48384
    s_waitcnt lgkmcnt(11)
    v_mfma_f32_16x16x32_bf16 v[84:87], v[136:139], v[116:119], v[84:87]
    s_waitcnt lgkmcnt(9)
    v_mfma_f32_16x16x32_bf16 v[28:31], v[140:143], v[104:107], v[28:31]
    ds_read_b128 v[124:127], v13 offset:38912
    v_mfma_f32_16x16x32_bf16 v[48:51], v[140:143], v[108:111], v[48:51]
    ds_read_b128 v[128:131], v13 offset:40960
    v_mfma_f32_16x16x32_bf16 v[68:71], v[140:143], v[112:115], v[68:71]
    v_mfma_f32_16x16x32_bf16 v[88:91], v[140:143], v[116:119], v[88:91]
    ds_read_b128 v[132:135], v13 offset:43008
    s_waitcnt lgkmcnt(10)
    v_mfma_f32_16x16x32_bf16 v[32:35], v[144:147], v[104:107], v[32:35]
    ds_read_b64_tr_b16 v[160:161], v15 offset:47136
    v_mfma_f32_16x16x32_bf16 v[52:55], v[144:147], v[108:111], v[52:55]
    v_mfma_f32_16x16x32_bf16 v[72:75], v[144:147], v[112:115], v[72:75]
    ds_read_b64_tr_b16 v[162:163], v15 offset:48416
    v_mfma_f32_16x16x32_bf16 v[92:95], v[144:147], v[116:119], v[92:95]
    ds_read_b64_tr_b16 v[164:165], v14 offset:47168
    s_waitcnt lgkmcnt(11)
    v_mfma_f32_16x16x32_bf16 v[36:39], v[148:151], v[104:107], v[36:39]
    ds_read_b64_tr_b16 v[166:167], v14 offset:48448
    v_mfma_f32_16x16x32_bf16 v[56:59], v[148:151], v[108:111], v[56:59]
    v_mfma_f32_16x16x32_bf16 v[76:79], v[148:151], v[112:115], v[76:79]
    ds_read_b64_tr_b16 v[168:169], v15 offset:47200
    v_mfma_f32_16x16x32_bf16 v[96:99], v[148:151], v[116:119], v[96:99]
    ds_read_b64_tr_b16 v[170:171], v15 offset:48480
    s_waitcnt lgkmcnt(12)
    v_mfma_f32_16x16x32_bf16 v[40:43], v[152:155], v[104:107], v[40:43]
    v_mfma_f32_16x16x32_bf16 v[60:63], v[152:155], v[108:111], v[60:63]
    ds_read_b64_tr_b16 v[172:173], v14 offset:47232
    v_mfma_f32_16x16x32_bf16 v[80:83], v[152:155], v[112:115], v[80:83]
    ds_read_b64_tr_b16 v[174:175], v14 offset:48512
    v_mfma_f32_16x16x32_bf16 v[100:103], v[152:155], v[116:119], v[100:103]
    s_waitcnt lgkmcnt(11)
    v_mfma_f32_16x16x32_bf16 v[24:27], v[156:159], v[120:123], v[24:27]
    s_waitcnt lgkmcnt(10)
    v_mfma_f32_16x16x32_bf16 v[44:47], v[156:159], v[124:127], v[44:47]
    s_waitcnt lgkmcnt(9)
    v_mfma_f32_16x16x32_bf16 v[64:67], v[156:159], v[128:131], v[64:67]
    s_waitcnt lgkmcnt(8)
    v_mfma_f32_16x16x32_bf16 v[84:87], v[156:159], v[132:135], v[84:87]
    s_waitcnt lgkmcnt(6)
    v_mfma_f32_16x16x32_bf16 v[28:31], v[160:163], v[120:123], v[28:31]
    v_mfma_f32_16x16x32_bf16 v[48:51], v[160:163], v[124:127], v[48:51]
    v_mfma_f32_16x16x32_bf16 v[68:71], v[160:163], v[128:131], v[68:71]
    v_mfma_f32_16x16x32_bf16 v[88:91], v[160:163], v[132:135], v[88:91]
    s_waitcnt lgkmcnt(0)
    s_barrier
    v_mfma_f32_16x16x32_bf16 v[32:35], v[164:167], v[120:123], v[32:35]
    ds_read_b128 v[104:107], v16 offset:0
    ds_read_b64_tr_b16 v[136:137], v18 offset:0
    v_mfma_f32_16x16x32_bf16 v[52:55], v[164:167], v[124:127], v[52:55]
    ds_read_b64_tr_b16 v[138:139], v18 offset:1280
    v_mfma_f32_16x16x32_bf16 v[72:75], v[164:167], v[128:131], v[72:75]
    ds_read_b128 v[108:111], v16 offset:2048
    v_mfma_f32_16x16x32_bf16 v[92:95], v[164:167], v[132:135], v[92:95]
    ds_read_b128 v[112:115], v16 offset:4096
    v_mfma_f32_16x16x32_bf16 v[36:39], v[168:171], v[120:123], v[36:39]
    ds_read_b128 v[116:119], v16 offset:6144
    v_mfma_f32_16x16x32_bf16 v[56:59], v[168:171], v[124:127], v[56:59]
    ds_read_b64_tr_b16 v[140:141], v19 offset:32
    v_mfma_f32_16x16x32_bf16 v[76:79], v[168:171], v[128:131], v[76:79]
    ds_read_b64_tr_b16 v[142:143], v19 offset:1312
    ds_read_b64_tr_b16 v[144:145], v18 offset:64
    v_mfma_f32_16x16x32_bf16 v[96:99], v[168:171], v[132:135], v[96:99]
    ds_read_b64_tr_b16 v[146:147], v18 offset:1344
    v_mfma_f32_16x16x32_bf16 v[40:43], v[172:175], v[120:123], v[40:43]
    ds_read_b64_tr_b16 v[148:149], v19 offset:96
    v_mfma_f32_16x16x32_bf16 v[60:63], v[172:175], v[124:127], v[60:63]
    ds_read_b64_tr_b16 v[150:151], v19 offset:1376
    v_mfma_f32_16x16x32_bf16 v[80:83], v[172:175], v[128:131], v[80:83]
    ds_read_b64_tr_b16 v[152:153], v18 offset:128
    v_mfma_f32_16x16x32_bf16 v[100:103], v[172:175], v[132:135], v[100:103]
    ds_read_b64_tr_b16 v[154:155], v18 offset:1408
    s_waitcnt lgkmcnt(11)
    v_mfma_f32_16x16x32_bf16 v[24:27], v[136:139], v[104:107], v[24:27]
    ds_read_b128 v[120:123], v17 offset:0
    s_waitcnt lgkmcnt(11)
    v_mfma_f32_16x16x32_bf16 v[44:47], v[136:139], v[108:111], v[44:47]
    ds_read_b64_tr_b16 v[156:157], v18 offset:10240
    s_waitcnt lgkmcnt(11)
    v_mfma_f32_16x16x32_bf16 v[64:67], v[136:139], v[112:115], v[64:67]
    ds_read_b64_tr_b16 v[158:159], v18 offset:11520
    s_waitcnt lgkmcnt(11)
    v_mfma_f32_16x16x32_bf16 v[84:87], v[136:139], v[116:119], v[84:87]
    s_waitcnt lgkmcnt(9)
    v_mfma_f32_16x16x32_bf16 v[28:31], v[140:143], v[104:107], v[28:31]
    ds_read_b128 v[124:127], v17 offset:2048
    v_mfma_f32_16x16x32_bf16 v[48:51], v[140:143], v[108:111], v[48:51]
    ds_read_b128 v[128:131], v17 offset:4096
    v_mfma_f32_16x16x32_bf16 v[68:71], v[140:143], v[112:115], v[68:71]
    v_mfma_f32_16x16x32_bf16 v[88:91], v[140:143], v[116:119], v[88:91]
    ds_read_b128 v[132:135], v17 offset:6144
    s_waitcnt lgkmcnt(10)
    v_mfma_f32_16x16x32_bf16 v[32:35], v[144:147], v[104:107], v[32:35]
    ds_read_b64_tr_b16 v[160:161], v19 offset:10272
    v_mfma_f32_16x16x32_bf16 v[52:55], v[144:147], v[108:111], v[52:55]
    v_mfma_f32_16x16x32_bf16 v[72:75], v[144:147], v[112:115], v[72:75]
    ds_read_b64_tr_b16 v[162:163], v19 offset:11552
    v_mfma_f32_16x16x32_bf16 v[92:95], v[144:147], v[116:119], v[92:95]
    ds_read_b64_tr_b16 v[164:165], v18 offset:10304
    s_waitcnt lgkmcnt(11)
    v_mfma_f32_16x16x32_bf16 v[36:39], v[148:151], v[104:107], v[36:39]
    ds_read_b64_tr_b16 v[166:167], v18 offset:11584
    v_mfma_f32_16x16x32_bf16 v[56:59], v[148:151], v[108:111], v[56:59]
    v_mfma_f32_16x16x32_bf16 v[76:79], v[148:151], v[112:115], v[76:79]
    ds_read_b64_tr_b16 v[168:169], v19 offset:10336
    v_mfma_f32_16x16x32_bf16 v[96:99], v[148:151], v[116:119], v[96:99]
    ds_read_b64_tr_b16 v[170:171], v19 offset:11616
    s_waitcnt lgkmcnt(12)
    v_mfma_f32_16x16x32_bf16 v[40:43], v[152:155], v[104:107], v[40:43]
    v_mfma_f32_16x16x32_bf16 v[60:63], v[152:155], v[108:111], v[60:63]
    ds_read_b64_tr_b16 v[172:173], v18 offset:10368
    v_mfma_f32_16x16x32_bf16 v[80:83], v[152:155], v[112:115], v[80:83]
    ds_read_b64_tr_b16 v[174:175], v18 offset:11648
    v_mfma_f32_16x16x32_bf16 v[100:103], v[152:155], v[116:119], v[100:103]
    s_waitcnt lgkmcnt(11)
    v_mfma_f32_16x16x32_bf16 v[24:27], v[156:159], v[120:123], v[24:27]
    s_waitcnt lgkmcnt(10)
    v_mfma_f32_16x16x32_bf16 v[44:47], v[156:159], v[124:127], v[44:47]
    s_waitcnt lgkmcnt(9)
    v_mfma_f32_16x16x32_bf16 v[64:67], v[156:159], v[128:131], v[64:67]
    s_waitcnt lgkmcnt(8)
    v_mfma_f32_16x16x32_bf16 v[84:87], v[156:159], v[132:135], v[84:87]
    s_waitcnt lgkmcnt(6)
    v_mfma_f32_16x16x32_bf16 v[28:31], v[160:163], v[120:123], v[28:31]
    v_mfma_f32_16x16x32_bf16 v[48:51], v[160:163], v[124:127], v[48:51]
    v_mfma_f32_16x16x32_bf16 v[68:71], v[160:163], v[128:131], v[68:71]
    v_mfma_f32_16x16x32_bf16 v[88:91], v[160:163], v[132:135], v[88:91]
    s_waitcnt lgkmcnt(0)
    s_barrier
    v_mfma_f32_16x16x32_bf16 v[32:35], v[164:167], v[120:123], v[32:35]
    ds_read_b128 v[104:107], v12 offset:0
    ds_read_b64_tr_b16 v[136:137], v14 offset:0
    v_mfma_f32_16x16x32_bf16 v[52:55], v[164:167], v[124:127], v[52:55]
    ds_read_b64_tr_b16 v[138:139], v14 offset:1280
    v_mfma_f32_16x16x32_bf16 v[72:75], v[164:167], v[128:131], v[72:75]
    ds_read_b128 v[108:111], v12 offset:2048
    v_mfma_f32_16x16x32_bf16 v[92:95], v[164:167], v[132:135], v[92:95]
    ds_read_b128 v[112:115], v12 offset:4096
    v_mfma_f32_16x16x32_bf16 v[36:39], v[168:171], v[120:123], v[36:39]
    ds_read_b128 v[116:119], v12 offset:6144
    v_mfma_f32_16x16x32_bf16 v[56:59], v[168:171], v[124:127], v[56:59]
    ds_read_b64_tr_b16 v[140:141], v15 offset:32
    v_mfma_f32_16x16x32_bf16 v[76:79], v[168:171], v[128:131], v[76:79]
    ds_read_b64_tr_b16 v[142:143], v15 offset:1312
    ds_read_b64_tr_b16 v[144:145], v14 offset:64
    v_mfma_f32_16x16x32_bf16 v[96:99], v[168:171], v[132:135], v[96:99]
    ds_read_b64_tr_b16 v[146:147], v14 offset:1344
    v_mfma_f32_16x16x32_bf16 v[40:43], v[172:175], v[120:123], v[40:43]
    ds_read_b64_tr_b16 v[148:149], v15 offset:96
    v_mfma_f32_16x16x32_bf16 v[60:63], v[172:175], v[124:127], v[60:63]
    ds_read_b64_tr_b16 v[150:151], v15 offset:1376
    v_mfma_f32_16x16x32_bf16 v[80:83], v[172:175], v[128:131], v[80:83]
    ds_read_b64_tr_b16 v[152:153], v14 offset:128
    v_mfma_f32_16x16x32_bf16 v[100:103], v[172:175], v[132:135], v[100:103]
    ds_read_b64_tr_b16 v[154:155], v14 offset:1408
    s_waitcnt lgkmcnt(11)
    v_mfma_f32_16x16x32_bf16 v[24:27], v[136:139], v[104:107], v[24:27]
    ds_read_b128 v[120:123], v13 offset:0
    s_waitcnt lgkmcnt(11)
    v_mfma_f32_16x16x32_bf16 v[44:47], v[136:139], v[108:111], v[44:47]
    ds_read_b64_tr_b16 v[156:157], v14 offset:10240
    s_waitcnt lgkmcnt(11)
    v_mfma_f32_16x16x32_bf16 v[64:67], v[136:139], v[112:115], v[64:67]
    ds_read_b64_tr_b16 v[158:159], v14 offset:11520
    s_waitcnt lgkmcnt(11)
    v_mfma_f32_16x16x32_bf16 v[84:87], v[136:139], v[116:119], v[84:87]
    ds_read_b128 v[124:127], v13 offset:2048
    s_waitcnt lgkmcnt(10)
    v_mfma_f32_16x16x32_bf16 v[28:31], v[140:143], v[104:107], v[28:31]
    ds_read_b128 v[128:131], v13 offset:4096
    v_mfma_f32_16x16x32_bf16 v[48:51], v[140:143], v[108:111], v[48:51]
    ds_read_b128 v[132:135], v13 offset:6144
    v_mfma_f32_16x16x32_bf16 v[68:71], v[140:143], v[112:115], v[68:71]
    ds_read_b64_tr_b16 v[160:161], v15 offset:10272
    v_mfma_f32_16x16x32_bf16 v[88:91], v[140:143], v[116:119], v[88:91]
    ds_read_b64_tr_b16 v[162:163], v15 offset:11552
    s_waitcnt lgkmcnt(12)
    v_mfma_f32_16x16x32_bf16 v[32:35], v[144:147], v[104:107], v[32:35]
    ds_read_b64_tr_b16 v[164:165], v14 offset:10304
    v_mfma_f32_16x16x32_bf16 v[52:55], v[144:147], v[108:111], v[52:55]
    ds_read_b64_tr_b16 v[166:167], v14 offset:11584
    v_mfma_f32_16x16x32_bf16 v[72:75], v[144:147], v[112:115], v[72:75]
    ds_read_b64_tr_b16 v[168:169], v15 offset:10336
    v_mfma_f32_16x16x32_bf16 v[92:95], v[144:147], v[116:119], v[92:95]
    ds_read_b64_tr_b16 v[170:171], v15 offset:11616
    s_waitcnt lgkmcnt(9)
    v_mfma_f32_16x16x32_bf16 v[24:27], v[156:159], v[120:123], v[24:27]
    ds_read_b64_tr_b16 v[172:173], v14 offset:10368
    s_waitcnt lgkmcnt(9)
    v_mfma_f32_16x16x32_bf16 v[44:47], v[156:159], v[124:127], v[44:47]
    ds_read_b64_tr_b16 v[174:175], v14 offset:11648
    s_waitcnt lgkmcnt(9)
    v_mfma_f32_16x16x32_bf16 v[64:67], v[156:159], v[128:131], v[64:67]
    s_waitcnt lgkmcnt(8)
    v_mfma_f32_16x16x32_bf16 v[84:87], v[156:159], v[132:135], v[84:87]
    s_waitcnt lgkmcnt(6)
    v_mfma_f32_16x16x32_bf16 v[28:31], v[160:163], v[120:123], v[28:31]
    v_mfma_f32_16x16x32_bf16 v[48:51], v[160:163], v[124:127], v[48:51]
    v_mfma_f32_16x16x32_bf16 v[68:71], v[160:163], v[128:131], v[68:71]
    v_mul_f32 v216, s76, v24
    v_mul_f32 v217, s76, v25
    v_mul_f32 v218, s76, v26
    v_mfma_f32_16x16x32_bf16 v[88:91], v[160:163], v[132:135], v[88:91]
    v_mul_f32 v219, s76, v27
    v_mul_f32 v220, s76, v44
    v_mul_f32 v221, s76, v45
    s_waitcnt lgkmcnt(4)
    v_mfma_f32_16x16x32_bf16 v[32:35], v[164:167], v[120:123], v[32:35]
    v_mul_f32 v222, s76, v46
    v_mul_f32 v223, s76, v47
    v_exp_f32_e64 v216, v216 clamp
    v_mfma_f32_16x16x32_bf16 v[52:55], v[164:167], v[124:127], v[52:55]
    v_exp_f32_e64 v217, v217 clamp
    v_exp_f32_e64 v218, v218 clamp
    v_mfma_f32_16x16x32_bf16 v[72:75], v[164:167], v[128:131], v[72:75]
    v_exp_f32_e64 v219, v219 clamp
    v_exp_f32_e64 v220, v220 clamp
    v_mfma_f32_16x16x32_bf16 v[92:95], v[164:167], v[132:135], v[92:95]
    v_exp_f32_e64 v221, v221 clamp
    v_exp_f32_e64 v222, v222 clamp
    v_mfma_f32_16x16x32_bf16 v[36:39], v[148:151], v[104:107], v[36:39]
    v_exp_f32_e64 v223, v223 clamp
    v_max_f32 v24, s77, v24
    v_mfma_f32_16x16x32_bf16 v[56:59], v[148:151], v[108:111], v[56:59]
    v_max_f32 v25, s77, v25
    v_max_f32 v26, s77, v26
    v_max_f32 v27, s77, v27
    v_mfma_f32_16x16x32_bf16 v[76:79], v[148:151], v[112:115], v[76:79]
    v_max_f32 v44, s77, v44
    v_max_f32 v45, s77, v45
    v_max_f32 v46, s77, v46
    v_mfma_f32_16x16x32_bf16 v[96:99], v[148:151], v[116:119], v[96:99]
    v_max_f32 v47, s77, v47
    v_add_f32 v24, v24, v216
    v_add_f32 v25, v25, v217
    v_mfma_f32_16x16x32_bf16 v[40:43], v[152:155], v[104:107], v[40:43]
    v_add_f32 v26, v26, v218
    v_add_f32 v27, v27, v219
    v_add_f32 v44, v44, v220
    v_mfma_f32_16x16x32_bf16 v[60:63], v[152:155], v[108:111], v[60:63]
    v_add_f32 v45, v45, v221
    v_add_f32 v46, v46, v222
    v_add_f32 v47, v47, v223
    v_mfma_f32_16x16x32_bf16 v[80:83], v[152:155], v[112:115], v[80:83]
    v_mul_f32 v216, s76, v64
    v_mul_f32 v217, s76, v65
    v_mul_f32 v218, s76, v66
    v_mfma_f32_16x16x32_bf16 v[100:103], v[152:155], v[116:119], v[100:103]
    v_mul_f32 v219, s76, v67
    v_mul_f32 v220, s76, v84
    v_mul_f32 v221, s76, v85
    s_waitcnt lgkmcnt(2)
    v_mfma_f32_16x16x32_bf16 v[36:39], v[168:171], v[120:123], v[36:39]
    v_mul_f32 v222, s76, v86
    v_mul_f32 v223, s76, v87
    v_exp_f32_e64 v216, v216 clamp
    v_mfma_f32_16x16x32_bf16 v[56:59], v[168:171], v[124:127], v[56:59]
    v_exp_f32_e64 v217, v217 clamp
    v_exp_f32_e64 v218, v218 clamp
    v_mfma_f32_16x16x32_bf16 v[76:79], v[168:171], v[128:131], v[76:79]
    v_exp_f32_e64 v219, v219 clamp
    v_exp_f32_e64 v220, v220 clamp
    v_mfma_f32_16x16x32_bf16 v[96:99], v[168:171], v[132:135], v[96:99]
    v_exp_f32_e64 v221, v221 clamp
    v_exp_f32_e64 v222, v222 clamp
    s_waitcnt lgkmcnt(0)
    v_mfma_f32_16x16x32_bf16 v[40:43], v[172:175], v[120:123], v[40:43]
    v_exp_f32_e64 v223, v223 clamp
    v_max_f32 v64, s77, v64
    v_mfma_f32_16x16x32_bf16 v[60:63], v[172:175], v[124:127], v[60:63]
    v_max_f32 v65, s77, v65
    v_max_f32 v66, s77, v66
    v_max_f32 v67, s77, v67
    v_mfma_f32_16x16x32_bf16 v[80:83], v[172:175], v[128:131], v[80:83]
    v_max_f32 v84, s77, v84
    v_max_f32 v85, s77, v85
    v_max_f32 v86, s77, v86
    v_mfma_f32_16x16x32_bf16 v[100:103], v[172:175], v[132:135], v[100:103]
    v_max_f32 v87, s77, v87
    v_add_f32 v64, v64, v216
    v_add_f32 v65, v65, v217
    v_add_f32 v66, v66, v218
    v_add_f32 v67, v67, v219
    v_add_f32 v84, v84, v220
    v_add_f32 v85, v85, v221
    v_add_f32 v86, v86, v222
    v_add_f32 v87, v87, v223
    v_cvt_pk_bf16_f32 v104, v24, v25
    v_cvt_pk_bf16_f32 v105, v26, v27
    v_cvt_pk_bf16_f32 v106, v44, v45
    v_cvt_pk_bf16_f32 v107, v46, v47
    v_cvt_pk_bf16_f32 v128, v64, v65
    v_cvt_pk_bf16_f32 v129, v66, v67
    v_cvt_pk_bf16_f32 v130, v84, v85
    v_cvt_pk_bf16_f32 v131, v86, v87
    buffer_store_dwordx4 v[104:107], v20, s[60:63], s78 offen offset:0 sc1
    buffer_store_dwordx4 v[128:131], v21, s[60:63], s78 offen offset:0 sc1
    v_mul_f32 v216, s76, v28
    v_mul_f32 v217, s76, v29
    v_mul_f32 v218, s76, v30
    v_mul_f32 v219, s76, v31
    v_mul_f32 v220, s76, v48
    v_mul_f32 v221, s76, v49
    v_mul_f32 v222, s76, v50
    v_mul_f32 v223, s76, v51
    v_exp_f32_e64 v216, v216 clamp
    v_exp_f32_e64 v217, v217 clamp
    v_exp_f32_e64 v218, v218 clamp
    v_exp_f32_e64 v219, v219 clamp
    v_exp_f32_e64 v220, v220 clamp
    v_exp_f32_e64 v221, v221 clamp
    v_exp_f32_e64 v222, v222 clamp
    v_exp_f32_e64 v223, v223 clamp
    v_max_f32 v28, s77, v28
    v_max_f32 v29, s77, v29
    v_max_f32 v30, s77, v30
    v_max_f32 v31, s77, v31
    v_max_f32 v48, s77, v48
    v_max_f32 v49, s77, v49
    v_max_f32 v50, s77, v50
    v_max_f32 v51, s77, v51
    v_add_f32 v28, v28, v216
    v_add_f32 v29, v29, v217
    v_add_f32 v30, v30, v218
    v_add_f32 v31, v31, v219
    v_add_f32 v48, v48, v220
    v_add_f32 v49, v49, v221
    v_add_f32 v50, v50, v222
    v_add_f32 v51, v51, v223
    v_mul_f32 v216, s76, v68
    v_mul_f32 v217, s76, v69
    v_mul_f32 v218, s76, v70
    v_mul_f32 v219, s76, v71
    v_mul_f32 v220, s76, v88
    v_mul_f32 v221, s76, v89
    v_mul_f32 v222, s76, v90
    v_mul_f32 v223, s76, v91
    v_exp_f32_e64 v216, v216 clamp
    v_exp_f32_e64 v217, v217 clamp
    v_exp_f32_e64 v218, v218 clamp
    v_exp_f32_e64 v219, v219 clamp
    v_exp_f32_e64 v220, v220 clamp
    v_exp_f32_e64 v221, v221 clamp
    v_exp_f32_e64 v222, v222 clamp
    v_exp_f32_e64 v223, v223 clamp
    v_max_f32 v68, s77, v68
    v_max_f32 v69, s77, v69
    v_max_f32 v70, s77, v70
    v_max_f32 v71, s77, v71
    v_max_f32 v88, s77, v88
    v_max_f32 v89, s77, v89
    v_max_f32 v90, s77, v90
    v_max_f32 v91, s77, v91
    v_add_f32 v68, v68, v216
    v_add_f32 v69, v69, v217
    v_add_f32 v70, v70, v218
    v_add_f32 v71, v71, v219
    v_add_f32 v88, v88, v220
    v_add_f32 v89, v89, v221
    v_add_f32 v90, v90, v222
    v_add_f32 v91, v91, v223
    v_cvt_pk_bf16_f32 v108, v28, v29
    v_cvt_pk_bf16_f32 v109, v30, v31
    v_cvt_pk_bf16_f32 v110, v48, v49
    v_cvt_pk_bf16_f32 v111, v50, v51
    v_cvt_pk_bf16_f32 v132, v68, v69
    v_cvt_pk_bf16_f32 v133, v70, v71
    v_cvt_pk_bf16_f32 v134, v88, v89
    v_cvt_pk_bf16_f32 v135, v90, v91
    buffer_store_dwordx4 v[108:111], v20, s[60:63], s78 offen offset:1024 sc1
    buffer_store_dwordx4 v[132:135], v21, s[60:63], s78 offen offset:1024 sc1
    v_mul_f32 v216, s76, v32
    v_mul_f32 v217, s76, v33
    v_mul_f32 v218, s76, v34
    v_mul_f32 v219, s76, v35
    v_mul_f32 v220, s76, v52
    v_mul_f32 v221, s76, v53
    v_mul_f32 v222, s76, v54
    v_mul_f32 v223, s76, v55
    v_exp_f32_e64 v216, v216 clamp
    v_exp_f32_e64 v217, v217 clamp
    v_exp_f32_e64 v218, v218 clamp
    v_exp_f32_e64 v219, v219 clamp
    v_exp_f32_e64 v220, v220 clamp
    v_exp_f32_e64 v221, v221 clamp
    v_exp_f32_e64 v222, v222 clamp
    v_exp_f32_e64 v223, v223 clamp
    v_max_f32 v32, s77, v32
    v_max_f32 v33, s77, v33
    v_max_f32 v34, s77, v34
    v_max_f32 v35, s77, v35
    v_max_f32 v52, s77, v52
    v_max_f32 v53, s77, v53
    v_max_f32 v54, s77, v54
    v_max_f32 v55, s77, v55
    v_add_f32 v32, v32, v216
    v_add_f32 v33, v33, v217
    v_add_f32 v34, v34, v218
    v_add_f32 v35, v35, v219
    v_add_f32 v52, v52, v220
    v_add_f32 v53, v53, v221
    v_add_f32 v54, v54, v222
    v_add_f32 v55, v55, v223
    v_mul_f32 v216, s76, v72
    v_mul_f32 v217, s76, v73
    v_mul_f32 v218, s76, v74
    v_mul_f32 v219, s76, v75
    v_mul_f32 v220, s76, v92
    v_mul_f32 v221, s76, v93
    v_mul_f32 v222, s76, v94
    v_mul_f32 v223, s76, v95
    v_exp_f32_e64 v216, v216 clamp
    v_exp_f32_e64 v217, v217 clamp
    v_exp_f32_e64 v218, v218 clamp
    v_exp_f32_e64 v219, v219 clamp
    v_exp_f32_e64 v220, v220 clamp
    v_exp_f32_e64 v221, v221 clamp
    v_exp_f32_e64 v222, v222 clamp
    v_exp_f32_e64 v223, v223 clamp
    v_max_f32 v72, s77, v72
    v_max_f32 v73, s77, v73
    v_max_f32 v74, s77, v74
    v_max_f32 v75, s77, v75
    v_max_f32 v92, s77, v92
    v_max_f32 v93, s77, v93
    v_max_f32 v94, s77, v94
    v_max_f32 v95, s77, v95
    v_add_f32 v72, v72, v216
    v_add_f32 v73, v73, v217
    v_add_f32 v74, v74, v218
    v_add_f32 v75, v75, v219
    v_add_f32 v92, v92, v220
    v_add_f32 v93, v93, v221
    v_add_f32 v94, v94, v222
    v_add_f32 v95, v95, v223
    v_cvt_pk_bf16_f32 v112, v32, v33
    v_cvt_pk_bf16_f32 v113, v34, v35
    v_cvt_pk_bf16_f32 v114, v52, v53
    v_cvt_pk_bf16_f32 v115, v54, v55
    v_cvt_pk_bf16_f32 v136, v72, v73
    v_cvt_pk_bf16_f32 v137, v74, v75
    v_cvt_pk_bf16_f32 v138, v92, v93
    v_cvt_pk_bf16_f32 v139, v94, v95
    buffer_store_dwordx4 v[112:115], v20, s[60:63], s78 offen offset:2048 sc1
    buffer_store_dwordx4 v[136:139], v21, s[60:63], s78 offen offset:2048 sc1
    v_mul_f32 v216, s76, v36
    v_mul_f32 v217, s76, v37
    v_mul_f32 v218, s76, v38
    v_mul_f32 v219, s76, v39
    v_mul_f32 v220, s76, v56
    v_mul_f32 v221, s76, v57
    v_mul_f32 v222, s76, v58
    v_mul_f32 v223, s76, v59
    v_exp_f32_e64 v216, v216 clamp
    v_exp_f32_e64 v217, v217 clamp
    v_exp_f32_e64 v218, v218 clamp
    v_exp_f32_e64 v219, v219 clamp
    v_exp_f32_e64 v220, v220 clamp
    v_exp_f32_e64 v221, v221 clamp
    v_exp_f32_e64 v222, v222 clamp
    v_exp_f32_e64 v223, v223 clamp
    v_max_f32 v36, s77, v36
    v_max_f32 v37, s77, v37
    v_max_f32 v38, s77, v38
    v_max_f32 v39, s77, v39
    v_max_f32 v56, s77, v56
    v_max_f32 v57, s77, v57
    v_max_f32 v58, s77, v58
    v_max_f32 v59, s77, v59
    v_add_f32 v36, v36, v216
    v_add_f32 v37, v37, v217
    v_add_f32 v38, v38, v218
    v_add_f32 v39, v39, v219
    v_add_f32 v56, v56, v220
    v_add_f32 v57, v57, v221
    v_add_f32 v58, v58, v222
    v_add_f32 v59, v59, v223
    v_mul_f32 v216, s76, v76
    v_mul_f32 v217, s76, v77
    v_mul_f32 v218, s76, v78
    v_mul_f32 v219, s76, v79
    v_mul_f32 v220, s76, v96
    v_mul_f32 v221, s76, v97
    v_mul_f32 v222, s76, v98
    v_mul_f32 v223, s76, v99
    v_exp_f32_e64 v216, v216 clamp
    v_exp_f32_e64 v217, v217 clamp
    v_exp_f32_e64 v218, v218 clamp
    v_exp_f32_e64 v219, v219 clamp
    v_exp_f32_e64 v220, v220 clamp
    v_exp_f32_e64 v221, v221 clamp
    v_exp_f32_e64 v222, v222 clamp
    v_exp_f32_e64 v223, v223 clamp
    v_max_f32 v76, s77, v76
    v_max_f32 v77, s77, v77
    v_max_f32 v78, s77, v78
    v_max_f32 v79, s77, v79
    v_max_f32 v96, s77, v96
    v_max_f32 v97, s77, v97
    v_max_f32 v98, s77, v98
    v_max_f32 v99, s77, v99
    v_add_f32 v76, v76, v216
    v_add_f32 v77, v77, v217
    v_add_f32 v78, v78, v218
    v_add_f32 v79, v79, v219
    v_add_f32 v96, v96, v220
    v_add_f32 v97, v97, v221
    v_add_f32 v98, v98, v222
    v_add_f32 v99, v99, v223
    v_cvt_pk_bf16_f32 v116, v36, v37
    v_cvt_pk_bf16_f32 v117, v38, v39
    v_cvt_pk_bf16_f32 v118, v56, v57
    v_cvt_pk_bf16_f32 v119, v58, v59
    v_cvt_pk_bf16_f32 v140, v76, v77
    v_cvt_pk_bf16_f32 v141, v78, v79
    v_cvt_pk_bf16_f32 v142, v96, v97
    v_cvt_pk_bf16_f32 v143, v98, v99
    buffer_store_dwordx4 v[116:119], v20, s[60:63], s78 offen offset:3072 sc1
    buffer_store_dwordx4 v[140:143], v21, s[60:63], s78 offen offset:3072 sc1
    v_mul_f32 v216, s76, v40
    v_mul_f32 v217, s76, v41
    v_mul_f32 v218, s76, v42
    v_mul_f32 v219, s76, v43
    v_mul_f32 v220, s76, v60
    v_mul_f32 v221, s76, v61
    v_mul_f32 v222, s76, v62
    v_mul_f32 v223, s76, v63
    v_exp_f32_e64 v216, v216 clamp
    v_exp_f32_e64 v217, v217 clamp
    v_exp_f32_e64 v218, v218 clamp
    v_exp_f32_e64 v219, v219 clamp
    v_exp_f32_e64 v220, v220 clamp
    v_exp_f32_e64 v221, v221 clamp
    v_exp_f32_e64 v222, v222 clamp
    v_exp_f32_e64 v223, v223 clamp
    v_max_f32 v40, s77, v40
    v_max_f32 v41, s77, v41
    v_max_f32 v42, s77, v42
    v_max_f32 v43, s77, v43
    v_max_f32 v60, s77, v60
    v_max_f32 v61, s77, v61
    v_max_f32 v62, s77, v62
    v_max_f32 v63, s77, v63
    v_add_f32 v40, v40, v216
    v_add_f32 v41, v41, v217
    v_add_f32 v42, v42, v218
    v_add_f32 v43, v43, v219
    v_add_f32 v60, v60, v220
    v_add_f32 v61, v61, v221
    v_add_f32 v62, v62, v222
    v_add_f32 v63, v63, v223
    v_mul_f32 v216, s76, v80
    v_mul_f32 v217, s76, v81
    v_mul_f32 v218, s76, v82
    v_mul_f32 v219, s76, v83
    v_mul_f32 v220, s76, v100
    v_mul_f32 v221, s76, v101
    v_mul_f32 v222, s76, v102
    v_mul_f32 v223, s76, v103
    v_exp_f32_e64 v216, v216 clamp
    v_exp_f32_e64 v217, v217 clamp
    v_exp_f32_e64 v218, v218 clamp
    v_exp_f32_e64 v219, v219 clamp
    v_exp_f32_e64 v220, v220 clamp
    v_exp_f32_e64 v221, v221 clamp
    v_exp_f32_e64 v222, v222 clamp
    v_exp_f32_e64 v223, v223 clamp
    v_max_f32 v80, s77, v80
    v_max_f32 v81, s77, v81
    v_max_f32 v82, s77, v82
    v_max_f32 v83, s77, v83
    v_max_f32 v100, s77, v100
    v_max_f32 v101, s77, v101
    v_max_f32 v102, s77, v102
    v_max_f32 v103, s77, v103
    v_add_f32 v80, v80, v216
    v_add_f32 v81, v81, v217
    v_add_f32 v82, v82, v218
    v_add_f32 v83, v83, v219
    v_add_f32 v100, v100, v220
    v_add_f32 v101, v101, v221
    v_add_f32 v102, v102, v222
    v_add_f32 v103, v103, v223
    v_cvt_pk_bf16_f32 v120, v40, v41
    v_cvt_pk_bf16_f32 v121, v42, v43
    v_cvt_pk_bf16_f32 v122, v60, v61
    v_cvt_pk_bf16_f32 v123, v62, v63
    v_cvt_pk_bf16_f32 v144, v80, v81
    v_cvt_pk_bf16_f32 v145, v82, v83
    v_cvt_pk_bf16_f32 v146, v100, v101
    v_cvt_pk_bf16_f32 v147, v102, v103
    buffer_store_dwordx4 v[120:123], v20, s[60:63], s79 offen offset:0 sc1
    buffer_store_dwordx4 v[144:147], v21, s[60:63], s79 offen offset:0 sc1
    s_waitcnt vmcnt(10)
    v_cmp_eq_u32 vcc, 0, v253
    s_cbranch_vccz L_qn
    s_mov_b32 s81, 100000
Lspin_27:
    buffer_load_dword v253, off, s[56:59], 0 sc1
    s_waitcnt vmcnt(0)
    v_cmp_eq_u32 vcc, 0, v253
    s_cbranch_vccz Lspun_28
    s_sleep 8
    s_sub_u32 s81, s81, 1
    s_cbranch_scc0 Lspin_27
Lspun_28:
L_qn:
    v_readfirstlane_b32 s0, v253
    s_lshl_b32 s72, s9, 1
    s_add_u32 s72, s72, s15
    s_lshl_b32 s72, s72, 4
    s_lshl_b32 s73, s13, 1
    s_add_u32 s72, s72, s73
    s_add_u32 s72, s72, s42
    s_lshl_b32 s72, s72, 7
    s_add_u32 s72, s72, 3997696
    s_waitcnt vmcnt(0)
    s_mov_b64 exec, 1
    buffer_store_dword v253, off, s[60:63], s72 sc1
    s_mov_b64 exec, -1
    s_barrier
L_gconv:
    s_mul_i32 s79, s42, 8752
    s_add_u32 s79, s79, 145408
    s_lshr_b32 s14, s14, 1
    s_mov_b32 s13, 1
    v_mov_b32 v3, 162912
    s_mov_b32 s81, 2000000
Lspin_29:
    ds_read_b32 v2, v3
    s_waitcnt lgkmcnt(0)
    v_cmp_ne_u32 vcc, 4, v2
    s_cbranch_vccz Lspun_30
    s_sleep 1
    s_sub_u32 s81, s81, 1
    s_cbranch_scc0 Lspin_29
Lspun_30:
    s_cmp_eq_u32 s15, 0
    s_cbranch_scc1 L_gconv_hi
    v_lshrrev_b32 v8, 4, v1
    v_and_b32 v9, 15, v1
    v_lshlrev_b32 v11, 3, v9
    v_lshlrev_b32 v12, 4, v8
    v_sub_u32 v11, v12, v11
    s_add_u32 s70, s79, 4248
    v_add_u32 v11, s70, v11
    v_bfe_u32 v10, v1, 2, 2
    v_and_b32 v13, 3, v1
    v_add_u32 v10, v10, v13
    v_lshlrev_b32 v10, 3, v10
    v_lshl_add_u32 v10, v8, 6, v10
    v_add_u32 v10, s79, v10
    v_add_u32 v2, 1152, v11
    v_add_u32 v3, 2304, v11
    v_add_u32 v13, 3456, v11
    ds_read2_b64 v[80:83], v11 offset0:72 offset1:73
    ds_read_b64_tr_b16 v[20:21], v10 offset:264
    ds_read_b64_tr_b16 v[22:23], v10 offset:296
    ds_read_b64_tr_b16 v[28:29], v10 offset:776
    ds_read_b64_tr_b16 v[30:31], v10 offset:808
    ds_read2_b64 v[84:87], v2 offset0:72 offset1:73
    ds_read2_b64 v[88:91], v3 offset0:72 offset1:73
    ds_read2_b64 v[92:95], v13 offset0:72 offset1:73
    ds_read2_b64 v[96:99], v11 offset0:120 offset1:121
    ds_read_b64_tr_b16 v[36:37], v10 offset:1288
    ds_read_b64_tr_b16 v[38:39], v10 offset:1320
    ds_read_b64_tr_b16 v[44:45], v10 offset:1800
    v_lshl_add_u32 v12, v9, 2, v8
    v_subrev_u32 v14, 16, v1
    v_add_u32 v15, 47, v1
    v_cmp_gt_u32 vcc, 16, v1
    s_nop 1
    v_cndmask_b32 v14, v14, v15, vcc
    v_cmp_eq_u32 s[74:75], 0, v1
    s_nop 1
    v_cndmask_b32 v14, v14, 63, s[74:75]
    v_lshlrev_b32 v14, 2, v14
    v_lshlrev_b32 v12, 3, v12
    s_mul_i32 s70, s43, 4224
    s_add_u32 s70, s70, 6815744
    v_mov_b32 v15, s79
    v_mov_b32 v4, 0
    v_mov_b32 v5, 0
    v_mov_b32 v6, 0
    v_mov_b32 v63, 1
    s_waitcnt lgkmcnt(9)
    v_mfma_f32_16x16x32_bf16 v[204:207], v[20:23], v[80:83], 0
    ds_read_b64_tr_b16 v[46:47], v10 offset:1832
    s_waitcnt lgkmcnt(8)
    v_mfma_f32_16x16x32_bf16 v[220:223], v[28:31], v[80:83], 0
    ds_read_b64_tr_b16 v[52:53], v10 offset:2312
    s_waitcnt lgkmcnt(8)
    v_mfma_f32_16x16x32_bf16 v[208:211], v[20:23], v[84:87], 0
    ds_read_b64_tr_b16 v[54:55], v10 offset:2344
    v_mfma_f32_16x16x32_bf16 v[224:227], v[28:31], v[84:87], 0
    ds_read2_b64 v[100:103], v2 offset0:120 offset1:121
    s_waitcnt lgkmcnt(9)
    v_mfma_f32_16x16x32_bf16 v[212:215], v[20:23], v[88:91], 0
    ds_read2_b64 v[104:107], v3 offset0:120 offset1:121
    v_mfma_f32_16x16x32_bf16 v[228:231], v[28:31], v[88:91], 0
    ds_read2_b64 v[108:111], v13 offset0:120 offset1:121
    s_waitcnt lgkmcnt(10)
    v_mfma_f32_16x16x32_bf16 v[216:219], v[20:23], v[92:95], 0
    ds_read2_b64 v[116:119], v11 offset0:48 offset1:49
    v_mfma_f32_16x16x32_bf16 v[232:235], v[28:31], v[92:95], 0
    ds_read_b64_tr_b16 v[16:17], v10 offset:8
    s_waitcnt lgkmcnt(11)
    v_mfma_f32_16x16x32_bf16 v[156:159], v[20:23], v[96:99], 0
    ds_read_b64_tr_b16 v[18:19], v10 offset:40
    v_mfma_f32_16x16x32_bf16 v[172:175], v[28:31], v[96:99], 0
    ds_read2_b64 v[120:123], v2 offset0:48 offset1:49
    s_waitcnt lgkmcnt(11)
    v_mfma_f32_16x16x32_bf16 v[188:191], v[36:39], v[96:99], 0
    ds_read2_b64 v[124:127], v3 offset0:48 offset1:49
    s_waitcnt lgkmcnt(10)
    v_mfma_f32_16x16x32_bf16 v[204:207], v[44:47], v[96:99], v[204:207]
    ds_read2_b64 v[128:131], v13 offset0:48 offset1:49
    s_waitcnt lgkmcnt(9)
    v_mfma_f32_16x16x32_bf16 v[220:223], v[52:55], v[96:99], v[220:223]
    ds_read2_b64 v[132:135], v11 offset0:64 offset1:65
    s_waitcnt lgkmcnt(9)
    v_mfma_f32_16x16x32_bf16 v[160:163], v[20:23], v[100:103], 0
    ds_read_b64_tr_b16 v[24:25], v10 offset:520
    v_mfma_f32_16x16x32_bf16 v[176:179], v[28:31], v[100:103], 0
    ds_read_b64_tr_b16 v[26:27], v10 offset:552
    v_mfma_f32_16x16x32_bf16 v[192:195], v[36:39], v[100:103], 0
    ds_read2_b64 v[136:139], v2 offset0:64 offset1:65
    v_mfma_f32_16x16x32_bf16 v[208:211], v[44:47], v[100:103], v[208:211]
    ds_read2_b64 v[140:143], v3 offset0:64 offset1:65
    v_mfma_f32_16x16x32_bf16 v[224:227], v[52:55], v[100:103], v[224:227]
    ds_read2_b64 v[144:147], v13 offset0:64 offset1:65
    s_waitcnt lgkmcnt(13)
    v_mfma_f32_16x16x32_bf16 v[164:167], v[20:23], v[104:107], 0
    ds_read2_b64 v[80:83], v11 offset0:112 offset1:113
    v_mfma_f32_16x16x32_bf16 v[180:183], v[28:31], v[104:107], 0
    v_mfma_f32_16x16x32_bf16 v[196:199], v[36:39], v[104:107], 0
    v_mfma_f32_16x16x32_bf16 v[212:215], v[44:47], v[104:107], v[212:215]
    v_mfma_f32_16x16x32_bf16 v[228:231], v[52:55], v[104:107], v[228:231]
    s_waitcnt lgkmcnt(13)
    v_mfma_f32_16x16x32_bf16 v[168:171], v[20:23], v[108:111], 0
    ds_read_b64_tr_b16 v[32:33], v10 offset:1032
    v_mfma_f32_16x16x32_bf16 v[184:187], v[28:31], v[108:111], 0
    v_mfma_f32_16x16x32_bf16 v[200:203], v[36:39], v[108:111], 0
    v_mfma_f32_16x16x32_bf16 v[216:219], v[44:47], v[108:111], v[216:219]
    v_mfma_f32_16x16x32_bf16 v[232:235], v[52:55], v[108:111], v[232:235]
    s_waitcnt lgkmcnt(11)
    v_mfma_f32_16x16x32_bf16 v[220:223], v[16:19], v[116:119], v[220:223]
    ds_read_b64_tr_b16 v[34:35], v10 offset:1064
    s_waitcnt lgkmcnt(11)
    v_mfma_f32_16x16x32_bf16 v[224:227], v[16:19], v[120:123], v[224:227]
    ds_read_b64_tr_b16 v[40:41], v10 offset:1544
    s_waitcnt lgkmcnt(11)
    v_mfma_f32_16x16x32_bf16 v[228:231], v[16:19], v[124:127], v[228:231]
    ds_read_b64_tr_b16 v[42:43], v10 offset:1576
    s_waitcnt lgkmcnt(11)
    v_mfma_f32_16x16x32_bf16 v[232:235], v[16:19], v[128:131], v[232:235]
    ds_read_b64_tr_b16 v[48:49], v10 offset:2056
    s_waitcnt lgkmcnt(11)
    v_mfma_f32_16x16x32_bf16 v[204:207], v[16:19], v[132:135], v[204:207]
    ds_read_b64_tr_b16 v[50:51], v10 offset:2088
    s_waitcnt lgkmcnt(10)
    v_mfma_f32_16x16x32_bf16 v[220:223], v[24:27], v[132:135], v[220:223]
    ds_read2_b64 v[84:87], v2 offset0:112 offset1:113
    s_waitcnt lgkmcnt(10)
    v_mfma_f32_16x16x32_bf16 v[208:211], v[16:19], v[136:139], v[208:211]
    ds_read2_b64 v[88:91], v3 offset0:112 offset1:113
    v_mfma_f32_16x16x32_bf16 v[224:227], v[24:27], v[136:139], v[224:227]
    ds_read2_b64 v[92:95], v13 offset0:112 offset1:113
    s_waitcnt lgkmcnt(11)
    v_mfma_f32_16x16x32_bf16 v[212:215], v[16:19], v[140:143], v[212:215]
    ds_read2_b64 v[96:99], v11 offset0:56 offset1:57
    v_mfma_f32_16x16x32_bf16 v[228:231], v[24:27], v[140:143], v[228:231]
    ds_read2_b64 v[100:103], v2 offset0:56 offset1:57
    s_waitcnt lgkmcnt(12)
    v_mfma_f32_16x16x32_bf16 v[216:219], v[16:19], v[144:147], v[216:219]
    ds_read2_b64 v[104:107], v3 offset0:56 offset1:57
    v_mfma_f32_16x16x32_bf16 v[232:235], v[24:27], v[144:147], v[232:235]
    ds_read2_b64 v[108:111], v13 offset0:56 offset1:57
    s_waitcnt lgkmcnt(13)
    v_mfma_f32_16x16x32_bf16 v[156:159], v[16:19], v[80:83], v[156:159]
    ds_read2_b64 v[116:119], v11 offset0:104 offset1:105
    v_mfma_f32_16x16x32_bf16 v[172:175], v[24:27], v[80:83], v[172:175]
    s_waitcnt lgkmcnt(12)
    v_mfma_f32_16x16x32_bf16 v[188:191], v[32:35], v[80:83], v[188:191]
    ds_read2_b64 v[120:123], v2 offset0:104 offset1:105
    s_waitcnt lgkmcnt(11)
    v_mfma_f32_16x16x32_bf16 v[204:207], v[40:43], v[80:83], v[204:207]
    ds_read2_b64 v[124:127], v3 offset0:104 offset1:105
    s_waitcnt lgkmcnt(10)
    v_mfma_f32_16x16x32_bf16 v[220:223], v[48:51], v[80:83], v[220:223]
    ds_read2_b64 v[128:131], v13 offset0:104 offset1:105
    s_waitcnt lgkmcnt(10)
    v_mfma_f32_16x16x32_bf16 v[160:163], v[16:19], v[84:87], v[160:163]
    ds_read2_b64 v[132:135], v11 offset0:96 offset1:97
    v_mfma_f32_16x16x32_bf16 v[176:179], v[24:27], v[84:87], v[176:179]
    ds_read2_b64 v[136:139], v2 offset0:96 offset1:97
    v_mfma_f32_16x16x32_bf16 v[192:195], v[32:35], v[84:87], v[192:195]
    ds_read2_b64 v[140:143], v3 offset0:96 offset1:97
    v_mfma_f32_16x16x32_bf16 v[208:211], v[40:43], v[84:87], v[208:211]
    ds_read2_b64 v[144:147], v13 offset0:96 offset1:97
    v_mfma_f32_16x16x32_bf16 v[224:227], v[48:51], v[84:87], v[224:227]
    s_waitcnt lgkmcnt(13)
    v_mfma_f32_16x16x32_bf16 v[164:167], v[16:19], v[88:91], v[164:167]
    ds_read2_b64 v[80:83], v11 offset0:88 offset1:89
    v_mfma_f32_16x16x32_bf16 v[180:183], v[24:27], v[88:91], v[180:183]
    v_mfma_f32_16x16x32_bf16 v[196:199], v[32:35], v[88:91], v[196:199]
    v_mfma_f32_16x16x32_bf16 v[212:215], v[40:43], v[88:91], v[212:215]
    v_mfma_f32_16x16x32_bf16 v[228:231], v[48:51], v[88:91], v[228:231]
    s_waitcnt lgkmcnt(13)
    v_mfma_f32_16x16x32_bf16 v[168:171], v[16:19], v[92:95], v[168:171]
    ds_read2_b64 v[84:87], v2 offset0:88 offset1:89
    v_mfma_f32_16x16x32_bf16 v[184:187], v[24:27], v[92:95], v[184:187]
    v_mfma_f32_16x16x32_bf16 v[200:203], v[32:35], v[92:95], v[200:203]
    v_mfma_f32_16x16x32_bf16 v[216:219], v[40:43], v[92:95], v[216:219]
    v_add_f32 v163, v163, v166
    s_nop 2
    v_add_f32 v167, v167, v170
    v_mfma_f32_16x16x32_bf16 v[232:235], v[48:51], v[92:95], v[232:235]
    v_add_f32 v163, v163, v169
    s_waitcnt lgkmcnt(13)
    v_mfma_f32_16x16x32_bf16 v[220:223], v[20:23], v[96:99], v[220:223]
    ds_bpermute_b32 v58, v14, v171
    s_waitcnt lgkmcnt(13)
    v_mfma_f32_16x16x32_bf16 v[224:227], v[20:23], v[100:103], v[224:227]
    ds_bpermute_b32 v57, v14, v167
    s_waitcnt lgkmcnt(13)
    v_mfma_f32_16x16x32_bf16 v[228:231], v[20:23], v[104:107], v[228:231]
    ds_bpermute_b32 v56, v14, v163
    s_waitcnt lgkmcnt(13)
    v_mfma_f32_16x16x32_bf16 v[232:235], v[20:23], v[108:111], v[232:235]
    v_add_f32 v157, v157, v160
    v_add_f32 v158, v158, v161
    s_waitcnt lgkmcnt(12)
    v_mfma_f32_16x16x32_bf16 v[172:175], v[20:23], v[116:119], v[172:175]
    v_add_f32 v159, v159, v162
    v_add_f32 v158, v158, v164
    s_waitcnt lgkmcnt(11)
    v_mfma_f32_16x16x32_bf16 v[176:179], v[20:23], v[120:123], v[176:179]
    v_add_f32 v159, v159, v165
    v_add_f32 v159, v159, v168
    s_waitcnt lgkmcnt(10)
    v_mfma_f32_16x16x32_bf16 v[180:183], v[20:23], v[124:127], v[180:183]
    s_waitcnt lgkmcnt(0)
    v_cndmask_b32 v164, v56, v4, s[74:75]
    v_cndmask_b32 v165, v57, v5, s[74:75]
    v_mfma_f32_16x16x32_bf16 v[184:187], v[20:23], v[128:131], v[184:187]
    v_cndmask_b32 v166, v58, v6, s[74:75]
    v_add_f32 v156, v156, v164
    v_mfma_f32_16x16x32_bf16 v[172:175], v[16:19], v[132:135], v[172:175]
    v_add_f32 v157, v157, v165
    v_add_f32 v158, v158, v166
    v_mfma_f32_16x16x32_bf16 v[176:179], v[16:19], v[136:139], v[176:179]
    v_cvt_pk_bf16_f32 v160, v156, v157
    v_cvt_pk_bf16_f32 v161, v158, v159
    v_mfma_f32_16x16x32_bf16 v[180:183], v[16:19], v[140:143], v[180:183]
    buffer_store_dwordx2 v[160:161], v12, s[60:63], s70 offen offset:0 sc1
    v_mfma_f32_16x16x32_bf16 v[184:187], v[16:19], v[144:147], v[184:187]
    ds_read2_b64 v[88:91], v3 offset0:88 offset1:89
    v_mfma_f32_16x16x32_bf16 v[188:191], v[28:31], v[116:119], v[188:191]
    ds_read2_b64 v[92:95], v13 offset0:88 offset1:89
    v_mfma_f32_16x16x32_bf16 v[192:195], v[28:31], v[120:123], v[192:195]
    ds_read2_b64 v[96:99], v11 offset0:80 offset1:81
    v_mfma_f32_16x16x32_bf16 v[196:199], v[28:31], v[124:127], v[196:199]
    v_add_f32 v179, v179, v182
    s_nop 0
    v_add_f32 v183, v183, v186
    v_mfma_f32_16x16x32_bf16 v[200:203], v[28:31], v[128:131], v[200:203]
    ds_read2_b64 v[100:103], v2 offset0:80 offset1:81
    v_mfma_f32_16x16x32_bf16 v[188:191], v[24:27], v[132:135], v[188:191]
    ds_read2_b64 v[104:107], v3 offset0:80 offset1:81
    v_mfma_f32_16x16x32_bf16 v[192:195], v[24:27], v[136:139], v[192:195]
    ds_read2_b64 v[108:111], v13 offset0:80 offset1:81
    v_mfma_f32_16x16x32_bf16 v[196:199], v[24:27], v[140:143], v[196:199]
    v_add_f32 v179, v179, v185
    v_mfma_f32_16x16x32_bf16 v[200:203], v[24:27], v[144:147], v[200:203]
    ds_bpermute_b32 v62, v14, v187
    v_mfma_f32_16x16x32_bf16 v[188:191], v[20:23], v[80:83], v[188:191]
    ds_bpermute_b32 v61, v14, v183
    v_mfma_f32_16x16x32_bf16 v[192:195], v[20:23], v[84:87], v[192:195]
    ds_bpermute_b32 v60, v14, v179
    s_waitcnt lgkmcnt(8)
    v_mfma_f32_16x16x32_bf16 v[196:199], v[20:23], v[88:91], v[196:199]
    v_add_f32 v173, v173, v176
    v_add_f32 v174, v174, v177
    s_waitcnt lgkmcnt(7)
    v_mfma_f32_16x16x32_bf16 v[200:203], v[20:23], v[92:95], v[200:203]
    v_add_f32 v175, v175, v178
    v_add_f32 v174, v174, v180
    s_waitcnt lgkmcnt(6)
    v_mfma_f32_16x16x32_bf16 v[188:191], v[16:19], v[96:99], v[188:191]
    v_add_f32 v175, v175, v181
    v_add_f32 v175, v175, v184
    s_waitcnt lgkmcnt(5)
    v_mfma_f32_16x16x32_bf16 v[192:195], v[16:19], v[100:103], v[192:195]
    s_waitcnt lgkmcnt(0)
    v_cndmask_b32 v180, v60, v56, s[74:75]
    v_cndmask_b32 v181, v61, v57, s[74:75]
    v_mfma_f32_16x16x32_bf16 v[196:199], v[16:19], v[104:107], v[196:199]
    v_cndmask_b32 v182, v62, v58, s[74:75]
    v_add_f32 v172, v172, v180
    v_mfma_f32_16x16x32_bf16 v[200:203], v[16:19], v[108:111], v[200:203]
    v_add_f32 v173, v173, v181
    v_add_f32 v174, v174, v182
    v_mfma_f32_16x16x32_bf16 v[204:207], v[36:39], v[116:119], v[204:207]
    v_cvt_pk_bf16_f32 v176, v172, v173
    v_cvt_pk_bf16_f32 v177, v174, v175
    v_mfma_f32_16x16x32_bf16 v[208:211], v[36:39], v[120:123], v[208:211]
    buffer_store_dwordx2 v[176:177], v12, s[60:63], s70 offen offset:512 sc1
    v_mfma_f32_16x16x32_bf16 v[212:215], v[36:39], v[124:127], v[212:215]
    v_add_f32 v195, v195, v198
    v_add_f32 v199, v199, v202
    v_mfma_f32_16x16x32_bf16 v[216:219], v[36:39], v[128:131], v[216:219]
    v_add_f32 v195, v195, v201
    v_mfma_f32_16x16x32_bf16 v[204:207], v[32:35], v[132:135], v[204:207]
    ds_bpermute_b32 v66, v14, v203
    v_mfma_f32_16x16x32_bf16 v[208:211], v[32:35], v[136:139], v[208:211]
    ds_bpermute_b32 v65, v14, v199
    v_mfma_f32_16x16x32_bf16 v[212:215], v[32:35], v[140:143], v[212:215]
    ds_bpermute_b32 v64, v14, v195
    v_mfma_f32_16x16x32_bf16 v[216:219], v[32:35], v[144:147], v[216:219]
    v_add_f32 v189, v189, v192
    v_add_f32 v190, v190, v193
    v_mfma_f32_16x16x32_bf16 v[204:207], v[28:31], v[80:83], v[204:207]
    v_add_f32 v191, v191, v194
    v_add_f32 v190, v190, v196
    v_mfma_f32_16x16x32_bf16 v[208:211], v[28:31], v[84:87], v[208:211]
    v_add_f32 v191, v191, v197
    v_add_f32 v191, v191, v200
    v_mfma_f32_16x16x32_bf16 v[212:215], v[28:31], v[88:91], v[212:215]
    s_waitcnt lgkmcnt(0)
    v_cndmask_b32 v196, v64, v60, s[74:75]
    v_cndmask_b32 v197, v65, v61, s[74:75]
    v_mfma_f32_16x16x32_bf16 v[216:219], v[28:31], v[92:95], v[216:219]
    v_cndmask_b32 v198, v66, v62, s[74:75]
    v_add_f32 v188, v188, v196
    v_mfma_f32_16x16x32_bf16 v[204:207], v[24:27], v[96:99], v[204:207]
    v_add_f32 v189, v189, v197
    v_add_f32 v190, v190, v198
    v_mfma_f32_16x16x32_bf16 v[208:211], v[24:27], v[100:103], v[208:211]
    v_cvt_pk_bf16_f32 v192, v188, v189
    v_cvt_pk_bf16_f32 v193, v190, v191
    v_mfma_f32_16x16x32_bf16 v[212:215], v[24:27], v[104:107], v[212:215]
    buffer_store_dwordx2 v[192:193], v12, s[60:63], s70 offen offset:1024 sc1
    v_mfma_f32_16x16x32_bf16 v[216:219], v[24:27], v[108:111], v[216:219]
    v_mfma_f32_16x16x32_bf16 v[220:223], v[44:47], v[116:119], v[220:223]
    v_mfma_f32_16x16x32_bf16 v[224:227], v[44:47], v[120:123], v[224:227]
    v_mfma_f32_16x16x32_bf16 v[228:231], v[44:47], v[124:127], v[228:231]
    s_nop 2
    v_add_f32 v211, v211, v214
    s_nop 0
    v_add_f32 v215, v215, v218
    v_mfma_f32_16x16x32_bf16 v[232:235], v[44:47], v[128:131], v[232:235]
    v_add_f32 v211, v211, v217
    v_mfma_f32_16x16x32_bf16 v[220:223], v[40:43], v[132:135], v[220:223]
    ds_bpermute_b32 v58, v14, v219
    v_mfma_f32_16x16x32_bf16 v[224:227], v[40:43], v[136:139], v[224:227]
    ds_bpermute_b32 v57, v14, v215
    v_mfma_f32_16x16x32_bf16 v[228:231], v[40:43], v[140:143], v[228:231]
    ds_bpermute_b32 v56, v14, v211
    v_mfma_f32_16x16x32_bf16 v[232:235], v[40:43], v[144:147], v[232:235]
    v_add_f32 v205, v205, v208
    v_add_f32 v206, v206, v209
    v_mfma_f32_16x16x32_bf16 v[220:223], v[36:39], v[80:83], v[220:223]
    v_add_f32 v207, v207, v210
    v_add_f32 v206, v206, v212
    v_mfma_f32_16x16x32_bf16 v[224:227], v[36:39], v[84:87], v[224:227]
    v_add_f32 v207, v207, v213
    v_add_f32 v207, v207, v216
    v_mfma_f32_16x16x32_bf16 v[228:231], v[36:39], v[88:91], v[228:231]
    s_waitcnt lgkmcnt(0)
    v_cndmask_b32 v212, v56, v64, s[74:75]
    v_cndmask_b32 v213, v57, v65, s[74:75]
    v_mfma_f32_16x16x32_bf16 v[232:235], v[36:39], v[92:95], v[232:235]
    v_cndmask_b32 v214, v58, v66, s[74:75]
    v_add_f32 v204, v204, v212
    v_mfma_f32_16x16x32_bf16 v[220:223], v[32:35], v[96:99], v[220:223]
    v_add_f32 v205, v205, v213
    v_add_f32 v206, v206, v214
    v_mfma_f32_16x16x32_bf16 v[224:227], v[32:35], v[100:103], v[224:227]
    v_cvt_pk_bf16_f32 v208, v204, v205
    v_cvt_pk_bf16_f32 v209, v206, v207
    v_mfma_f32_16x16x32_bf16 v[228:231], v[32:35], v[104:107], v[228:231]
    buffer_store_dwordx2 v[208:209], v12, s[60:63], s70 offen offset:1536 sc1
    v_mfma_f32_16x16x32_bf16 v[232:235], v[32:35], v[108:111], v[232:235]
    s_nop 5
    v_add_f32 v227, v227, v230
    s_nop 0
    v_add_f32 v231, v231, v234
    v_add_f32 v227, v227, v233
    ds_bpermute_b32 v62, v14, v235
    ds_bpermute_b32 v61, v14, v231
    ds_bpermute_b32 v60, v14, v227
    v_add_f32 v221, v221, v224
    v_add_f32 v222, v222, v225
    v_add_f32 v223, v223, v226
    v_add_f32 v222, v222, v228
    v_add_f32 v223, v223, v229
    v_add_f32 v223, v223, v232
    s_waitcnt lgkmcnt(0)
    s_mov_b64 exec, 1
    ds_write_b128 v15, v[60:63] offset:8736
    s_mov_b64 exec, -1
    v_cndmask_b32 v228, v60, v56, s[74:75]
    v_cndmask_b32 v229, v61, v57, s[74:75]
    v_cndmask_b32 v230, v62, v58, s[74:75]
    v_add_f32 v220, v220, v228
    v_add_f32 v221, v221, v229
    v_add_f32 v222, v222, v230
    v_cvt_pk_bf16_f32 v224, v220, v221
    v_cvt_pk_bf16_f32 v225, v222, v223
    buffer_store_dwordx2 v[224:225], v12, s[60:63], s70 offen offset:2048 sc1
    s_branch L_join
L_gconv_hi:
    v_lshrrev_b32 v8, 4, v1
    v_and_b32 v9, 15, v1
    v_lshlrev_b32 v11, 3, v9
    v_lshlrev_b32 v12, 4, v8
    v_sub_u32 v11, v12, v11
    s_add_u32 s70, s79, 4248
    v_add_u32 v11, s70, v11
    v_bfe_u32 v10, v1, 2, 2
    v_and_b32 v13, 3, v1
    v_add_u32 v10, v10, v13
    v_lshlrev_b32 v10, 3, v10
    v_lshl_add_u32 v10, v8, 6, v10
    v_add_u32 v10, s79, v10
    v_add_u32 v2, 1152, v11
    v_add_u32 v3, 2304, v11
    v_add_u32 v13, 3456, v11
    ds_read2_b64 v[80:83], v11 offset0:120 offset1:121
    ds_read_b64_tr_b16 v[60:61], v10 offset:2824
    ds_read_b64_tr_b16 v[62:63], v10 offset:2856
    ds_read_b64_tr_b16 v[68:69], v10 offset:3336
    ds_read_b64_tr_b16 v[70:71], v10 offset:3368
    ds_read_b64_tr_b16 v[76:77], v10 offset:3848
    ds_read_b64_tr_b16 v[78:79], v10 offset:3880
    ds_read2_b64 v[84:87], v2 offset0:120 offset1:121
    ds_read2_b64 v[88:91], v3 offset0:120 offset1:121
    ds_read2_b64 v[92:95], v13 offset0:120 offset1:121
    ds_read2_b64 v[96:99], v11 offset0:112 offset1:113
    ds_read_b64_tr_b16 v[56:57], v10 offset:2568
    v_lshl_add_u32 v12, v9, 2, v8
    v_subrev_u32 v14, 16, v1
    v_add_u32 v15, 47, v1
    v_cmp_gt_u32 vcc, 16, v1
    s_nop 1
    v_cndmask_b32 v14, v14, v15, vcc
    v_cmp_eq_u32 s[74:75], 0, v1
    s_nop 1
    v_cndmask_b32 v14, v14, 63, s[74:75]
    v_lshlrev_b32 v14, 2, v14
    v_lshlrev_b32 v12, 3, v12
    s_mul_i32 s70, s43, 4224
    s_add_u32 s70, s70, 6815744
    v_mov_b32 v15, s79
    s_waitcnt lgkmcnt(9)
    v_mfma_f32_16x16x32_bf16 v[156:159], v[60:63], v[80:83], 0
    ds_read_b64_tr_b16 v[58:59], v10 offset:2600
    s_waitcnt lgkmcnt(8)
    v_mfma_f32_16x16x32_bf16 v[172:175], v[68:71], v[80:83], 0
    ds_read_b64_tr_b16 v[64:65], v10 offset:3080
    s_waitcnt lgkmcnt(7)
    v_mfma_f32_16x16x32_bf16 v[188:191], v[76:79], v[80:83], 0
    ds_read_b64_tr_b16 v[66:67], v10 offset:3112
    s_waitcnt lgkmcnt(7)
    v_mfma_f32_16x16x32_bf16 v[160:163], v[60:63], v[84:87], 0
    ds_read_b64_tr_b16 v[72:73], v10 offset:3592
    v_mfma_f32_16x16x32_bf16 v[176:179], v[68:71], v[84:87], 0
    ds_read_b64_tr_b16 v[74:75], v10 offset:3624
    v_mfma_f32_16x16x32_bf16 v[192:195], v[76:79], v[84:87], 0
    ds_read2_b64 v[100:103], v2 offset0:112 offset1:113
    s_waitcnt lgkmcnt(9)
    v_mfma_f32_16x16x32_bf16 v[164:167], v[60:63], v[88:91], 0
    ds_read2_b64 v[104:107], v3 offset0:112 offset1:113
    v_mfma_f32_16x16x32_bf16 v[180:183], v[68:71], v[88:91], 0
    ds_read2_b64 v[108:111], v13 offset0:112 offset1:113
    v_mfma_f32_16x16x32_bf16 v[196:199], v[76:79], v[88:91], 0
    ds_read2_b64 v[112:115], v11 offset0:104 offset1:105
    s_waitcnt lgkmcnt(11)
    v_mfma_f32_16x16x32_bf16 v[168:171], v[60:63], v[92:95], 0
    ds_read_b64_tr_b16 v[52:53], v10 offset:2312
    v_mfma_f32_16x16x32_bf16 v[184:187], v[68:71], v[92:95], 0
    ds_read_b64_tr_b16 v[54:55], v10 offset:2344
    v_mfma_f32_16x16x32_bf16 v[200:203], v[76:79], v[92:95], 0
    ds_read2_b64 v[216:219], v2 offset0:104 offset1:105
    s_waitcnt lgkmcnt(11)
    v_mfma_f32_16x16x32_bf16 v[156:159], v[56:59], v[96:99], v[156:159]
    ds_read2_b64 v[220:223], v3 offset0:104 offset1:105
    s_waitcnt lgkmcnt(10)
    v_mfma_f32_16x16x32_bf16 v[172:175], v[64:67], v[96:99], v[172:175]
    ds_read2_b64 v[224:227], v13 offset0:104 offset1:105
    s_waitcnt lgkmcnt(9)
    v_mfma_f32_16x16x32_bf16 v[188:191], v[72:75], v[96:99], v[188:191]
    ds_read2_b64 v[228:231], v11 offset0:0 offset1:1
    s_waitcnt lgkmcnt(9)
    v_mfma_f32_16x16x32_bf16 v[160:163], v[56:59], v[100:103], v[160:163]
    ds_read_b64_tr_b16 v[16:17], v10 offset:8
    v_mfma_f32_16x16x32_bf16 v[176:179], v[64:67], v[100:103], v[176:179]
    ds_read_b64_tr_b16 v[18:19], v10 offset:40
    v_mfma_f32_16x16x32_bf16 v[192:195], v[72:75], v[100:103], v[192:195]
    ds_read2_b64 v[232:235], v2 offset0:0 offset1:1
    s_waitcnt lgkmcnt(11)
    v_mfma_f32_16x16x32_bf16 v[164:167], v[56:59], v[104:107], v[164:167]
    ds_read2_b64 v[80:83], v3 offset0:0 offset1:1
    v_mfma_f32_16x16x32_bf16 v[180:183], v[64:67], v[104:107], v[180:183]
    ds_read2_b64 v[84:87], v13 offset0:0 offset1:1
    v_mfma_f32_16x16x32_bf16 v[196:199], v[72:75], v[104:107], v[196:199]
    ds_read2_b64 v[88:91], v11 offset0:96 offset1:97
    s_waitcnt lgkmcnt(13)
    v_mfma_f32_16x16x32_bf16 v[168:171], v[56:59], v[108:111], v[168:171]
    ds_read_b64_tr_b16 v[48:49], v10 offset:2056
    v_mfma_f32_16x16x32_bf16 v[184:187], v[64:67], v[108:111], v[184:187]
    v_mfma_f32_16x16x32_bf16 v[200:203], v[72:75], v[108:111], v[200:203]
    s_waitcnt lgkmcnt(11)
    v_mfma_f32_16x16x32_bf16 v[156:159], v[52:55], v[112:115], v[156:159]
    ds_read_b64_tr_b16 v[50:51], v10 offset:2088
    v_mfma_f32_16x16x32_bf16 v[172:175], v[60:63], v[112:115], v[172:175]
    ds_read2_b64 v[92:95], v2 offset0:96 offset1:97
    v_mfma_f32_16x16x32_bf16 v[188:191], v[68:71], v[112:115], v[188:191]
    ds_read2_b64 v[96:99], v3 offset0:96 offset1:97
    s_waitcnt lgkmcnt(13)
    v_mfma_f32_16x16x32_bf16 v[160:163], v[52:55], v[216:219], v[160:163]
    ds_read2_b64 v[100:103], v13 offset0:96 offset1:97
    v_mfma_f32_16x16x32_bf16 v[176:179], v[60:63], v[216:219], v[176:179]
    v_mfma_f32_16x16x32_bf16 v[192:195], v[68:71], v[216:219], v[192:195]
    s_waitcnt lgkmcnt(13)
    v_mfma_f32_16x16x32_bf16 v[164:167], v[52:55], v[220:223], v[164:167]
    ds_read2_b64 v[104:107], v11 offset0:8 offset1:9
    v_mfma_f32_16x16x32_bf16 v[180:183], v[60:63], v[220:223], v[180:183]
    v_mfma_f32_16x16x32_bf16 v[196:199], v[68:71], v[220:223], v[196:199]
    s_waitcnt lgkmcnt(13)
    v_mfma_f32_16x16x32_bf16 v[168:171], v[52:55], v[224:227], v[168:171]
    ds_read_b64_tr_b16 v[20:21], v10 offset:264
    v_mfma_f32_16x16x32_bf16 v[184:187], v[60:63], v[224:227], v[184:187]
    v_mfma_f32_16x16x32_bf16 v[200:203], v[68:71], v[224:227], v[200:203]
    s_waitcnt lgkmcnt(11)
    v_mfma_f32_16x16x32_bf16 v[188:191], v[16:19], v[228:231], v[188:191]
    ds_read_b64_tr_b16 v[22:23], v10 offset:296
    s_waitcnt lgkmcnt(11)
    v_mfma_f32_16x16x32_bf16 v[192:195], v[16:19], v[232:235], v[192:195]
    ds_read2_b64 v[108:111], v2 offset0:8 offset1:9
    s_waitcnt lgkmcnt(11)
    v_mfma_f32_16x16x32_bf16 v[196:199], v[16:19], v[80:83], v[196:199]
    ds_read2_b64 v[112:115], v3 offset0:8 offset1:9
    s_waitcnt lgkmcnt(11)
    v_mfma_f32_16x16x32_bf16 v[200:203], v[16:19], v[84:87], v[200:203]
    ds_read2_b64 v[216:219], v13 offset0:8 offset1:9
    s_waitcnt lgkmcnt(9)
    v_mfma_f32_16x16x32_bf16 v[156:159], v[48:51], v[88:91], v[156:159]
    ds_read2_b64 v[220:223], v11 offset0:88 offset1:89
    v_mfma_f32_16x16x32_bf16 v[172:175], v[56:59], v[88:91], v[172:175]
    ds_read_b64_tr_b16 v[44:45], v10 offset:1800
    v_mfma_f32_16x16x32_bf16 v[188:191], v[64:67], v[88:91], v[188:191]
    ds_read_b64_tr_b16 v[46:47], v10 offset:1832
    s_waitcnt lgkmcnt(11)
    v_mfma_f32_16x16x32_bf16 v[160:163], v[48:51], v[92:95], v[160:163]
    ds_read2_b64 v[224:227], v2 offset0:88 offset1:89
    v_mfma_f32_16x16x32_bf16 v[176:179], v[56:59], v[92:95], v[176:179]
    ds_read2_b64 v[228:231], v3 offset0:88 offset1:89
    v_mfma_f32_16x16x32_bf16 v[192:195], v[64:67], v[92:95], v[192:195]
    ds_read2_b64 v[232:235], v13 offset0:88 offset1:89
    s_waitcnt lgkmcnt(13)
    v_mfma_f32_16x16x32_bf16 v[164:167], v[48:51], v[96:99], v[164:167]
    ds_read2_b64 v[80:83], v11 offset0:16 offset1:17
    v_mfma_f32_16x16x32_bf16 v[180:183], v[56:59], v[96:99], v[180:183]
    v_mfma_f32_16x16x32_bf16 v[196:199], v[64:67], v[96:99], v[196:199]
    s_waitcnt lgkmcnt(13)
    v_mfma_f32_16x16x32_bf16 v[168:171], v[48:51], v[100:103], v[168:171]
    ds_read_b64_tr_b16 v[24:25], v10 offset:520
    v_mfma_f32_16x16x32_bf16 v[184:187], v[56:59], v[100:103], v[184:187]
    v_mfma_f32_16x16x32_bf16 v[200:203], v[64:67], v[100:103], v[200:203]
    s_waitcnt lgkmcnt(11)
    v_mfma_f32_16x16x32_bf16 v[188:191], v[20:23], v[104:107], v[188:191]
    ds_read_b64_tr_b16 v[26:27], v10 offset:552
    s_waitcnt lgkmcnt(11)
    v_mfma_f32_16x16x32_bf16 v[192:195], v[20:23], v[108:111], v[192:195]
    ds_read2_b64 v[84:87], v2 offset0:16 offset1:17
    s_waitcnt lgkmcnt(11)
    v_mfma_f32_16x16x32_bf16 v[196:199], v[20:23], v[112:115], v[196:199]
    ds_read2_b64 v[88:91], v3 offset0:16 offset1:17
    s_waitcnt lgkmcnt(11)
    v_mfma_f32_16x16x32_bf16 v[200:203], v[20:23], v[216:219], v[200:203]
    ds_read2_b64 v[92:95], v13 offset0:16 offset1:17
    s_waitcnt lgkmcnt(9)
    v_mfma_f32_16x16x32_bf16 v[156:159], v[44:47], v[220:223], v[156:159]
    ds_read2_b64 v[96:99], v11 offset0:80 offset1:81
    v_mfma_f32_16x16x32_bf16 v[172:175], v[52:55], v[220:223], v[172:175]
    ds_read_b64_tr_b16 v[40:41], v10 offset:1544
    v_mfma_f32_16x16x32_bf16 v[188:191], v[60:63], v[220:223], v[188:191]
    ds_read_b64_tr_b16 v[42:43], v10 offset:1576
    s_waitcnt lgkmcnt(11)
    v_mfma_f32_16x16x32_bf16 v[160:163], v[44:47], v[224:227], v[160:163]
    ds_read2_b64 v[100:103], v2 offset0:80 offset1:81
    v_mfma_f32_16x16x32_bf16 v[176:179], v[52:55], v[224:227], v[176:179]
    ds_read2_b64 v[104:107], v3 offset0:80 offset1:81
    v_mfma_f32_16x16x32_bf16 v[192:195], v[60:63], v[224:227], v[192:195]
    ds_read2_b64 v[108:111], v13 offset0:80 offset1:81
    s_waitcnt lgkmcnt(13)
    v_mfma_f32_16x16x32_bf16 v[164:167], v[44:47], v[228:231], v[164:167]
    ds_read2_b64 v[112:115], v11 offset0:24 offset1:25
    v_mfma_f32_16x16x32_bf16 v[180:183], v[52:55], v[228:231], v[180:183]
    v_mfma_f32_16x16x32_bf16 v[196:199], v[60:63], v[228:231], v[196:199]
    s_waitcnt lgkmcnt(13)
    v_mfma_f32_16x16x32_bf16 v[168:171], v[44:47], v[232:235], v[168:171]
    ds_read_b64_tr_b16 v[28:29], v10 offset:776
    v_mfma_f32_16x16x32_bf16 v[184:187], v[52:55], v[232:235], v[184:187]
    v_mfma_f32_16x16x32_bf16 v[200:203], v[60:63], v[232:235], v[200:203]
    s_waitcnt lgkmcnt(13)
    v_mfma_f32_16x16x32_bf16 v[172:175], v[16:19], v[80:83], v[172:175]
    ds_read_b64_tr_b16 v[30:31], v10 offset:808
    s_waitcnt lgkmcnt(12)
    v_mfma_f32_16x16x32_bf16 v[188:191], v[24:27], v[80:83], v[188:191]
    ds_read2_b64 v[216:219], v2 offset0:24 offset1:25
    s_waitcnt lgkmcnt(12)
    v_mfma_f32_16x16x32_bf16 v[176:179], v[16:19], v[84:87], v[176:179]
    ds_read2_b64 v[220:223], v3 offset0:24 offset1:25
    v_mfma_f32_16x16x32_bf16 v[192:195], v[24:27], v[84:87], v[192:195]
    ds_read2_b64 v[224:227], v13 offset0:24 offset1:25
    s_waitcnt lgkmcnt(13)
    v_mfma_f32_16x16x32_bf16 v[180:183], v[16:19], v[88:91], v[180:183]
    ds_read2_b64 v[228:231], v11 offset0:72 offset1:73
    v_mfma_f32_16x16x32_bf16 v[196:199], v[24:27], v[88:91], v[196:199]
    s_waitcnt lgkmcnt(13)
    v_mfma_f32_16x16x32_bf16 v[184:187], v[16:19], v[92:95], v[184:187]
    ds_read_b64_tr_b16 v[36:37], v10 offset:1288
    v_mfma_f32_16x16x32_bf16 v[200:203], v[24:27], v[92:95], v[200:203]
    s_waitcnt lgkmcnt(11)
    v_mfma_f32_16x16x32_bf16 v[156:159], v[40:43], v[96:99], v[156:159]
    ds_read_b64_tr_b16 v[38:39], v10 offset:1320
    v_mfma_f32_16x16x32_bf16 v[172:175], v[48:51], v[96:99], v[172:175]
    ds_read2_b64 v[232:235], v2 offset0:72 offset1:73
    v_mfma_f32_16x16x32_bf16 v[188:191], v[56:59], v[96:99], v[188:191]
    ds_read2_b64 v[80:83], v3 offset0:72 offset1:73
    s_waitcnt lgkmcnt(13)
    v_mfma_f32_16x16x32_bf16 v[160:163], v[40:43], v[100:103], v[160:163]
    ds_read2_b64 v[84:87], v13 offset0:72 offset1:73
    v_mfma_f32_16x16x32_bf16 v[176:179], v[48:51], v[100:103], v[176:179]
    v_mfma_f32_16x16x32_bf16 v[192:195], v[56:59], v[100:103], v[192:195]
    s_waitcnt lgkmcnt(13)
    v_mfma_f32_16x16x32_bf16 v[164:167], v[40:43], v[104:107], v[164:167]
    ds_read2_b64 v[88:91], v11 offset0:64 offset1:65
    v_mfma_f32_16x16x32_bf16 v[180:183], v[48:51], v[104:107], v[180:183]
    v_mfma_f32_16x16x32_bf16 v[196:199], v[56:59], v[104:107], v[196:199]
    s_waitcnt lgkmcnt(13)
    v_mfma_f32_16x16x32_bf16 v[168:171], v[40:43], v[108:111], v[168:171]
    ds_read_b64_tr_b16 v[32:33], v10 offset:1032
    v_mfma_f32_16x16x32_bf16 v[184:187], v[48:51], v[108:111], v[184:187]
    v_mfma_f32_16x16x32_bf16 v[200:203], v[56:59], v[108:111], v[200:203]
    s_waitcnt lgkmcnt(13)
    v_mfma_f32_16x16x32_bf16 v[172:175], v[20:23], v[112:115], v[172:175]
    ds_read_b64_tr_b16 v[34:35], v10 offset:1064
    s_waitcnt lgkmcnt(12)
    v_mfma_f32_16x16x32_bf16 v[188:191], v[28:31], v[112:115], v[188:191]
    ds_read2_b64 v[92:95], v2 offset0:64 offset1:65
    s_waitcnt lgkmcnt(12)
    v_mfma_f32_16x16x32_bf16 v[176:179], v[20:23], v[216:219], v[176:179]
    ds_read2_b64 v[96:99], v3 offset0:64 offset1:65
    v_mfma_f32_16x16x32_bf16 v[192:195], v[28:31], v[216:219], v[192:195]
    ds_read2_b64 v[100:103], v13 offset0:64 offset1:65
    s_waitcnt lgkmcnt(13)
    v_mfma_f32_16x16x32_bf16 v[180:183], v[20:23], v[220:223], v[180:183]
    ds_read2_b64 v[104:107], v11 offset0:56 offset1:57
    v_mfma_f32_16x16x32_bf16 v[196:199], v[28:31], v[220:223], v[196:199]
    s_waitcnt lgkmcnt(13)
    v_mfma_f32_16x16x32_bf16 v[184:187], v[20:23], v[224:227], v[184:187]
    ds_read2_b64 v[108:111], v2 offset0:56 offset1:57
    v_mfma_f32_16x16x32_bf16 v[200:203], v[28:31], v[224:227], v[200:203]
    s_waitcnt lgkmcnt(11)
    v_mfma_f32_16x16x32_bf16 v[156:159], v[36:39], v[228:231], v[156:159]
    ds_read2_b64 v[112:115], v3 offset0:56 offset1:57
    v_mfma_f32_16x16x32_bf16 v[172:175], v[44:47], v[228:231], v[172:175]
    ds_read2_b64 v[216:219], v13 offset0:56 offset1:57
    v_mfma_f32_16x16x32_bf16 v[188:191], v[52:55], v[228:231], v[188:191]
    ds_read2_b64 v[220:223], v11 offset0:48 offset1:49
    s_waitcnt lgkmcnt(13)
    v_mfma_f32_16x16x32_bf16 v[160:163], v[36:39], v[232:235], v[160:163]
    ds_read2_b64 v[224:227], v2 offset0:48 offset1:49
    v_mfma_f32_16x16x32_bf16 v[176:179], v[44:47], v[232:235], v[176:179]
    v_mfma_f32_16x16x32_bf16 v[192:195], v[52:55], v[232:235], v[192:195]
    s_waitcnt lgkmcnt(13)
    v_mfma_f32_16x16x32_bf16 v[164:167], v[36:39], v[80:83], v[164:167]
    ds_read2_b64 v[228:231], v3 offset0:48 offset1:49
    v_mfma_f32_16x16x32_bf16 v[180:183], v[44:47], v[80:83], v[180:183]
    v_mfma_f32_16x16x32_bf16 v[196:199], v[52:55], v[80:83], v[196:199]
    s_waitcnt lgkmcnt(13)
    v_mfma_f32_16x16x32_bf16 v[168:171], v[36:39], v[84:87], v[168:171]
    ds_read2_b64 v[232:235], v13 offset0:48 offset1:49
    v_mfma_f32_16x16x32_bf16 v[184:187], v[44:47], v[84:87], v[184:187]
    v_mfma_f32_16x16x32_bf16 v[200:203], v[52:55], v[84:87], v[200:203]
    s_waitcnt lgkmcnt(11)
    v_mfma_f32_16x16x32_bf16 v[156:159], v[32:35], v[88:91], v[156:159]
    ds_read2_b64 v[80:83], v11 offset0:40 offset1:41
    v_mfma_f32_16x16x32_bf16 v[172:175], v[40:43], v[88:91], v[172:175]
    ds_read2_b64 v[84:87], v2 offset0:40 offset1:41
    v_mfma_f32_16x16x32_bf16 v[188:191], v[48:51], v[88:91], v[188:191]
    ds_read2_b64 v[88:91], v3 offset0:40 offset1:41
    s_waitcnt lgkmcnt(13)
    v_mfma_f32_16x16x32_bf16 v[160:163], v[32:35], v[92:95], v[160:163]
    v_mfma_f32_16x16x32_bf16 v[176:179], v[40:43], v[92:95], v[176:179]
    v_mfma_f32_16x16x32_bf16 v[192:195], v[48:51], v[92:95], v[192:195]
    ds_read2_b64 v[92:95], v13 offset0:40 offset1:41
    s_waitcnt lgkmcnt(13)
    v_mfma_f32_16x16x32_bf16 v[164:167], v[32:35], v[96:99], v[164:167]
    v_mfma_f32_16x16x32_bf16 v[180:183], v[40:43], v[96:99], v[180:183]
    v_mfma_f32_16x16x32_bf16 v[196:199], v[48:51], v[96:99], v[196:199]
    ds_read2_b64 v[96:99], v11 offset0:32 offset1:33
    s_waitcnt lgkmcnt(13)
    v_mfma_f32_16x16x32_bf16 v[168:171], v[32:35], v[100:103], v[168:171]
    v_mfma_f32_16x16x32_bf16 v[184:187], v[40:43], v[100:103], v[184:187]
    v_mfma_f32_16x16x32_bf16 v[200:203], v[48:51], v[100:103], v[200:203]
    ds_read2_b64 v[100:103], v2 offset0:32 offset1:33
    s_waitcnt lgkmcnt(13)
    v_mfma_f32_16x16x32_bf16 v[156:159], v[28:31], v[104:107], v[156:159]
    v_mfma_f32_16x16x32_bf16 v[172:175], v[36:39], v[104:107], v[172:175]
    v_mfma_f32_16x16x32_bf16 v[188:191], v[44:47], v[104:107], v[188:191]
    ds_read2_b64 v[104:107], v3 offset0:32 offset1:33
    s_waitcnt lgkmcnt(13)
    v_mfma_f32_16x16x32_bf16 v[160:163], v[28:31], v[108:111], v[160:163]
    v_mfma_f32_16x16x32_bf16 v[176:179], v[36:39], v[108:111], v[176:179]
    v_mfma_f32_16x16x32_bf16 v[192:195], v[44:47], v[108:111], v[192:195]
    ds_read2_b64 v[108:111], v13 offset0:32 offset1:33
    s_waitcnt lgkmcnt(13)
    v_mfma_f32_16x16x32_bf16 v[164:167], v[28:31], v[112:115], v[164:167]
    v_mov_b32 v7, 162912
    s_mov_b32 s81, 2000000
Lspin_31:
    ds_read_b32 v6, v7 offset:4
    s_waitcnt lgkmcnt(0)
    v_cmp_eq_u32 vcc, 0, v6
    s_cbranch_vccz Lspun_32
    s_sleep 1
    s_sub_u32 s81, s81, 1
    s_cbranch_scc0 Lspin_31
Lspun_32:
    s_lshl_b32 s72, s6, 1
    s_lshr_b32 s73, s3, 2
    s_xor_b32 s73, s73, s7
    s_and_b32 s73, s73, 1
    s_add_u32 s72, s72, s73
    s_mul_i32 s72, s72, 40
    s_and_b32 s73, s3, 3
    s_mul_i32 s73, s73, 10
    s_add_u32 s72, s72, s73
    s_lshl_b32 s72, s72, 10
    s_add_u32 s72, s72, 4194304
    v_lshlrev_b32 v6, 4, v1
    buffer_load_dwordx4 v[116:119], v6, s[60:63], s72 offen offset:0 sc1
    buffer_load_dwordx4 v[120:123], v6, s[60:63], s72 offen offset:1024 sc1
    buffer_load_dwordx4 v[124:127], v6, s[60:63], s72 offen offset:2048 sc1
    buffer_load_dwordx4 v[128:131], v6, s[60:63], s72 offen offset:3072 sc1
    s_add_u32 s72, s72, 4096
    buffer_load_dwordx4 v[132:135], v6, s[60:63], s72 offen offset:0 sc1
    buffer_load_dwordx4 v[136:139], v6, s[60:63], s72 offen offset:1024 sc1
    buffer_load_dwordx4 v[140:143], v6, s[60:63], s72 offen offset:2048 sc1
    buffer_load_dwordx4 v[144:147], v6, s[60:63], s72 offen offset:3072 sc1
    s_add_u32 s72, s72, 4096
    buffer_load_dwordx4 v[148:151], v6, s[60:63], s72 offen offset:0 sc1
    buffer_load_dwordx4 v[152:155], v6, s[60:63], s72 offen offset:1024 sc1
    v_mfma_f32_16x16x32_bf16 v[180:183], v[36:39], v[112:115], v[180:183]
    v_mfma_f32_16x16x32_bf16 v[196:199], v[44:47], v[112:115], v[196:199]
    v_mfma_f32_16x16x32_bf16 v[168:171], v[28:31], v[216:219], v[168:171]
    v_mfma_f32_16x16x32_bf16 v[184:187], v[36:39], v[216:219], v[184:187]
    v_mfma_f32_16x16x32_bf16 v[200:203], v[44:47], v[216:219], v[200:203]
    v_mfma_f32_16x16x32_bf16 v[156:159], v[24:27], v[220:223], v[156:159]
    v_mfma_f32_16x16x32_bf16 v[160:163], v[24:27], v[224:227], v[160:163]
    v_mfma_f32_16x16x32_bf16 v[164:167], v[24:27], v[228:231], v[164:167]
    v_mfma_f32_16x16x32_bf16 v[168:171], v[24:27], v[232:235], v[168:171]
    v_mfma_f32_16x16x32_bf16 v[156:159], v[20:23], v[80:83], v[156:159]
    v_mfma_f32_16x16x32_bf16 v[160:163], v[20:23], v[84:87], v[160:163]
    v_mfma_f32_16x16x32_bf16 v[164:167], v[20:23], v[88:91], v[164:167]
    v_mfma_f32_16x16x32_bf16 v[168:171], v[20:23], v[92:95], v[168:171]
    v_mfma_f32_16x16x32_bf16 v[156:159], v[16:19], v[96:99], v[156:159]
    v_mfma_f32_16x16x32_bf16 v[160:163], v[16:19], v[100:103], v[160:163]
    v_mfma_f32_16x16x32_bf16 v[164:167], v[16:19], v[104:107], v[164:167]
    v_mfma_f32_16x16x32_bf16 v[168:171], v[16:19], v[108:111], v[168:171]
    v_mfma_f32_16x16x32_bf16 v[172:175], v[32:35], v[220:223], v[172:175]
    v_mfma_f32_16x16x32_bf16 v[176:179], v[32:35], v[224:227], v[176:179]
    v_mfma_f32_16x16x32_bf16 v[180:183], v[32:35], v[228:231], v[180:183]
    s_nop 3
    v_add_f32 v163, v163, v166
    v_add_f32 v167, v167, v170
    v_mfma_f32_16x16x32_bf16 v[184:187], v[32:35], v[232:235], v[184:187]
    v_add_f32 v163, v163, v169
    v_mfma_f32_16x16x32_bf16 v[172:175], v[28:31], v[80:83], v[172:175]
    ds_bpermute_b32 v214, v14, v171
    v_mfma_f32_16x16x32_bf16 v[176:179], v[28:31], v[84:87], v[176:179]
    ds_bpermute_b32 v213, v14, v167
    v_mfma_f32_16x16x32_bf16 v[180:183], v[28:31], v[88:91], v[180:183]
    ds_bpermute_b32 v212, v14, v163
    v_mfma_f32_16x16x32_bf16 v[184:187], v[28:31], v[92:95], v[184:187]
    v_add_f32 v157, v157, v160
    v_add_f32 v158, v158, v161
    v_mfma_f32_16x16x32_bf16 v[172:175], v[24:27], v[96:99], v[172:175]
    v_add_f32 v159, v159, v162
    v_add_f32 v158, v158, v164
    v_mfma_f32_16x16x32_bf16 v[176:179], v[24:27], v[100:103], v[176:179]
    v_add_f32 v159, v159, v165
    v_add_f32 v159, v159, v168
    v_mfma_f32_16x16x32_bf16 v[180:183], v[24:27], v[104:107], v[180:183]
    v_mfma_f32_16x16x32_bf16 v[184:187], v[24:27], v[108:111], v[184:187]
    v_mfma_f32_16x16x32_bf16 v[188:191], v[40:43], v[220:223], v[188:191]
    v_mfma_f32_16x16x32_bf16 v[192:195], v[40:43], v[224:227], v[192:195]
    v_mfma_f32_16x16x32_bf16 v[196:199], v[40:43], v[228:231], v[196:199]
    s_nop 3
    v_add_f32 v179, v179, v182
    v_add_f32 v183, v183, v186
    v_mfma_f32_16x16x32_bf16 v[200:203], v[40:43], v[232:235], v[200:203]
    v_add_f32 v179, v179, v185
    v_mfma_f32_16x16x32_bf16 v[188:191], v[36:39], v[80:83], v[188:191]
    ds_bpermute_b32 v206, v14, v187
    v_mfma_f32_16x16x32_bf16 v[192:195], v[36:39], v[84:87], v[192:195]
    ds_bpermute_b32 v205, v14, v183
    v_mfma_f32_16x16x32_bf16 v[196:199], v[36:39], v[88:91], v[196:199]
    ds_bpermute_b32 v204, v14, v179
    v_mfma_f32_16x16x32_bf16 v[200:203], v[36:39], v[92:95], v[200:203]
    v_add_f32 v173, v173, v176
    v_add_f32 v174, v174, v177
    v_mfma_f32_16x16x32_bf16 v[188:191], v[32:35], v[96:99], v[188:191]
    v_add_f32 v175, v175, v178
    v_add_f32 v174, v174, v180
    v_mfma_f32_16x16x32_bf16 v[192:195], v[32:35], v[100:103], v[192:195]
    v_add_f32 v175, v175, v181
    v_add_f32 v175, v175, v184
    v_mfma_f32_16x16x32_bf16 v[196:199], v[32:35], v[104:107], v[196:199]
    s_waitcnt lgkmcnt(0)
    v_cndmask_b32 v180, v204, v212, s[74:75]
    v_cndmask_b32 v181, v205, v213, s[74:75]
    v_mfma_f32_16x16x32_bf16 v[200:203], v[32:35], v[108:111], v[200:203]
    v_cndmask_b32 v182, v206, v214, s[74:75]
    v_add_f32 v172, v172, v180
    v_add_f32 v173, v173, v181
    v_add_f32 v174, v174, v182
    v_cvt_pk_bf16_f32 v176, v172, v173
    v_cvt_pk_bf16_f32 v177, v174, v175
    buffer_store_dwordx2 v[176:177], v12, s[60:63], s70 offen offset:3072 sc1
    v_add_f32 v195, v195, v198
    v_add_f32 v199, v199, v202
    v_add_f32 v195, v195, v201
    ds_bpermute_b32 v210, v14, v203
    ds_bpermute_b32 v209, v14, v199
    ds_bpermute_b32 v208, v14, v195
    s_mov_b32 s81, 2000000
Lspin_33:
    ds_read_b128 v[4:7], v15 offset:8736
    s_waitcnt lgkmcnt(0)
    v_cmp_eq_u32 vcc, 0, v7
    s_cbranch_vccz Lspun_34
    s_sub_u32 s81, s81, 1
    s_cbranch_scc0 Lspin_33
Lspun_34:
    v_cndmask_b32 v164, v212, v4, s[74:75]
    v_cndmask_b32 v165, v213, v5, s[74:75]
    v_cndmask_b32 v166, v214, v6, s[74:75]
    v_add_f32 v156, v156, v164
    v_add_f32 v157, v157, v165
    v_add_f32 v158, v158, v166
    v_cvt_pk_bf16_f32 v160, v156, v157
    v_cvt_pk_bf16_f32 v161, v158, v159
    buffer_store_dwordx2 v[160:161], v12, s[60:63], s70 offen offset:2560 sc1
    v_add_f32 v189, v189, v192
    v_add_f32 v190, v190, v193
    v_add_f32 v191, v191, v194
    v_add_f32 v190, v190, v196
    v_add_f32 v191, v191, v197
    v_add_f32 v191, v191, v200
    v_cndmask_b32 v196, v208, v204, s[74:75]
    v_cndmask_b32 v197, v209, v205, s[74:75]
    v_cndmask_b32 v198, v210, v206, s[74:75]
    v_add_f32 v188, v188, v196
    v_add_f32 v189, v189, v197
    v_add_f32 v190, v190, v198
    v_cvt_pk_bf16_f32 v192, v188, v189
    v_cvt_pk_bf16_f32 v193, v190, v191
    buffer_store_dwordx2 v[192:193], v12, s[60:63], s70 offen offset:3584 sc1
    s_branch L_join1
L_aux:
    s_and_b32 s10, s3, 3
    s_lshl_b32 s43, s9, 2
    s_add_u32 s43, s43, s10
    s_lshr_b32 s42, s3, 2
    s_and_b32 s11, s10, 1
    s_mul_i32 s11, s11, 8752
    s_cmp_ge_u32 s10, 2
    s_cselect_b32 s12, 0, 43008
    s_add_u32 s79, s11, s12
    s_add_u32 s79, s79, 102400
    s_memrealtime s[14:15]
    s_waitcnt lgkmcnt(0)
    s_mov_b32 s60, s40
    s_and_b32 s61, s41, 0xffff
    s_mov_b32 s62, 268435456
    s_mov_b32 s63, 0x00020000
    s_mov_b32 s56, s38
    s_and_b32 s57, s39, 0xffff
    s_mov_b32 s58, 256
    s_mov_b32 s59, 0x00020000
    s_mov_b32 s44, s16
    s_and_b32 s45, s17, 0xffff
    s_mov_b32 s46, 2621440
    s_mov_b32 s47, 0x00020000
    s_mov_b32 s64, s20
    s_and_b32 s65, s21, 0xffff
    s_mov_b32 s66, 819200
    s_mov_b32 s67, 0x00020000
    s_mov_b32 s68, s30
    s_and_b32 s69, s31, 0xffff
    s_mov_b32 s70, 2621440
    s_mov_b32 s71, 0x00020000
    s_mov_b32 s52, s32
    s_and_b32 s53, s33, 0xffff
    s_mov_b32 s54, 1280
    s_mov_b32 s55, 0x00020000
    s_lshl_b32 s72, s43, 1
    v_mov_b32 v254, 0
    buffer_load_short_d16_hi v254, off, s[52:55], s72
    s_lshl_b32 s13, s9, 3
    s_add_u32 s13, s13, s3
    s_cmp_eq_u32 s13, 0
    s_cselect_b32 s13, 0, 2147483392
    s_or_b32 s14, s14, 1
    v_mov_b32 v8, s14
    s_mov_b64 exec, 1
    buffer_store_dword v8, off, s[56:59], s13 sc1
    s_mov_b64 exec, -1
    s_mul_i32 s72, s7, 160
    v_add_u32 v16, 0, v1
    v_mul_u32_u24 v17, 6554, v16
    v_lshrrev_b32 v17, 16, v17
    v_mul_u32_u24 v18, 10, v17
    v_sub_u32 v16, v16, v18
    v_and_b32 v18, 17, v17
    v_bfe_u32 v19, v17, 1, 2
    v_lshl_add_u32 v18, v19, 2, v18
    v_bfe_u32 v19, v17, 3, 1
    v_lshl_add_u32 v18, v19, 1, v18
    v_mul_u32_u24 v18, 1280, v18
    v_lshl_add_u32 v18, v16, 4, v18
    v_add_u32 v200, s72, v18
    v_add_u32 v16, 64, v1
    v_mul_u32_u24 v17, 6554, v16
    v_lshrrev_b32 v17, 16, v17
    v_mul_u32_u24 v18, 10, v17
    v_sub_u32 v16, v16, v18
    v_and_b32 v18, 17, v17
    v_bfe_u32 v19, v17, 1, 2
    v_lshl_add_u32 v18, v19, 2, v18
    v_bfe_u32 v19, v17, 3, 1
    v_lshl_add_u32 v18, v19, 1, v18
    v_mul_u32_u24 v18, 1280, v18
    v_lshl_add_u32 v18, v16, 4, v18
    v_add_u32 v201, s72, v18
    v_add_u32 v16, 128, v1
    v_mul_u32_u24 v17, 6554, v16
    v_lshrrev_b32 v17, 16, v17
    v_mul_u32_u24 v18, 10, v17
    v_sub_u32 v16, v16, v18
    v_and_b32 v18, 17, v17
    v_bfe_u32 v19, v17, 1, 2
    v_lshl_add_u32 v18, v19, 2, v18
    v_bfe_u32 v19, v17, 3, 1
    v_lshl_add_u32 v18, v19, 1, v18
    v_mul_u32_u24 v18, 1280, v18
    v_lshl_add_u32 v18, v16, 4, v18
    v_add_u32 v202, s72, v18
    v_add_u32 v16, 192, v1
    v_mul_u32_u24 v17, 6554, v16
    v_lshrrev_b32 v17, 16, v17
    v_mul_u32_u24 v18, 10, v17
    v_sub_u32 v16, v16, v18
    v_and_b32 v18, 17, v17
    v_bfe_u32 v19, v17, 1, 2
    v_lshl_add_u32 v18, v19, 2, v18
    v_bfe_u32 v19, v17, 3, 1
    v_lshl_add_u32 v18, v19, 1, v18
    v_mul_u32_u24 v18, 1280, v18
    v_lshl_add_u32 v18, v16, 4, v18
    v_add_u32 v203, s72, v18
    v_add_u32 v16, 256, v1
    v_mul_u32_u24 v17, 6554, v16
    v_lshrrev_b32 v17, 16, v17
    v_mul_u32_u24 v18, 10, v17
    v_sub_u32 v16, v16, v18
    v_and_b32 v18, 17, v17
    v_bfe_u32 v19, v17, 1, 2
    v_lshl_add_u32 v18, v19, 2, v18
    v_bfe_u32 v19, v17, 3, 1
    v_lshl_add_u32 v18, v19, 1, v18
    v_mul_u32_u24 v18, 1280, v18
    v_lshl_add_u32 v18, v16, 4, v18
    v_add_u32 v204, s72, v18
    s_and_b32 s72, s3, 3
    s_mul_i32 s22, s72, 15360
    s_mul_i32 s23, s72, 10240
    s_mul_i32 s25, s72, 204800
    s_add_u32 s26, s25, 204800
    s_and_b32 s73, s5, 7
    s_cmp_ge_u32 s73, 5
    s_cselect_b32 s1, 5, 0
    s_sub_u32 s73, s73, s1
    s_mul_i32 s24, s73, 40960
    s_add_u32 s24, s24, s25
    v_and_b32 v2, 15, v1
    v_lshrrev_b32 v3, 4, v1
    s_and_b32 s75, s5, 7
    s_cmp_ge_u32 s75, 5
    s_cselect_b32 s1, 5, 0
    s_sub_u32 s75, s75, s1
    s_and_b32 s1, s3, 3
    v_lshrrev_b32 v4, 1, v3
    v_lshlrev_b32 v4, 3, v4
    v_bfe_u32 v5, v1, 2, 2
    v_lshl_add_u32 v4, v5, 1, v4
    v_and_b32 v5, 1, v3
    v_add_u32 v4, v4, v5
    v_mul_u32_u24 v4, 160, v4
    v_and_b32 v5, 3, v1
    v_lshl_add_u32 v4, v5, 3, v4
    s_sub_u32 s75, 5, s75
    s_cmp_ge_u32 s75, 5
    s_cselect_b32 s75, 0, s75
    s_mul_i32 s72, s1, 15360
    s_add_u32 s72, s72, 40960
    s_mul_i32 s73, s1, 10240
    s_sub_u32 s73, s73, 15360
    s_cmp_ge_u32 s75, 3
    s_cselect_b32 s72, s73, s72
    s_mul_i32 s73, s75, 5120
    s_add_u32 s72, s72, s73
    v_add_u32 v236, s72, v4
    s_add_u32 s75, s75, 1
    s_cmp_ge_u32 s75, 5
    s_cselect_b32 s75, 0, s75
    s_mul_i32 s72, s1, 15360
    s_add_u32 s72, s72, 40960
    s_mul_i32 s73, s1, 10240
    s_sub_u32 s73, s73, 15360
    s_cmp_ge_u32 s75, 3
    s_cselect_b32 s72, s73, s72
    s_mul_i32 s73, s75, 5120
    s_add_u32 s72, s72, s73
    v_add_u32 v237, s72, v4
    s_add_u32 s75, s75, 1
    s_cmp_ge_u32 s75, 5
    s_cselect_b32 s75, 0, s75
    s_mul_i32 s72, s1, 15360
    s_add_u32 s72, s72, 40960
    s_mul_i32 s73, s1, 10240
    s_sub_u32 s73, s73, 15360
    s_cmp_ge_u32 s75, 3
    s_cselect_b32 s72, s73, s72
    s_mul_i32 s73, s75, 5120
    s_add_u32 s72, s72, s73
    v_add_u32 v238, s72, v4
    s_add_u32 s75, s75, 1
    s_cmp_ge_u32 s75, 5
    s_cselect_b32 s75, 0, s75
    s_mul_i32 s72, s1, 15360
    s_add_u32 s72, s72, 40960
    s_mul_i32 s73, s1, 10240
    s_sub_u32 s73, s73, 15360
    s_cmp_ge_u32 s75, 3
    s_cselect_b32 s72, s73, s72
    s_mul_i32 s73, s75, 5120
    s_add_u32 s72, s72, s73
    v_add_u32 v239, s72, v4
    s_add_u32 s75, s75, 1
    s_cmp_ge_u32 s75, 5
    s_cselect_b32 s75, 0, s75
    s_mul_i32 s72, s1, 15360
    s_add_u32 s72, s72, 40960
    s_mul_i32 s73, s1, 10240
    s_sub_u32 s73, s73, 15360
    s_cmp_ge_u32 s75, 3
    s_cselect_b32 s72, s73, s72
    s_mul_i32 s73, s75, 5120
    s_add_u32 s72, s72, s73
    v_add_u32 v240, s72, v4
    s_add_u32 s75, s75, 1
    v_lshrrev_b32 v4, 2, v1
    v_lshlrev_b32 v4, 7, v4
    v_lshl_add_u32 v4, v5, 3, v4
    s_lshr_b32 s73, s3, 2
    s_lshl_b32 s72, s73, 11
    s_lshl_b32 s74, s1, 5
    s_add_u32 s72, s72, s74
    s_add_u32 s72, s72, 81920
    v_add_u32 v249, s72, v4
    s_mul_i32 s72, s1, 10752
    s_add_u32 s72, s72, 102400
    v_lshlrev_b32 v4, 4, v3
    v_and_b32 v6, 8, v2
    v_lshlrev_b32 v6, 2, v6
    v_xor_b32 v6, v6, v4
    v_lshl_add_u32 v6, v2, 6, v6
    v_add_u32 v244, s72, v6
    v_lshrrev_b32 v6, 2, v2
    v_add_u32 v6, 16, v6
    v_lshl_add_u32 v6, v6, 6, v4
    v_xor_b32 v7, 32, v4
    v_add_u32 v7, 1280, v7
    v_cmp_eq_u32 vcc, 0, v5
    s_nop 1
    v_cndmask_b32 v6, v7, v6, vcc
    v_add_u32 v245, s72, v6
    v_lshlrev_b32 v251, 4, v1
    s_mul_i32 s72, s1, 20480
    s_xor_b32 s74, s73, s7
    s_and_b32 s74, s74, 1
    s_mul_i32 s74, s74, 10240
    s_add_u32 s72, s72, s74
    v_add_u32 v246, s72, v251
    s_mul_i32 s72, s1, 5120
    s_lshl_b32 s74, s73, 10
    s_add_u32 s72, s72, s74
    v_add_u32 v247, s72, v251
    s_lshl_b32 s72, s6, 6
    s_lshl_b32 s74, s1, 4
    s_add_u32 s72, s72, s74
    v_add_u32 v4, s72, v2
    v_mul_u32_u24 v4, 1280, v4
    v_lshl_add_u32 v4, v3, 3, v4
    s_mul_i32 s72, s7, 160
    s_lshl_b32 s74, s73, 5
    s_add_u32 s72, s72, s74
    v_add_u32 v248, s72, v4
    s_mul_i32 s72, s7, 80
    s_lshl_b32 s74, s3, 3
    s_add_u32 s72, s72, s74
    v_lshrrev_b32 v4, 3, v1
    v_add_u32 v4, s72, v4
    v_mul_u32_u24 v4, 4224, v4
    v_and_b32 v6, 7, v1
    v_lshl_add_u32 v4, v6, 4, v4
    s_lshl_b32 s72, s6, 7
    s_add_u32 s72, s72, 6815744
    v_add_u32 v250, s72, v4
    v_lshlrev_b32 v2, 1, v1
    s_add_u32 s72, s1, 5
    s_and_b32 s73, s72, 3
    s_lshl_b32 s73, s73, 4
    s_bfe_u32 s72, s72, 0x10002
    s_lshl_b32 s72, s72, 3
    s_add_u32 s73, s73, s72
    s_mul_i32 s72, s1, 1344
    s_add_u32 s72, s72, 102400
    v_mul_u32_u24 v3, 3121, v2
    v_lshrrev_b32 v3, 16, v3
    v_mul_u32_u24 v4, 21, v3
    v_sub_u32 v4, v2, v4
    v_and_b32 v5, 3, v4
    v_lshrrev_b32 v6, 2, v4
    v_lshl_add_u32 v5, v5, 2, v6
    v_cmp_gt_u32 vcc, 16, v4
    s_nop 1
    v_cndmask_b32 v4, v4, v5, vcc
    v_add_u32 v3, s1, v3
    v_and_b32 v5, 3, v3
    v_lshlrev_b32 v5, 4, v5
    v_and_b32 v6, 8, v4
    v_lshlrev_b32 v6, 2, v6
    v_cmp_eq_u32 vcc, 20, v4
    s_nop 1
    v_cndmask_b32 v6, v6, 32, vcc
    v_xor_b32 v5, v5, v6
    v_lshl_add_u32 v4, v4, 6, v5
    v_lshrrev_b32 v3, 2, v3
    v_lshl_add_u32 v4, v3, 3, v4
    v_cmp_gt_u32 vcc, 105, v2
    v_mov_b32 v5, s73
    s_nop 0
    v_cndmask_b32 v4, v5, v4, vcc
    v_add_u32 v241, s72, v4
    v_add_u32 v2, 1, v2
    v_mul_u32_u24 v3, 3121, v2
    v_lshrrev_b32 v3, 16, v3
    v_mul_u32_u24 v4, 21, v3
    v_sub_u32 v4, v2, v4
    v_and_b32 v5, 3, v4
    v_lshrrev_b32 v6, 2, v4
    v_lshl_add_u32 v5, v5, 2, v6
    v_cmp_gt_u32 vcc, 16, v4
    s_nop 1
    v_cndmask_b32 v4, v4, v5, vcc
    v_add_u32 v3, s1, v3
    v_and_b32 v5, 3, v3
    v_lshlrev_b32 v5, 4, v5
    v_and_b32 v6, 8, v4
    v_lshlrev_b32 v6, 2, v6
    v_cmp_eq_u32 vcc, 20, v4
    s_nop 1
    v_cndmask_b32 v6, v6, 32, vcc
    v_xor_b32 v5, v5, v6
    v_lshl_add_u32 v4, v4, 6, v5
    v_lshrrev_b32 v3, 2, v3
    v_lshl_add_u32 v4, v3, 3, v4
    v_cmp_gt_u32 vcc, 105, v2
    v_mov_b32 v5, s73
    s_nop 0
    v_cndmask_b32 v4, v5, v4, vcc
    v_add_u32 v242, s72, v4
    s_mov_b32 s29, 2147483392
    s_waitcnt vmcnt(18)
    s_mov_b32 s72, 0xffff0000
    v_lshlrev_b32 v72, 16, v64
    v_lshlrev_b32 v73, 16, v66
    v_lshlrev_b32 v74, 16, v68
    v_lshlrev_b32 v75, 16, v70
    v_and_b32 v76, s72, v64
    v_and_b32 v77, s72, v66
    v_and_b32 v78, s72, v68
    v_and_b32 v79, s72, v70
    v_lshlrev_b32 v80, 16, v65
    v_lshlrev_b32 v81, 16, v67
    v_lshlrev_b32 v82, 16, v69
    v_lshlrev_b32 v83, 16, v71
    v_and_b32 v84, s72, v65
    v_and_b32 v85, s72, v67
    v_and_b32 v86, s72, v69
    v_and_b32 v87, s72, v71
    v_lshlrev_b32 v88, 16, v24
    v_and_b32 v89, s72, v24
    v_lshlrev_b32 v90, 16, v25
    v_and_b32 v91, s72, v25
    v_lshlrev_b32 v92, 16, v26
    v_and_b32 v93, s72, v26
    v_lshlrev_b32 v94, 16, v27
    v_and_b32 v95, s72, v27
    v_lshlrev_b32 v96, 16, v28
    v_and_b32 v97, s72, v28
    v_lshlrev_b32 v98, 16, v29
    v_and_b32 v99, s72, v29
    v_pk_mul_f32 v[104:105], v[88:89], v[84:85]
    v_pk_mul_f32 v[106:107], v[90:91], v[86:87]
    v_pk_fma_f32 v[104:105], v[92:93], v[80:81], v[104:105]
    v_pk_fma_f32 v[106:107], v[94:95], v[82:83], v[106:107]
    v_pk_fma_f32 v[104:105], v[96:97], v[76:77], v[104:105]
    v_pk_fma_f32 v[106:107], v[98:99], v[78:79], v[106:107]
    s_waitcnt vmcnt(17)
    v_lshlrev_b32 v100, 16, v30
    v_and_b32 v101, s72, v30
    v_lshlrev_b32 v102, 16, v31
    v_and_b32 v103, s72, v31
    v_pk_fma_f32 v[104:105], v[100:101], v[72:73], v[104:105]
    v_pk_fma_f32 v[106:107], v[102:103], v[74:75], v[106:107]
    s_waitcnt vmcnt(13)
    v_lshlrev_b32 v136, 16, v46
    v_and_b32 v137, s72, v46
    v_lshlrev_b32 v138, 16, v47
    v_and_b32 v139, s72, v47
    v_pk_mul_f32 v[104:105], v[104:105], v[136:137]
    v_pk_mul_f32 v[106:107], v[106:107], v[138:139]
    v_pk_mul_f32 v[108:109], v[92:93], v[84:85]
    v_pk_mul_f32 v[110:111], v[94:95], v[86:87]
    v_pk_fma_f32 v[108:109], v[96:97], v[80:81], v[108:109]
    v_pk_fma_f32 v[110:111], v[98:99], v[82:83], v[110:111]
    v_pk_fma_f32 v[108:109], v[100:101], v[76:77], v[108:109]
    v_pk_fma_f32 v[110:111], v[102:103], v[78:79], v[110:111]
    v_lshlrev_b32 v88, 16, v32
    v_and_b32 v89, s72, v32
    v_lshlrev_b32 v90, 16, v33
    v_and_b32 v91, s72, v33
    v_pk_fma_f32 v[108:109], v[88:89], v[72:73], v[108:109]
    v_pk_fma_f32 v[110:111], v[90:91], v[74:75], v[110:111]
    s_waitcnt vmcnt(12)
    v_lshlrev_b32 v136, 16, v48
    v_and_b32 v137, s72, v48
    v_lshlrev_b32 v138, 16, v49
    v_and_b32 v139, s72, v49
    v_pk_mul_f32 v[108:109], v[108:109], v[136:137]
    v_pk_mul_f32 v[110:111], v[110:111], v[138:139]
    v_pk_mul_f32 v[112:113], v[96:97], v[84:85]
    v_pk_mul_f32 v[114:115], v[98:99], v[86:87]
    v_pk_fma_f32 v[112:113], v[100:101], v[80:81], v[112:113]
    v_pk_fma_f32 v[114:115], v[102:103], v[82:83], v[114:115]
    v_pk_fma_f32 v[112:113], v[88:89], v[76:77], v[112:113]
    v_pk_fma_f32 v[114:115], v[90:91], v[78:79], v[114:115]
    v_lshlrev_b32 v92, 16, v34
    v_and_b32 v93, s72, v34
    v_lshlrev_b32 v94, 16, v35
    v_and_b32 v95, s72, v35
    v_pk_fma_f32 v[112:113], v[92:93], v[72:73], v[112:113]
    v_pk_fma_f32 v[114:115], v[94:95], v[74:75], v[114:115]
    s_waitcnt vmcnt(11)
    v_lshlrev_b32 v136, 16, v50
    v_and_b32 v137, s72, v50
    v_lshlrev_b32 v138, 16, v51
    v_and_b32 v139, s72, v51
    v_pk_mul_f32 v[112:113], v[112:113], v[136:137]
    v_pk_mul_f32 v[114:115], v[114:115], v[138:139]
    v_pk_mul_f32 v[116:117], v[100:101], v[84:85]
    v_pk_mul_f32 v[118:119], v[102:103], v[86:87]
    v_pk_fma_f32 v[116:117], v[88:89], v[80:81], v[116:117]
    v_pk_fma_f32 v[118:119], v[90:91], v[82:83], v[118:119]
    v_pk_fma_f32 v[116:117], v[92:93], v[76:77], v[116:117]
    v_pk_fma_f32 v[118:119], v[94:95], v[78:79], v[118:119]
    v_lshlrev_b32 v96, 16, v36
    v_and_b32 v97, s72, v36
    v_lshlrev_b32 v98, 16, v37
    v_and_b32 v99, s72, v37
    v_pk_fma_f32 v[116:117], v[96:97], v[72:73], v[116:117]
    v_pk_fma_f32 v[118:119], v[98:99], v[74:75], v[118:119]
    s_waitcnt vmcnt(10)
    v_lshlrev_b32 v136, 16, v52
    v_and_b32 v137, s72, v52
    v_lshlrev_b32 v138, 16, v53
    v_and_b32 v139, s72, v53
    v_pk_mul_f32 v[116:117], v[116:117], v[136:137]
    v_pk_mul_f32 v[118:119], v[118:119], v[138:139]
    v_pk_mul_f32 v[120:121], v[88:89], v[84:85]
    v_pk_mul_f32 v[122:123], v[90:91], v[86:87]
    v_pk_fma_f32 v[120:121], v[92:93], v[80:81], v[120:121]
    v_pk_fma_f32 v[122:123], v[94:95], v[82:83], v[122:123]
    v_pk_fma_f32 v[120:121], v[96:97], v[76:77], v[120:121]
    v_pk_fma_f32 v[122:123], v[98:99], v[78:79], v[122:123]
    s_waitcnt vmcnt(9)
    v_lshlrev_b32 v100, 16, v38
    v_and_b32 v101, s72, v38
    v_lshlrev_b32 v102, 16, v39
    v_and_b32 v103, s72, v39
    v_pk_fma_f32 v[120:121], v[100:101], v[72:73], v[120:121]
    v_pk_fma_f32 v[122:123], v[102:103], v[74:75], v[122:123]
    s_waitcnt vmcnt(5)
    v_lshlrev_b32 v136, 16, v54
    v_and_b32 v137, s72, v54
    v_lshlrev_b32 v138, 16, v55
    v_and_b32 v139, s72, v55
    v_pk_mul_f32 v[120:121], v[120:121], v[136:137]
    v_pk_mul_f32 v[122:123], v[122:123], v[138:139]
    v_cvt_pk_bf16_f32 v140, v120, v104
    ds_write_b32 v156, v140 offset:0
    v_cvt_pk_bf16_f32 v141, v121, v105
    ds_write_b32 v156, v141 offset:64
    v_cvt_pk_bf16_f32 v142, v122, v106
    ds_write_b32 v156, v142 offset:128
    v_cvt_pk_bf16_f32 v143, v123, v107
    ds_write_b32 v156, v143 offset:192
    v_pk_mul_f32 v[124:125], v[92:93], v[84:85]
    v_pk_mul_f32 v[126:127], v[94:95], v[86:87]
    v_pk_fma_f32 v[124:125], v[96:97], v[80:81], v[124:125]
    v_pk_fma_f32 v[126:127], v[98:99], v[82:83], v[126:127]
    v_pk_fma_f32 v[124:125], v[100:101], v[76:77], v[124:125]
    v_pk_fma_f32 v[126:127], v[102:103], v[78:79], v[126:127]
    v_lshlrev_b32 v88, 16, v40
    v_and_b32 v89, s72, v40
    v_lshlrev_b32 v90, 16, v41
    v_and_b32 v91, s72, v41
    v_pk_fma_f32 v[124:125], v[88:89], v[72:73], v[124:125]
    v_pk_fma_f32 v[126:127], v[90:91], v[74:75], v[126:127]
    s_waitcnt vmcnt(4)
    v_lshlrev_b32 v136, 16, v56
    v_and_b32 v137, s72, v56
    v_lshlrev_b32 v138, 16, v57
    v_and_b32 v139, s72, v57
    v_pk_mul_f32 v[124:125], v[124:125], v[136:137]
    v_pk_mul_f32 v[126:127], v[126:127], v[138:139]
    v_cvt_pk_bf16_f32 v144, v124, v108
    ds_write_b32 v156, v144 offset:16
    v_cvt_pk_bf16_f32 v145, v125, v109
    ds_write_b32 v156, v145 offset:80
    v_cvt_pk_bf16_f32 v146, v126, v110
    ds_write_b32 v156, v146 offset:144
    v_cvt_pk_bf16_f32 v147, v127, v111
    ds_write_b32 v156, v147 offset:208
    v_pk_mul_f32 v[128:129], v[96:97], v[84:85]
    v_pk_mul_f32 v[130:131], v[98:99], v[86:87]
    v_pk_fma_f32 v[128:129], v[100:101], v[80:81], v[128:129]
    v_pk_fma_f32 v[130:131], v[102:103], v[82:83], v[130:131]
    v_pk_fma_f32 v[128:129], v[88:89], v[76:77], v[128:129]
    v_pk_fma_f32 v[130:131], v[90:91], v[78:79], v[130:131]
    v_lshlrev_b32 v92, 16, v42
    v_and_b32 v93, s72, v42
    v_lshlrev_b32 v94, 16, v43
    v_and_b32 v95, s72, v43
    v_pk_fma_f32 v[128:129], v[92:93], v[72:73], v[128:129]
    v_pk_fma_f32 v[130:131], v[94:95], v[74:75], v[130:131]
    s_waitcnt vmcnt(3)
    v_lshlrev_b32 v136, 16, v58
    v_and_b32 v137, s72, v58
    v_lshlrev_b32 v138, 16, v59
    v_and_b32 v139, s72, v59
    v_pk_mul_f32 v[128:129], v[128:129], v[136:137]
    v_pk_mul_f32 v[130:131], v[130:131], v[138:139]
    v_cvt_pk_bf16_f32 v148, v128, v112
    ds_write_b32 v156, v148 offset:32
    v_cvt_pk_bf16_f32 v149, v129, v113
    ds_write_b32 v156, v149 offset:96
    v_cvt_pk_bf16_f32 v150, v130, v114
    ds_write_b32 v156, v150 offset:160
    v_cvt_pk_bf16_f32 v151, v131, v115
    ds_write_b32 v156, v151 offset:224
    v_pk_mul_f32 v[132:133], v[100:101], v[84:85]
    v_pk_mul_f32 v[134:135], v[102:103], v[86:87]
    v_pk_fma_f32 v[132:133], v[88:89], v[80:81], v[132:133]
    v_pk_fma_f32 v[134:135], v[90:91], v[82:83], v[134:135]
    v_pk_fma_f32 v[132:133], v[92:93], v[76:77], v[132:133]
    v_pk_fma_f32 v[134:135], v[94:95], v[78:79], v[134:135]
    v_lshlrev_b32 v96, 16, v44
    v_and_b32 v97, s72, v44
    v_lshlrev_b32 v98, 16, v45
    v_and_b32 v99, s72, v45
    v_pk_fma_f32 v[132:133], v[96:97], v[72:73], v[132:133]
    v_pk_fma_f32 v[134:135], v[98:99], v[74:75], v[134:135]
    s_waitcnt vmcnt(2)
    v_lshlrev_b32 v136, 16, v60
    v_and_b32 v137, s72, v60
    v_lshlrev_b32 v138, 16, v61
    v_and_b32 v139, s72, v61
    v_pk_mul_f32 v[132:133], v[132:133], v[136:137]
    v_pk_mul_f32 v[134:135], v[134:135], v[138:139]
    v_cvt_pk_bf16_f32 v152, v132, v116
    ds_write_b32 v156, v152 offset:48
    v_cvt_pk_bf16_f32 v153, v133, v117
    ds_write_b32 v156, v153 offset:112
    v_cvt_pk_bf16_f32 v154, v134, v118
    ds_write_b32 v156, v154 offset:176
    v_cvt_pk_bf16_f32 v155, v135, v119
    ds_write_b32 v156, v155 offset:240
    ds_read_b128 v[24:27], v157 offset:0
    ds_read_b128 v[28:31], v157 offset:1088
    ds_read_b128 v[32:35], v157 offset:2176
    ds_read_b128 v[36:39], v157 offset:3264
    s_mov_b32 s72, 0
    s_waitcnt lgkmcnt(3)
    buffer_store_dwordx4 v[24:27], v158, s[60:63], s72 offen sc1
    s_add_u32 s72, s72, 66560
    s_waitcnt lgkmcnt(2)
    buffer_store_dwordx4 v[28:31], v158, s[60:63], s72 offen sc1
    s_add_u32 s72, s72, 66560
    s_waitcnt lgkmcnt(1)
    buffer_store_dwordx4 v[32:35], v158, s[60:63], s72 offen sc1
    s_add_u32 s72, s72, 66560
    s_waitcnt lgkmcnt(0)
    buffer_store_dwordx4 v[36:39], v158, s[60:63], s72 offen sc1
L_auxnp:
    v_lshlrev_b32 v2, 4, v1
    v_mov_b32 v4, -1
    v_mov_b32 v5, -1
    v_mov_b32 v6, -1
    v_mov_b32 v7, -1
    s_lshl_b32 s12, s9, 9
    s_lshl_b32 s13, s3, 6
    s_add_u32 s12, s12, s13
    s_add_u32 s12, s12, 3670016
    s_mov_b64 exec, -1
    v_lshrrev_b32 v3, 2, v1
    v_mul_u32_u24 v3, 32896, v3
    v_and_b32 v9, 3, v1
    v_lshl_add_u32 v3, v9, 4, v3
    s_mov_b32 exec_hi, 0
    buffer_store_dwordx4 v[4:7], v3, s[60:63], s12 offen sc1
    s_mov_b64 exec, -1
    s_mov_b32 s81, 100000
Lspin_35:
    buffer_load_dword v8, off, s[56:59], 0 sc1
    s_waitcnt vmcnt(0)
    v_cmp_eq_u32 vcc, 0, v8
    s_cbranch_vccz Lspun_36
    s_sleep 8
    s_sub_u32 s81, s81, 1
    s_cbranch_scc0 Lspin_35
Lspun_36:
    v_readfirstlane_b32 s0, v8
    v_mov_b32 v12, 162912
    v_mov_b32 v16, 0
    v_mov_b32 v17, 0
    v_mov_b32 v18, 0
    v_mov_b32 v19, 0
    ds_write_b128 v12, v[16:19]
    ds_write_b128 v12, v[16:19] offset:16
    ds_write_b128 v12, v[16:19] offset:32
    s_waitcnt lgkmcnt(0)
    s_barrier
    s_cmp_eq_u32 s3, 0
    s_cbranch_scc0 L_aux2
    s_lshl_b32 s72, s2, 7
    s_add_u32 s72, s72, 3964928
    s_mov_b64 exec, 1
    buffer_store_dword v8, off, s[60:63], s72 sc1
    s_mov_b64 exec, -1
L_aux2:
    s_sub_u32 s12, s5, 24
    s_lshl_b32 s12, s12, 3
    s_add_u32 s12, s12, s3
    s_mul_i32 s12, s12, 12800
    s_and_b32 s13, s4, 1
    s_mul_i32 s13, s13, 640
    s_add_u32 s12, s12, s13
    v_min_u32 v2, 49, v1
    v_mul_u32_u24 v3, 13108, v2
    v_lshrrev_b32 v3, 16, v3
    v_mul_u32_u24 v4, 640, v3
    v_lshl_add_u32 v4, v2, 7, v4
    buffer_load_dword v255, v4, s[64:67], s12 offen
    v_lshlrev_b32 v16, 4, v1
    s_lshl_b32 s72, s43, 12
    s_lshl_b32 s73, s42, 11
    s_add_u32 s72, s72, s73
    s_add_u32 s73, s73, s79
    s_add_u32 m0, s73, 32
    s_nop 0
    buffer_load_dwordx4 v16, s[68:71], s72 offen offset:0 nt lds
    buffer_load_dwordx4 v16, s[68:71], s72 offen offset:1024 nt lds
    v_mov_b32 v18, 0
    v_mov_b32 v19, 0
    v_bfe_u32 v16, v1, 4, 1
    v_mul_u32_u24 v16, 1152, v16
    v_and_b32 v17, 15, v1
    v_lshl_add_u32 v16, v17, 3, v16
    s_mul_i32 s72, s42, 2304
    s_add_u32 s72, s72, s79
    v_add_u32 v16, s72, v16
    ds_write_b64 v16, v[18:19] offset:5152
    v_and_b32 v16, 3, v1
    v_lshlrev_b32 v16, 3, v16
    v_add_u32 v16, s79, v16
    ds_write_b64 v16, v[18:19]
    v_and_b32 v16, 1, v1
    v_lshlrev_b32 v16, 3, v16
    v_add_u32 v16, s79, v16
    ds_write_b64 v16, v[18:19] offset:8736
    s_cmp_ge_u32 s3, 4
    s_cbranch_scc0 L_aux3
    s_add_u32 m0, s22, 40960
    s_nop 0
    buffer_load_dwordx4 v200, s[64:67], s24 offen lds
    s_add_u32 m0, s22, 41984
    s_nop 0
    buffer_load_dwordx4 v201, s[64:67], s24 offen lds
    s_add_u32 m0, s22, 43008
    s_nop 0
    buffer_load_dwordx4 v202, s[64:67], s24 offen lds
    s_add_u32 m0, s22, 44032
    s_nop 0
    buffer_load_dwordx4 v203, s[64:67], s24 offen lds
    s_add_u32 m0, s22, 45056
    s_nop 0
    buffer_load_dwordx4 v204, s[64:67], s24 offen lds
    s_add_u32 s24, s24, 40960
    s_cmp_eq_u32 s24, s26
    s_cselect_b32 s24, s25, s24
    s_add_u32 m0, s22, 46080
    s_nop 0
    buffer_load_dwordx4 v200, s[64:67], s24 offen lds
    s_add_u32 m0, s22, 47104
    s_nop 0
    buffer_load_dwordx4 v201, s[64:67], s24 offen lds
    s_add_u32 m0, s22, 48128
    s_nop 0
    buffer_load_dwordx4 v202, s[64:67], s24 offen lds
    s_add_u32 m0, s22, 49152
    s_nop 0
    buffer_load_dwordx4 v203, s[64:67], s24 offen lds
    s_add_u32 m0, s22, 50176
    s_nop 0
    buffer_load_dwordx4 v204, s[64:67], s24 offen lds
    s_add_u32 s24, s24, 40960
    s_cmp_eq_u32 s24, s26
    s_cselect_b32 s24, s25, s24
    s_add_u32 m0, s22, 51200
    s_nop 0
    buffer_load_dwordx4 v200, s[64:67], s24 offen lds
    s_add_u32 m0, s22, 52224
    s_nop 0
    buffer_load_dwordx4 v201, s[64:67], s24 offen lds
    s_add_u32 m0, s22, 53248
    s_nop 0
    buffer_load_dwordx4 v202, s[64:67], s24 offen lds
    s_add_u32 m0, s22, 54272
    s_nop 0
    buffer_load_dwordx4 v203, s[64:67], s24 offen lds
    s_add_u32 m0, s22, 55296
    s_nop 0
    buffer_load_dwordx4 v204, s[64:67], s24 offen lds
    s_add_u32 s24, s24, 40960
    s_cmp_eq_u32 s24, s26
    s_cselect_b32 s24, s25, s24
    s_add_u32 m0, s23, 0
    s_nop 0
    buffer_load_dwordx4 v200, s[64:67], s24 offen lds
    s_add_u32 m0, s23, 1024
    s_nop 0
    buffer_load_dwordx4 v201, s[64:67], s24 offen lds
    s_add_u32 m0, s23, 2048
    s_nop 0
    buffer_load_dwordx4 v202, s[64:67], s24 offen lds
    s_add_u32 m0, s23, 3072
    s_nop 0
    buffer_load_dwordx4 v203, s[64:67], s24 offen lds
    s_add_u32 m0, s23, 4096
    s_nop 0
    buffer_load_dwordx4 v204, s[64:67], s24 offen lds
    s_add_u32 s24, s24, 40960
    s_cmp_eq_u32 s24, s26
    s_cselect_b32 s24, s25, s24
    s_add_u32 m0, s23, 5120
    s_nop 0
    buffer_load_dwordx4 v200, s[64:67], s24 offen lds
    s_add_u32 m0, s23, 6144
    s_nop 0
    buffer_load_dwordx4 v201, s[64:67], s24 offen lds
    s_add_u32 m0, s23, 7168
    s_nop 0
    buffer_load_dwordx4 v202, s[64:67], s24 offen lds
    s_add_u32 m0, s23, 8192
    s_nop 0
    buffer_load_dwordx4 v203, s[64:67], s24 offen lds
    s_add_u32 m0, s23, 9216
    s_nop 0
    buffer_load_dwordx4 v204, s[64:67], s24 offen lds
    s_branch L_aux4
L_aux3:
    s_cmp_eq_u32 s3, 0
    s_cbranch_scc0 L_aux4
    v_lshlrev_b32 v2, 7, v1
    s_mov_b32 s72, 3964928
    s_mov_b32 s73, 3973120
    s_mov_b32 s74, 3981312
    s_mov_b32 s81, 100000
Lspin_37:
    buffer_load_dword v4, v2, s[60:63], s72 offen sc1
    buffer_load_dword v5, v2, s[60:63], s73 offen sc1
    buffer_load_dword v6, v2, s[60:63], s74 offen sc1
    s_waitcnt vmcnt(0)
    v_xor_b32 v4, s0, v4
    v_xor_b32 v5, s0, v5
    v_xor_b32 v6, s0, v6
    v_or_b32 v4, v4, v5
    v_or_b32 v4, v4, v6
    v_cmp_ne_u32 vcc, 0, v4
    s_cbranch_vccz Lspun_38
    s_sleep 4
    s_sub_u32 s81, s81, 1
    s_cbranch_scc0 Lspin_37
Lspun_38:
    s_mov_b32 s72, 3989504
    s_mov_b32 s81, 100000
Lspin_39:
    buffer_load_dword v4, v2, s[60:63], s72 offen sc1
    s_waitcnt vmcnt(0)
    v_xor_b32 v4, s0, v4
    v_cmp_ne_u32 vcc, 0, v4
    s_cbranch_vccz Lspun_40
    s_sleep 4
    s_sub_u32 s81, s81, 1
    s_cbranch_scc0 Lspin_39
Lspun_40:
    s_lshl_b32 s72, s4, 7
    s_add_u32 s72, s72, 3956736
    s_cmp_eq_u32 s5, 24
    s_cselect_b32 s72, s72, 2147483392
    s_mov_b64 exec, 1
    buffer_store_dword v8, off, s[60:63], s72 sc1
    s_mov_b64 exec, -1
L_aux4:
    s_barrier
    v_lshlrev_b32 v16, 4, v1
    s_lshr_b32 s72, s43, 1
    s_mul_i32 s72, s72, 8320
    s_and_b32 s73, s43, 1
    s_lshl_b32 s73, s73, 1
    s_add_u32 s73, s73, s42
    s_lshl_b32 s73, s73, 11
    s_add_u32 s72, s72, s73
    buffer_load_dwordx4 v[18:21], v16, s[60:63], s72 offen offset:0 sc1
    buffer_load_dwordx4 v[22:25], v16, s[60:63], s72 offen offset:1024 sc1
    s_and_b32 s73, s43, 1
    s_mul_i32 s72, s73, 9264
    s_sub_u32 s72, s79, s72
    s_lshl_b32 s73, s42, 8
    s_sub_u32 s72, s72, s73
    s_add_u32 s72, s72, 5008
    v_and_b32 v17, 3, v1
    v_mul_u32_u24 v17, 1152, v17
    v_bfe_u32 v16, v1, 2, 1
    v_mul_u32_u24 v16, 8752, v16
    v_add_u32 v17, v17, v16
    v_and_b32 v16, 56, v1
    v_lshlrev_b32 v16, 1, v16
    v_sub_u32 v17, v17, v16
    v_add_u32 v17, s72, v17
    s_cmp_eq_u32 s42, 0
    s_cselect_b32 s72, 32, 0
    s_add_u32 s72, s72, s79
    v_mov_b32 v16, s72
    v_mov_b32 v26, 0
    s_waitcnt vmcnt(0)
    ds_read_u16_d16_hi v26, v16
    ds_write_b128 v17, v[18:21] offset:128
    ds_write_b128 v17, v[22:25] offset:0
    s_waitcnt lgkmcnt(2)
    v_add_f32 v26, v26, v254
    v_cvt_pk_bf16_f32 v26, v26, v26
    ds_write_b16 v16, v26
    s_waitcnt lgkmcnt(0)
    s_barrier
    s_lshl_b32 s14, s9, 1
    s_mov_b32 s13, 3
    s_cmp_ge_u32 s3, 4
    s_cbranch_scc1 L_aux5
    s_lshl_b32 s10, s3, 12
    s_add_u32 s10, s10, 123904
    v_add_u32 v252, s10, v251
    ds_write_b128 v252, v[236:239] offset:0
    ds_write_b128 v252, v[240:243] offset:1024
    ds_write_b128 v252, v[244:247] offset:2048
    ds_write_b128 v252, v[248:251] offset:3072
    s_waitcnt lgkmcnt(0)
    v_lshrrev_b32 v8, 4, v1
    v_and_b32 v9, 15, v1
    v_lshlrev_b32 v11, 3, v9
    v_lshlrev_b32 v12, 4, v8
    v_sub_u32 v11, v12, v11
    s_add_u32 s70, s79, 4248
    v_add_u32 v11, s70, v11
    v_bfe_u32 v10, v1, 2, 2
    v_and_b32 v13, 3, v1
    v_add_u32 v10, v10, v13
    v_lshlrev_b32 v10, 3, v10
    v_lshl_add_u32 v10, v8, 6, v10
    v_add_u32 v10, s79, v10
    v_add_u32 v2, 1152, v11
    v_add_u32 v3, 2304, v11
    v_add_u32 v13, 3456, v11
    ds_read2_b64 v[80:83], v11 offset0:24 offset1:25
    ds_read_b64_tr_b16 v[20:21], v10 offset:264
    ds_read_b64_tr_b16 v[22:23], v10 offset:296
    ds_read_b64_tr_b16 v[28:29], v10 offset:776
    ds_read_b64_tr_b16 v[30:31], v10 offset:808
    ds_read2_b64 v[84:87], v2 offset0:24 offset1:25
    ds_read2_b64 v[88:91], v3 offset0:24 offset1:25
    ds_read2_b64 v[92:95], v13 offset0:24 offset1:25
    ds_read2_b64 v[96:99], v11 offset0:120 offset1:121
    ds_read_b64_tr_b16 v[36:37], v10 offset:1288
    ds_read_b64_tr_b16 v[38:39], v10 offset:1320
    ds_read_b64_tr_b16 v[44:45], v10 offset:1800
    v_lshl_add_u32 v12, v9, 2, v8
    v_subrev_u32 v14, 16, v1
    v_add_u32 v15, 47, v1
    v_cmp_gt_u32 vcc, 16, v1
    s_nop 1
    v_cndmask_b32 v14, v14, v15, vcc
    v_cmp_eq_u32 s[74:75], 0, v1
    s_nop 1
    v_cndmask_b32 v14, v14, 63, s[74:75]
    v_lshlrev_b32 v14, 2, v14
    v_lshlrev_b32 v12, 3, v12
    s_mul_i32 s70, s43, 4224
    s_add_u32 s70, s70, 6815744
    v_mov_b32 v15, s79
    v_mov_b32 v4, 0
    v_mov_b32 v5, 0
    v_mov_b32 v6, 0
    s_waitcnt lgkmcnt(9)
    v_mfma_f32_16x16x32_bf16 v[208:211], v[20:23], v[80:83], 0
    ds_read_b64_tr_b16 v[46:47], v10 offset:1832
    s_waitcnt lgkmcnt(8)
    v_mfma_f32_16x16x32_bf16 v[224:227], v[28:31], v[80:83], 0
    ds_read_b64_tr_b16 v[52:53], v10 offset:2312
    s_waitcnt lgkmcnt(8)
    v_mfma_f32_16x16x32_bf16 v[212:215], v[20:23], v[84:87], 0
    ds_read_b64_tr_b16 v[54:55], v10 offset:2344
    v_mfma_f32_16x16x32_bf16 v[228:231], v[28:31], v[84:87], 0
    ds_read_b64_tr_b16 v[60:61], v10 offset:2824
    s_waitcnt lgkmcnt(9)
    v_mfma_f32_16x16x32_bf16 v[216:219], v[20:23], v[88:91], 0
    ds_read_b64_tr_b16 v[62:63], v10 offset:2856
    v_mfma_f32_16x16x32_bf16 v[232:235], v[28:31], v[88:91], 0
    ds_read_b64_tr_b16 v[68:69], v10 offset:3336
    s_waitcnt lgkmcnt(10)
    v_mfma_f32_16x16x32_bf16 v[220:223], v[20:23], v[92:95], 0
    ds_read_b64_tr_b16 v[70:71], v10 offset:3368
    v_mfma_f32_16x16x32_bf16 v[236:239], v[28:31], v[92:95], 0
    ds_read_b64_tr_b16 v[76:77], v10 offset:3848
    s_waitcnt lgkmcnt(11)
    v_mfma_f32_16x16x32_bf16 v[112:115], v[20:23], v[96:99], 0
    ds_read_b64_tr_b16 v[78:79], v10 offset:3880
    v_mfma_f32_16x16x32_bf16 v[128:131], v[28:31], v[96:99], 0
    ds_read2_b64 v[100:103], v2 offset0:120 offset1:121
    s_waitcnt lgkmcnt(11)
    v_mfma_f32_16x16x32_bf16 v[144:147], v[36:39], v[96:99], 0
    ds_read2_b64 v[104:107], v3 offset0:120 offset1:121
    s_waitcnt lgkmcnt(10)
    v_mfma_f32_16x16x32_bf16 v[160:163], v[44:47], v[96:99], 0
    ds_read2_b64 v[108:111], v13 offset0:120 offset1:121
    s_waitcnt lgkmcnt(9)
    v_mfma_f32_16x16x32_bf16 v[176:179], v[52:55], v[96:99], 0
    ds_read2_b64 v[80:83], v11 offset0:112 offset1:113
    s_waitcnt lgkmcnt(8)
    v_mfma_f32_16x16x32_bf16 v[192:195], v[60:63], v[96:99], 0
    ds_read_b64_tr_b16 v[16:17], v10 offset:8
    s_waitcnt lgkmcnt(7)
    v_mfma_f32_16x16x32_bf16 v[208:211], v[68:71], v[96:99], v[208:211]
    ds_read_b64_tr_b16 v[18:19], v10 offset:40
    s_waitcnt lgkmcnt(6)
    v_mfma_f32_16x16x32_bf16 v[224:227], v[76:79], v[96:99], v[224:227]
    ds_read_b64_tr_b16 v[24:25], v10 offset:520
    s_waitcnt lgkmcnt(6)
    v_mfma_f32_16x16x32_bf16 v[116:119], v[20:23], v[100:103], 0
    ds_read_b64_tr_b16 v[26:27], v10 offset:552
    v_mfma_f32_16x16x32_bf16 v[132:135], v[28:31], v[100:103], 0
    ds_read_b64_tr_b16 v[32:33], v10 offset:1032
    v_mfma_f32_16x16x32_bf16 v[148:151], v[36:39], v[100:103], 0
    ds_read_b64_tr_b16 v[34:35], v10 offset:1064
    v_mfma_f32_16x16x32_bf16 v[164:167], v[44:47], v[100:103], 0
    ds_read_b64_tr_b16 v[40:41], v10 offset:1544
    v_mfma_f32_16x16x32_bf16 v[180:183], v[52:55], v[100:103], 0
    ds_read_b64_tr_b16 v[42:43], v10 offset:1576
    v_mfma_f32_16x16x32_bf16 v[196:199], v[60:63], v[100:103], 0
    ds_read_b64_tr_b16 v[48:49], v10 offset:2056
    v_mfma_f32_16x16x32_bf16 v[212:215], v[68:71], v[100:103], v[212:215]
    ds_read_b64_tr_b16 v[50:51], v10 offset:2088
    v_mfma_f32_16x16x32_bf16 v[228:231], v[76:79], v[100:103], v[228:231]
    ds_read_b64_tr_b16 v[56:57], v10 offset:2568
    s_waitcnt lgkmcnt(13)
    v_mfma_f32_16x16x32_bf16 v[120:123], v[20:23], v[104:107], 0
    ds_read_b64_tr_b16 v[58:59], v10 offset:2600
    v_mfma_f32_16x16x32_bf16 v[136:139], v[28:31], v[104:107], 0
    v_mfma_f32_16x16x32_bf16 v[152:155], v[36:39], v[104:107], 0
    v_mfma_f32_16x16x32_bf16 v[168:171], v[44:47], v[104:107], 0
    v_mfma_f32_16x16x32_bf16 v[184:187], v[52:55], v[104:107], 0
    v_mfma_f32_16x16x32_bf16 v[200:203], v[60:63], v[104:107], 0
    v_mfma_f32_16x16x32_bf16 v[216:219], v[68:71], v[104:107], v[216:219]
    v_mfma_f32_16x16x32_bf16 v[232:235], v[76:79], v[104:107], v[232:235]
    s_waitcnt lgkmcnt(13)
    v_mfma_f32_16x16x32_bf16 v[124:127], v[20:23], v[108:111], 0
    ds_read_b64_tr_b16 v[64:65], v10 offset:3080
    v_mfma_f32_16x16x32_bf16 v[140:143], v[28:31], v[108:111], 0
    v_mfma_f32_16x16x32_bf16 v[156:159], v[36:39], v[108:111], 0
    v_mfma_f32_16x16x32_bf16 v[172:175], v[44:47], v[108:111], 0
    v_mfma_f32_16x16x32_bf16 v[188:191], v[52:55], v[108:111], 0
    v_mfma_f32_16x16x32_bf16 v[204:207], v[60:63], v[108:111], 0
    v_mfma_f32_16x16x32_bf16 v[220:223], v[68:71], v[108:111], v[220:223]
    v_mfma_f32_16x16x32_bf16 v[236:239], v[76:79], v[108:111], v[236:239]
    s_waitcnt lgkmcnt(11)
    v_mfma_f32_16x16x32_bf16 v[112:115], v[16:19], v[80:83], v[112:115]
    ds_read_b64_tr_b16 v[66:67], v10 offset:3112
    s_waitcnt lgkmcnt(10)
    v_mfma_f32_16x16x32_bf16 v[128:131], v[24:27], v[80:83], v[128:131]
    ds_read_b64_tr_b16 v[72:73], v10 offset:3592
    s_waitcnt lgkmcnt(9)
    v_mfma_f32_16x16x32_bf16 v[144:147], v[32:35], v[80:83], v[144:147]
    ds_read_b64_tr_b16 v[74:75], v10 offset:3624
    s_waitcnt lgkmcnt(8)
    v_mfma_f32_16x16x32_bf16 v[160:163], v[40:43], v[80:83], v[160:163]
    ds_read2_b64 v[84:87], v2 offset0:112 offset1:113
    s_waitcnt lgkmcnt(7)
    v_mfma_f32_16x16x32_bf16 v[176:179], v[48:51], v[80:83], v[176:179]
    ds_read2_b64 v[88:91], v3 offset0:112 offset1:113
    s_waitcnt lgkmcnt(6)
    v_mfma_f32_16x16x32_bf16 v[192:195], v[56:59], v[80:83], v[192:195]
    ds_read2_b64 v[92:95], v13 offset0:112 offset1:113
    s_waitcnt lgkmcnt(5)
    v_mfma_f32_16x16x32_bf16 v[208:211], v[64:67], v[80:83], v[208:211]
    ds_read2_b64 v[96:99], v11 offset0:0 offset1:1
    s_waitcnt lgkmcnt(4)
    v_mfma_f32_16x16x32_bf16 v[224:227], v[72:75], v[80:83], v[224:227]
    ds_read2_b64 v[100:103], v2 offset0:0 offset1:1
    s_waitcnt lgkmcnt(4)
    v_mfma_f32_16x16x32_bf16 v[116:119], v[16:19], v[84:87], v[116:119]
    ds_read2_b64 v[104:107], v3 offset0:0 offset1:1
    v_mfma_f32_16x16x32_bf16 v[132:135], v[24:27], v[84:87], v[132:135]
    ds_read2_b64 v[108:111], v13 offset0:0 offset1:1
    v_mfma_f32_16x16x32_bf16 v[148:151], v[32:35], v[84:87], v[148:151]
    ds_read2_b64 v[80:83], v11 offset0:104 offset1:105
    v_mfma_f32_16x16x32_bf16 v[164:167], v[40:43], v[84:87], v[164:167]
    v_mfma_f32_16x16x32_bf16 v[180:183], v[48:51], v[84:87], v[180:183]
    v_mfma_f32_16x16x32_bf16 v[196:199], v[56:59], v[84:87], v[196:199]
    v_mfma_f32_16x16x32_bf16 v[212:215], v[64:67], v[84:87], v[212:215]
    v_mfma_f32_16x16x32_bf16 v[228:231], v[72:75], v[84:87], v[228:231]
    ds_read2_b64 v[84:87], v2 offset0:104 offset1:105
    s_waitcnt lgkmcnt(7)
    v_mfma_f32_16x16x32_bf16 v[120:123], v[16:19], v[88:91], v[120:123]
    v_mfma_f32_16x16x32_bf16 v[136:139], v[24:27], v[88:91], v[136:139]
    v_mfma_f32_16x16x32_bf16 v[152:155], v[32:35], v[88:91], v[152:155]
    v_mfma_f32_16x16x32_bf16 v[168:171], v[40:43], v[88:91], v[168:171]
    v_mfma_f32_16x16x32_bf16 v[184:187], v[48:51], v[88:91], v[184:187]
    v_mfma_f32_16x16x32_bf16 v[200:203], v[56:59], v[88:91], v[200:203]
    v_mfma_f32_16x16x32_bf16 v[216:219], v[64:67], v[88:91], v[216:219]
    v_mfma_f32_16x16x32_bf16 v[232:235], v[72:75], v[88:91], v[232:235]
    ds_read2_b64 v[88:91], v3 offset0:104 offset1:105
    s_waitcnt lgkmcnt(7)
    v_mfma_f32_16x16x32_bf16 v[124:127], v[16:19], v[92:95], v[124:127]
    v_mfma_f32_16x16x32_bf16 v[140:143], v[24:27], v[92:95], v[140:143]
    v_mfma_f32_16x16x32_bf16 v[156:159], v[32:35], v[92:95], v[156:159]
    v_mfma_f32_16x16x32_bf16 v[172:175], v[40:43], v[92:95], v[172:175]
    v_add_f32 v119, v119, v122
    s_nop 3
    v_add_f32 v123, v123, v126
    v_mfma_f32_16x16x32_bf16 v[188:191], v[48:51], v[92:95], v[188:191]
    v_add_f32 v119, v119, v125
    v_mfma_f32_16x16x32_bf16 v[204:207], v[56:59], v[92:95], v[204:207]
    ds_bpermute_b32 v242, v14, v127
    v_mfma_f32_16x16x32_bf16 v[220:223], v[64:67], v[92:95], v[220:223]
    ds_bpermute_b32 v241, v14, v123
    v_mfma_f32_16x16x32_bf16 v[236:239], v[72:75], v[92:95], v[236:239]
    ds_bpermute_b32 v240, v14, v119
    s_waitcnt lgkmcnt(9)
    v_mfma_f32_16x16x32_bf16 v[224:227], v[16:19], v[96:99], v[224:227]
    v_add_f32 v113, v113, v116
    v_add_f32 v114, v114, v117
    s_waitcnt lgkmcnt(8)
    v_mfma_f32_16x16x32_bf16 v[228:231], v[16:19], v[100:103], v[228:231]
    v_add_f32 v115, v115, v118
    v_add_f32 v114, v114, v120
    s_waitcnt lgkmcnt(7)
    v_mfma_f32_16x16x32_bf16 v[232:235], v[16:19], v[104:107], v[232:235]
    v_add_f32 v115, v115, v121
    v_add_f32 v115, v115, v124
    s_waitcnt lgkmcnt(6)
    v_mfma_f32_16x16x32_bf16 v[236:239], v[16:19], v[108:111], v[236:239]
    s_waitcnt lgkmcnt(0)
    v_cndmask_b32 v120, v240, v4, s[74:75]
    v_cndmask_b32 v121, v241, v5, s[74:75]
    v_mfma_f32_16x16x32_bf16 v[128:131], v[20:23], v[80:83], v[128:131]
    v_cndmask_b32 v122, v242, v6, s[74:75]
    v_add_f32 v112, v112, v120
    v_mfma_f32_16x16x32_bf16 v[144:147], v[28:31], v[80:83], v[144:147]
    v_add_f32 v113, v113, v121
    v_add_f32 v114, v114, v122
    v_mfma_f32_16x16x32_bf16 v[160:163], v[36:39], v[80:83], v[160:163]
    v_cvt_pk_bf16_f32 v116, v112, v113
    v_cvt_pk_bf16_f32 v117, v114, v115
    v_mfma_f32_16x16x32_bf16 v[176:179], v[44:47], v[80:83], v[176:179]
    buffer_store_dwordx2 v[116:117], v12, s[60:63], s70 offen offset:0 sc1
    v_mfma_f32_16x16x32_bf16 v[192:195], v[52:55], v[80:83], v[192:195]
    ds_read2_b64 v[92:95], v13 offset0:104 offset1:105
    v_mfma_f32_16x16x32_bf16 v[208:211], v[60:63], v[80:83], v[208:211]
    ds_read2_b64 v[96:99], v11 offset0:8 offset1:9
    v_mfma_f32_16x16x32_bf16 v[224:227], v[68:71], v[80:83], v[224:227]
    ds_read2_b64 v[100:103], v2 offset0:8 offset1:9
    v_mfma_f32_16x16x32_bf16 v[132:135], v[20:23], v[84:87], v[132:135]
    ds_read2_b64 v[104:107], v3 offset0:8 offset1:9
    v_mfma_f32_16x16x32_bf16 v[148:151], v[28:31], v[84:87], v[148:151]
    ds_read2_b64 v[108:111], v13 offset0:8 offset1:9
    v_mfma_f32_16x16x32_bf16 v[164:167], v[36:39], v[84:87], v[164:167]
    ds_read2_b64 v[112:115], v11 offset0:96 offset1:97
    v_mfma_f32_16x16x32_bf16 v[180:183], v[44:47], v[84:87], v[180:183]
    ds_read2_b64 v[120:123], v2 offset0:96 offset1:97
    v_mfma_f32_16x16x32_bf16 v[196:199], v[52:55], v[84:87], v[196:199]
    ds_read2_b64 v[124:127], v3 offset0:96 offset1:97
    v_mfma_f32_16x16x32_bf16 v[212:215], v[60:63], v[84:87], v[212:215]
    v_mfma_f32_16x16x32_bf16 v[228:231], v[68:71], v[84:87], v[228:231]
    ds_read2_b64 v[80:83], v13 offset0:96 offset1:97
    v_mfma_f32_16x16x32_bf16 v[136:139], v[20:23], v[88:91], v[136:139]
    v_mfma_f32_16x16x32_bf16 v[152:155], v[28:31], v[88:91], v[152:155]
    v_mfma_f32_16x16x32_bf16 v[168:171], v[36:39], v[88:91], v[168:171]
    v_mfma_f32_16x16x32_bf16 v[184:187], v[44:47], v[88:91], v[184:187]
    v_mfma_f32_16x16x32_bf16 v[200:203], v[52:55], v[88:91], v[200:203]
    v_mfma_f32_16x16x32_bf16 v[216:219], v[60:63], v[88:91], v[216:219]
    v_mfma_f32_16x16x32_bf16 v[232:235], v[68:71], v[88:91], v[232:235]
    ds_read2_b64 v[84:87], v11 offset0:16 offset1:17
    s_waitcnt lgkmcnt(9)
    v_mfma_f32_16x16x32_bf16 v[140:143], v[20:23], v[92:95], v[140:143]
    v_mfma_f32_16x16x32_bf16 v[156:159], v[28:31], v[92:95], v[156:159]
    ds_read2_b64 v[88:91], v2 offset0:16 offset1:17
    v_mfma_f32_16x16x32_bf16 v[172:175], v[36:39], v[92:95], v[172:175]
    v_mfma_f32_16x16x32_bf16 v[188:191], v[44:47], v[92:95], v[188:191]
    v_mfma_f32_16x16x32_bf16 v[204:207], v[52:55], v[92:95], v[204:207]
    v_mfma_f32_16x16x32_bf16 v[220:223], v[60:63], v[92:95], v[220:223]
    v_mfma_f32_16x16x32_bf16 v[236:239], v[68:71], v[92:95], v[236:239]
    ds_read2_b64 v[92:95], v3 offset0:16 offset1:17
    s_waitcnt lgkmcnt(10)
    v_mfma_f32_16x16x32_bf16 v[224:227], v[20:23], v[96:99], v[224:227]
    ds_read2_b64 v[96:99], v13 offset0:16 offset1:17
    s_waitcnt lgkmcnt(10)
    v_mfma_f32_16x16x32_bf16 v[228:231], v[20:23], v[100:103], v[228:231]
    ds_read2_b64 v[100:103], v11 offset0:88 offset1:89
    s_waitcnt lgkmcnt(10)
    v_mfma_f32_16x16x32_bf16 v[232:235], v[20:23], v[104:107], v[232:235]
    s_waitcnt lgkmcnt(9)
    v_mfma_f32_16x16x32_bf16 v[236:239], v[20:23], v[108:111], v[236:239]
    s_waitcnt lgkmcnt(8)
    v_mfma_f32_16x16x32_bf16 v[128:131], v[16:19], v[112:115], v[128:131]
    v_mfma_f32_16x16x32_bf16 v[144:147], v[24:27], v[112:115], v[144:147]
    v_mfma_f32_16x16x32_bf16 v[160:163], v[32:35], v[112:115], v[160:163]
    ds_read2_b64 v[104:107], v2 offset0:88 offset1:89
    v_mfma_f32_16x16x32_bf16 v[176:179], v[40:43], v[112:115], v[176:179]
    v_mfma_f32_16x16x32_bf16 v[192:195], v[48:51], v[112:115], v[192:195]
    v_mfma_f32_16x16x32_bf16 v[208:211], v[56:59], v[112:115], v[208:211]
    v_mfma_f32_16x16x32_bf16 v[224:227], v[64:67], v[112:115], v[224:227]
    s_waitcnt lgkmcnt(8)
    v_mfma_f32_16x16x32_bf16 v[132:135], v[16:19], v[120:123], v[132:135]
    v_mfma_f32_16x16x32_bf16 v[148:151], v[24:27], v[120:123], v[148:151]
    ds_read2_b64 v[108:111], v3 offset0:88 offset1:89
    v_mfma_f32_16x16x32_bf16 v[164:167], v[32:35], v[120:123], v[164:167]
    v_mfma_f32_16x16x32_bf16 v[180:183], v[40:43], v[120:123], v[180:183]
    v_mfma_f32_16x16x32_bf16 v[196:199], v[48:51], v[120:123], v[196:199]
    v_mfma_f32_16x16x32_bf16 v[212:215], v[56:59], v[120:123], v[212:215]
    v_mfma_f32_16x16x32_bf16 v[228:231], v[64:67], v[120:123], v[228:231]
    s_waitcnt lgkmcnt(8)
    v_mfma_f32_16x16x32_bf16 v[136:139], v[16:19], v[124:127], v[136:139]
    ds_read2_b64 v[112:115], v13 offset0:88 offset1:89
    v_mfma_f32_16x16x32_bf16 v[152:155], v[24:27], v[124:127], v[152:155]
    v_mfma_f32_16x16x32_bf16 v[168:171], v[32:35], v[124:127], v[168:171]
    v_mfma_f32_16x16x32_bf16 v[184:187], v[40:43], v[124:127], v[184:187]
    v_mfma_f32_16x16x32_bf16 v[200:203], v[48:51], v[124:127], v[200:203]
    v_mfma_f32_16x16x32_bf16 v[216:219], v[56:59], v[124:127], v[216:219]
    v_mfma_f32_16x16x32_bf16 v[232:235], v[64:67], v[124:127], v[232:235]
    ds_read2_b64 v[120:123], v11 offset0:80 offset1:81
    s_waitcnt lgkmcnt(9)
    v_mfma_f32_16x16x32_bf16 v[140:143], v[16:19], v[80:83], v[140:143]
    v_mfma_f32_16x16x32_bf16 v[156:159], v[24:27], v[80:83], v[156:159]
    v_mfma_f32_16x16x32_bf16 v[172:175], v[32:35], v[80:83], v[172:175]
    v_mfma_f32_16x16x32_bf16 v[188:191], v[40:43], v[80:83], v[188:191]
    v_add_f32 v135, v135, v138
    s_nop 3
    v_add_f32 v139, v139, v142
    v_mfma_f32_16x16x32_bf16 v[204:207], v[48:51], v[80:83], v[204:207]
    v_add_f32 v135, v135, v141
    v_mfma_f32_16x16x32_bf16 v[220:223], v[56:59], v[80:83], v[220:223]
    ds_bpermute_b32 v246, v14, v143
    v_mfma_f32_16x16x32_bf16 v[236:239], v[64:67], v[80:83], v[236:239]
    ds_bpermute_b32 v245, v14, v139
    s_waitcnt lgkmcnt(10)
    v_mfma_f32_16x16x32_bf16 v[208:211], v[16:19], v[84:87], v[208:211]
    ds_bpermute_b32 v244, v14, v135
    v_mfma_f32_16x16x32_bf16 v[224:227], v[24:27], v[84:87], v[224:227]
    v_add_f32 v129, v129, v132
    v_add_f32 v130, v130, v133
    s_waitcnt lgkmcnt(10)
    v_mfma_f32_16x16x32_bf16 v[212:215], v[16:19], v[88:91], v[212:215]
    v_add_f32 v131, v131, v134
    v_add_f32 v130, v130, v136
    v_mfma_f32_16x16x32_bf16 v[228:231], v[24:27], v[88:91], v[228:231]
    v_add_f32 v131, v131, v137
    v_add_f32 v131, v131, v140
    s_waitcnt lgkmcnt(9)
    v_mfma_f32_16x16x32_bf16 v[216:219], v[16:19], v[92:95], v[216:219]
    s_waitcnt lgkmcnt(0)
    v_cndmask_b32 v136, v244, v240, s[74:75]
    v_cndmask_b32 v137, v245, v241, s[74:75]
    v_mfma_f32_16x16x32_bf16 v[232:235], v[24:27], v[92:95], v[232:235]
    v_cndmask_b32 v138, v246, v242, s[74:75]
    v_add_f32 v128, v128, v136
    v_mfma_f32_16x16x32_bf16 v[220:223], v[16:19], v[96:99], v[220:223]
    v_add_f32 v129, v129, v137
    v_add_f32 v130, v130, v138
    v_mfma_f32_16x16x32_bf16 v[236:239], v[24:27], v[96:99], v[236:239]
    v_cvt_pk_bf16_f32 v132, v128, v129
    v_cvt_pk_bf16_f32 v133, v130, v131
    v_mfma_f32_16x16x32_bf16 v[144:147], v[20:23], v[100:103], v[144:147]
    buffer_store_dwordx2 v[132:133], v12, s[60:63], s70 offen offset:512 sc1
    v_mfma_f32_16x16x32_bf16 v[160:163], v[28:31], v[100:103], v[160:163]
    ds_read2_b64 v[124:127], v2 offset0:80 offset1:81
    v_mfma_f32_16x16x32_bf16 v[176:179], v[36:39], v[100:103], v[176:179]
    ds_read2_b64 v[80:83], v3 offset0:80 offset1:81
    v_mfma_f32_16x16x32_bf16 v[192:195], v[44:47], v[100:103], v[192:195]
    ds_read2_b64 v[84:87], v13 offset0:80 offset1:81
    v_mfma_f32_16x16x32_bf16 v[208:211], v[52:55], v[100:103], v[208:211]
    v_mfma_f32_16x16x32_bf16 v[224:227], v[60:63], v[100:103], v[224:227]
    v_mfma_f32_16x16x32_bf16 v[148:151], v[20:23], v[104:107], v[148:151]
    v_mfma_f32_16x16x32_bf16 v[164:167], v[28:31], v[104:107], v[164:167]
    v_mfma_f32_16x16x32_bf16 v[180:183], v[36:39], v[104:107], v[180:183]
    ds_read2_b64 v[88:91], v11 offset0:72 offset1:73
    v_mfma_f32_16x16x32_bf16 v[196:199], v[44:47], v[104:107], v[196:199]
    v_mfma_f32_16x16x32_bf16 v[212:215], v[52:55], v[104:107], v[212:215]
    v_mfma_f32_16x16x32_bf16 v[228:231], v[60:63], v[104:107], v[228:231]
    v_mfma_f32_16x16x32_bf16 v[152:155], v[20:23], v[108:111], v[152:155]
    v_mfma_f32_16x16x32_bf16 v[168:171], v[28:31], v[108:111], v[168:171]
    ds_read2_b64 v[92:95], v2 offset0:72 offset1:73
    v_mfma_f32_16x16x32_bf16 v[184:187], v[36:39], v[108:111], v[184:187]
    v_mfma_f32_16x16x32_bf16 v[200:203], v[44:47], v[108:111], v[200:203]
    v_mfma_f32_16x16x32_bf16 v[216:219], v[52:55], v[108:111], v[216:219]
    v_mfma_f32_16x16x32_bf16 v[232:235], v[60:63], v[108:111], v[232:235]
    v_mfma_f32_16x16x32_bf16 v[156:159], v[20:23], v[112:115], v[156:159]
    ds_read2_b64 v[96:99], v3 offset0:72 offset1:73
    v_mfma_f32_16x16x32_bf16 v[172:175], v[28:31], v[112:115], v[172:175]
    v_mfma_f32_16x16x32_bf16 v[188:191], v[36:39], v[112:115], v[188:191]
    v_mfma_f32_16x16x32_bf16 v[204:207], v[44:47], v[112:115], v[204:207]
    v_mfma_f32_16x16x32_bf16 v[220:223], v[52:55], v[112:115], v[220:223]
    v_mfma_f32_16x16x32_bf16 v[236:239], v[60:63], v[112:115], v[236:239]
    ds_read2_b64 v[128:131], v13 offset0:72 offset1:73
    v_mfma_f32_16x16x32_bf16 v[144:147], v[16:19], v[120:123], v[144:147]
    v_mfma_f32_16x16x32_bf16 v[160:163], v[24:27], v[120:123], v[160:163]
    v_mfma_f32_16x16x32_bf16 v[176:179], v[32:35], v[120:123], v[176:179]
    v_mfma_f32_16x16x32_bf16 v[192:195], v[40:43], v[120:123], v[192:195]
    v_mfma_f32_16x16x32_bf16 v[208:211], v[48:51], v[120:123], v[208:211]
    ds_read2_b64 v[136:139], v11 offset0:64 offset1:65
    v_mfma_f32_16x16x32_bf16 v[224:227], v[56:59], v[120:123], v[224:227]
    s_waitcnt lgkmcnt(7)
    v_mfma_f32_16x16x32_bf16 v[148:151], v[16:19], v[124:127], v[148:151]
    v_mfma_f32_16x16x32_bf16 v[164:167], v[24:27], v[124:127], v[164:167]
    v_mfma_f32_16x16x32_bf16 v[180:183], v[32:35], v[124:127], v[180:183]
    v_mfma_f32_16x16x32_bf16 v[196:199], v[40:43], v[124:127], v[196:199]
    ds_read2_b64 v[140:143], v2 offset0:64 offset1:65
    v_mfma_f32_16x16x32_bf16 v[212:215], v[48:51], v[124:127], v[212:215]
    v_mfma_f32_16x16x32_bf16 v[228:231], v[56:59], v[124:127], v[228:231]
    s_waitcnt lgkmcnt(7)
    v_mfma_f32_16x16x32_bf16 v[152:155], v[16:19], v[80:83], v[152:155]
    v_mfma_f32_16x16x32_bf16 v[168:171], v[24:27], v[80:83], v[168:171]
    v_mfma_f32_16x16x32_bf16 v[184:187], v[32:35], v[80:83], v[184:187]
    ds_read2_b64 v[100:103], v3 offset0:64 offset1:65
    v_mfma_f32_16x16x32_bf16 v[200:203], v[40:43], v[80:83], v[200:203]
    v_mfma_f32_16x16x32_bf16 v[216:219], v[48:51], v[80:83], v[216:219]
    v_mfma_f32_16x16x32_bf16 v[232:235], v[56:59], v[80:83], v[232:235]
    s_waitcnt lgkmcnt(7)
    v_mfma_f32_16x16x32_bf16 v[156:159], v[16:19], v[84:87], v[156:159]
    v_mfma_f32_16x16x32_bf16 v[172:175], v[24:27], v[84:87], v[172:175]
    ds_read2_b64 v[104:107], v13 offset0:64 offset1:65
    v_mfma_f32_16x16x32_bf16 v[188:191], v[32:35], v[84:87], v[188:191]
    v_mfma_f32_16x16x32_bf16 v[204:207], v[40:43], v[84:87], v[204:207]
    v_add_f32 v151, v151, v154
    s_nop 2
    v_add_f32 v155, v155, v158
    v_mfma_f32_16x16x32_bf16 v[220:223], v[48:51], v[84:87], v[220:223]
    v_add_f32 v151, v151, v157
    v_mfma_f32_16x16x32_bf16 v[236:239], v[56:59], v[84:87], v[236:239]
    ds_bpermute_b32 v250, v14, v159
    s_waitcnt lgkmcnt(8)
    v_mfma_f32_16x16x32_bf16 v[160:163], v[20:23], v[88:91], v[160:163]
    ds_bpermute_b32 v249, v14, v155
    v_mfma_f32_16x16x32_bf16 v[176:179], v[28:31], v[88:91], v[176:179]
    ds_bpermute_b32 v248, v14, v151
    v_mfma_f32_16x16x32_bf16 v[192:195], v[36:39], v[88:91], v[192:195]
    v_add_f32 v145, v145, v148
    v_add_f32 v146, v146, v149
    v_mfma_f32_16x16x32_bf16 v[208:211], v[44:47], v[88:91], v[208:211]
    v_add_f32 v147, v147, v150
    v_add_f32 v146, v146, v152
    v_mfma_f32_16x16x32_bf16 v[224:227], v[52:55], v[88:91], v[224:227]
    v_add_f32 v147, v147, v153
    v_add_f32 v147, v147, v156
    s_waitcnt lgkmcnt(9)
    v_mfma_f32_16x16x32_bf16 v[164:167], v[20:23], v[92:95], v[164:167]
    s_waitcnt lgkmcnt(0)
    v_cndmask_b32 v152, v248, v244, s[74:75]
    v_cndmask_b32 v153, v249, v245, s[74:75]
    v_mfma_f32_16x16x32_bf16 v[180:183], v[28:31], v[92:95], v[180:183]
    v_cndmask_b32 v154, v250, v246, s[74:75]
    v_add_f32 v144, v144, v152
    v_mfma_f32_16x16x32_bf16 v[196:199], v[36:39], v[92:95], v[196:199]
    v_add_f32 v145, v145, v153
    v_add_f32 v146, v146, v154
    v_mfma_f32_16x16x32_bf16 v[212:215], v[44:47], v[92:95], v[212:215]
    v_cvt_pk_bf16_f32 v148, v144, v145
    v_cvt_pk_bf16_f32 v149, v146, v147
    v_mfma_f32_16x16x32_bf16 v[228:231], v[52:55], v[92:95], v[228:231]
    buffer_store_dwordx2 v[148:149], v12, s[60:63], s70 offen offset:1024 sc1
    v_mfma_f32_16x16x32_bf16 v[168:171], v[20:23], v[96:99], v[168:171]
    ds_read2_b64 v[108:111], v11 offset0:56 offset1:57
    v_mfma_f32_16x16x32_bf16 v[184:187], v[28:31], v[96:99], v[184:187]
    ds_read2_b64 v[112:115], v2 offset0:56 offset1:57
    v_mfma_f32_16x16x32_bf16 v[200:203], v[36:39], v[96:99], v[200:203]
    ds_read2_b64 v[120:123], v3 offset0:56 offset1:57
    v_mfma_f32_16x16x32_bf16 v[216:219], v[44:47], v[96:99], v[216:219]
    ds_read2_b64 v[124:127], v13 offset0:56 offset1:57
    v_mfma_f32_16x16x32_bf16 v[232:235], v[52:55], v[96:99], v[232:235]
    ds_read2_b64 v[80:83], v11 offset0:48 offset1:49
    v_mfma_f32_16x16x32_bf16 v[172:175], v[20:23], v[128:131], v[172:175]
    ds_read2_b64 v[84:87], v2 offset0:48 offset1:49
    v_mfma_f32_16x16x32_bf16 v[188:191], v[28:31], v[128:131], v[188:191]
    ds_read2_b64 v[88:91], v3 offset0:48 offset1:49
    v_mfma_f32_16x16x32_bf16 v[204:207], v[36:39], v[128:131], v[204:207]
    ds_read2_b64 v[92:95], v13 offset0:48 offset1:49
    v_mfma_f32_16x16x32_bf16 v[220:223], v[44:47], v[128:131], v[220:223]
    ds_read2_b64 v[144:147], v11 offset0:40 offset1:41
    v_mfma_f32_16x16x32_bf16 v[236:239], v[52:55], v[128:131], v[236:239]
    ds_read2_b64 v[152:155], v2 offset0:40 offset1:41
    v_mfma_f32_16x16x32_bf16 v[160:163], v[16:19], v[136:139], v[160:163]
    ds_read2_b64 v[156:159], v3 offset0:40 offset1:41
    v_mfma_f32_16x16x32_bf16 v[176:179], v[24:27], v[136:139], v[176:179]
    ds_read2_b64 v[96:99], v13 offset0:40 offset1:41
    v_mfma_f32_16x16x32_bf16 v[192:195], v[32:35], v[136:139], v[192:195]
    ds_read2_b64 v[128:131], v11 offset0:32 offset1:33
    v_mfma_f32_16x16x32_bf16 v[208:211], v[40:43], v[136:139], v[208:211]
    v_mfma_f32_16x16x32_bf16 v[224:227], v[48:51], v[136:139], v[224:227]
    ds_read2_b64 v[136:139], v2 offset0:32 offset1:33
    v_mfma_f32_16x16x32_bf16 v[164:167], v[16:19], v[140:143], v[164:167]
    v_mfma_f32_16x16x32_bf16 v[180:183], v[24:27], v[140:143], v[180:183]
    v_mfma_f32_16x16x32_bf16 v[196:199], v[32:35], v[140:143], v[196:199]
    v_mfma_f32_16x16x32_bf16 v[212:215], v[40:43], v[140:143], v[212:215]
    v_mfma_f32_16x16x32_bf16 v[228:231], v[48:51], v[140:143], v[228:231]
    v_mfma_f32_16x16x32_bf16 v[168:171], v[16:19], v[100:103], v[168:171]
    v_mfma_f32_16x16x32_bf16 v[184:187], v[24:27], v[100:103], v[184:187]
    v_mfma_f32_16x16x32_bf16 v[200:203], v[32:35], v[100:103], v[200:203]
    v_mfma_f32_16x16x32_bf16 v[216:219], v[40:43], v[100:103], v[216:219]
    v_mfma_f32_16x16x32_bf16 v[232:235], v[48:51], v[100:103], v[232:235]
    v_mfma_f32_16x16x32_bf16 v[172:175], v[16:19], v[104:107], v[172:175]
    v_mfma_f32_16x16x32_bf16 v[188:191], v[24:27], v[104:107], v[188:191]
    v_mfma_f32_16x16x32_bf16 v[204:207], v[32:35], v[104:107], v[204:207]
    v_mfma_f32_16x16x32_bf16 v[220:223], v[40:43], v[104:107], v[220:223]
    v_add_f32 v167, v167, v170
    s_nop 3
    v_add_f32 v171, v171, v174
    v_mfma_f32_16x16x32_bf16 v[236:239], v[48:51], v[104:107], v[236:239]
    v_add_f32 v167, v167, v173
    s_waitcnt lgkmcnt(13)
    v_mfma_f32_16x16x32_bf16 v[176:179], v[20:23], v[108:111], v[176:179]
    ds_bpermute_b32 v242, v14, v175
    s_waitcnt lgkmcnt(13)
    v_mfma_f32_16x16x32_bf16 v[180:183], v[20:23], v[112:115], v[180:183]
    ds_bpermute_b32 v241, v14, v171
    s_waitcnt lgkmcnt(13)
    v_mfma_f32_16x16x32_bf16 v[184:187], v[20:23], v[120:123], v[184:187]
    ds_bpermute_b32 v240, v14, v167
    s_waitcnt lgkmcnt(13)
    v_mfma_f32_16x16x32_bf16 v[188:191], v[20:23], v[124:127], v[188:191]
    v_add_f32 v161, v161, v164
    v_add_f32 v162, v162, v165
    s_waitcnt lgkmcnt(12)
    v_mfma_f32_16x16x32_bf16 v[176:179], v[16:19], v[80:83], v[176:179]
    v_add_f32 v163, v163, v166
    v_add_f32 v162, v162, v168
    s_waitcnt lgkmcnt(11)
    v_mfma_f32_16x16x32_bf16 v[180:183], v[16:19], v[84:87], v[180:183]
    v_add_f32 v163, v163, v169
    v_add_f32 v163, v163, v172
    s_waitcnt lgkmcnt(10)
    v_mfma_f32_16x16x32_bf16 v[184:187], v[16:19], v[88:91], v[184:187]
    s_waitcnt lgkmcnt(0)
    v_cndmask_b32 v168, v240, v248, s[74:75]
    v_cndmask_b32 v169, v241, v249, s[74:75]
    v_mfma_f32_16x16x32_bf16 v[188:191], v[16:19], v[92:95], v[188:191]
    v_cndmask_b32 v170, v242, v250, s[74:75]
    v_add_f32 v160, v160, v168
    v_mfma_f32_16x16x32_bf16 v[192:195], v[28:31], v[108:111], v[192:195]
    v_add_f32 v161, v161, v169
    v_add_f32 v162, v162, v170
    v_mfma_f32_16x16x32_bf16 v[196:199], v[28:31], v[112:115], v[196:199]
    v_cvt_pk_bf16_f32 v164, v160, v161
    v_cvt_pk_bf16_f32 v165, v162, v163
    v_mfma_f32_16x16x32_bf16 v[200:203], v[28:31], v[120:123], v[200:203]
    buffer_store_dwordx2 v[164:165], v12, s[60:63], s70 offen offset:1536 sc1
    v_mfma_f32_16x16x32_bf16 v[204:207], v[28:31], v[124:127], v[204:207]
    v_add_f32 v183, v183, v186
    v_add_f32 v187, v187, v190
    v_mfma_f32_16x16x32_bf16 v[192:195], v[24:27], v[80:83], v[192:195]
    ds_read2_b64 v[140:143], v3 offset0:32 offset1:33
    v_mfma_f32_16x16x32_bf16 v[196:199], v[24:27], v[84:87], v[196:199]
    ds_read2_b64 v[100:103], v13 offset0:32 offset1:33
    v_mfma_f32_16x16x32_bf16 v[200:203], v[24:27], v[88:91], v[200:203]
    v_add_f32 v183, v183, v189
    v_mfma_f32_16x16x32_bf16 v[204:207], v[24:27], v[92:95], v[204:207]
    ds_bpermute_b32 v246, v14, v191
    v_mfma_f32_16x16x32_bf16 v[192:195], v[20:23], v[144:147], v[192:195]
    ds_bpermute_b32 v245, v14, v187
    v_mfma_f32_16x16x32_bf16 v[196:199], v[20:23], v[152:155], v[196:199]
    ds_bpermute_b32 v244, v14, v183
    v_mfma_f32_16x16x32_bf16 v[200:203], v[20:23], v[156:159], v[200:203]
    v_add_f32 v177, v177, v180
    v_add_f32 v178, v178, v181
    v_mfma_f32_16x16x32_bf16 v[204:207], v[20:23], v[96:99], v[204:207]
    v_add_f32 v179, v179, v182
    v_add_f32 v178, v178, v184
    v_mfma_f32_16x16x32_bf16 v[192:195], v[16:19], v[128:131], v[192:195]
    v_add_f32 v179, v179, v185
    v_add_f32 v179, v179, v188
    v_mfma_f32_16x16x32_bf16 v[196:199], v[16:19], v[136:139], v[196:199]
    s_waitcnt lgkmcnt(0)
    v_cndmask_b32 v184, v244, v240, s[74:75]
    v_cndmask_b32 v185, v245, v241, s[74:75]
    v_mfma_f32_16x16x32_bf16 v[200:203], v[16:19], v[140:143], v[200:203]
    v_cndmask_b32 v186, v246, v242, s[74:75]
    v_add_f32 v176, v176, v184
    v_mfma_f32_16x16x32_bf16 v[204:207], v[16:19], v[100:103], v[204:207]
    v_add_f32 v177, v177, v185
    v_add_f32 v178, v178, v186
    v_mfma_f32_16x16x32_bf16 v[208:211], v[36:39], v[108:111], v[208:211]
    v_cvt_pk_bf16_f32 v180, v176, v177
    v_cvt_pk_bf16_f32 v181, v178, v179
    v_mfma_f32_16x16x32_bf16 v[212:215], v[36:39], v[112:115], v[212:215]
    buffer_store_dwordx2 v[180:181], v12, s[60:63], s70 offen offset:2048 sc1
    v_mfma_f32_16x16x32_bf16 v[216:219], v[36:39], v[120:123], v[216:219]
    v_add_f32 v199, v199, v202
    v_add_f32 v203, v203, v206
    v_mfma_f32_16x16x32_bf16 v[220:223], v[36:39], v[124:127], v[220:223]
    v_add_f32 v199, v199, v205
    v_mfma_f32_16x16x32_bf16 v[208:211], v[32:35], v[80:83], v[208:211]
    ds_bpermute_b32 v250, v14, v207
    v_mfma_f32_16x16x32_bf16 v[212:215], v[32:35], v[84:87], v[212:215]
    ds_bpermute_b32 v249, v14, v203
    v_mfma_f32_16x16x32_bf16 v[216:219], v[32:35], v[88:91], v[216:219]
    ds_bpermute_b32 v248, v14, v199
    v_mfma_f32_16x16x32_bf16 v[220:223], v[32:35], v[92:95], v[220:223]
    v_add_f32 v193, v193, v196
    v_add_f32 v194, v194, v197
    v_mfma_f32_16x16x32_bf16 v[208:211], v[28:31], v[144:147], v[208:211]
    v_add_f32 v195, v195, v198
    v_add_f32 v194, v194, v200
    v_mfma_f32_16x16x32_bf16 v[212:215], v[28:31], v[152:155], v[212:215]
    v_add_f32 v195, v195, v201
    v_add_f32 v195, v195, v204
    v_mfma_f32_16x16x32_bf16 v[216:219], v[28:31], v[156:159], v[216:219]
    s_waitcnt lgkmcnt(0)
    v_cndmask_b32 v200, v248, v244, s[74:75]
    v_cndmask_b32 v201, v249, v245, s[74:75]
    v_mfma_f32_16x16x32_bf16 v[220:223], v[28:31], v[96:99], v[220:223]
    v_cndmask_b32 v202, v250, v246, s[74:75]
    v_add_f32 v192, v192, v200
    v_mfma_f32_16x16x32_bf16 v[208:211], v[24:27], v[128:131], v[208:211]
    v_add_f32 v193, v193, v201
    v_add_f32 v194, v194, v202
    v_mfma_f32_16x16x32_bf16 v[212:215], v[24:27], v[136:139], v[212:215]
    v_cvt_pk_bf16_f32 v196, v192, v193
    v_cvt_pk_bf16_f32 v197, v194, v195
    v_mfma_f32_16x16x32_bf16 v[216:219], v[24:27], v[140:143], v[216:219]
    buffer_store_dwordx2 v[196:197], v12, s[60:63], s70 offen offset:2560 sc1
    v_mfma_f32_16x16x32_bf16 v[220:223], v[24:27], v[100:103], v[220:223]
    v_mfma_f32_16x16x32_bf16 v[224:227], v[44:47], v[108:111], v[224:227]
    v_mfma_f32_16x16x32_bf16 v[228:231], v[44:47], v[112:115], v[228:231]
    v_mfma_f32_16x16x32_bf16 v[232:235], v[44:47], v[120:123], v[232:235]
    s_nop 2
    v_add_f32 v215, v215, v218
    s_nop 0
    v_add_f32 v219, v219, v222
    v_mfma_f32_16x16x32_bf16 v[236:239], v[44:47], v[124:127], v[236:239]
    v_add_f32 v215, v215, v221
    v_mfma_f32_16x16x32_bf16 v[224:227], v[40:43], v[80:83], v[224:227]
    ds_bpermute_b32 v242, v14, v223
    v_mfma_f32_16x16x32_bf16 v[228:231], v[40:43], v[84:87], v[228:231]
    ds_bpermute_b32 v241, v14, v219
    v_mfma_f32_16x16x32_bf16 v[232:235], v[40:43], v[88:91], v[232:235]
    ds_bpermute_b32 v240, v14, v215
    v_mfma_f32_16x16x32_bf16 v[236:239], v[40:43], v[92:95], v[236:239]
    v_add_f32 v209, v209, v212
    v_add_f32 v210, v210, v213
    v_mfma_f32_16x16x32_bf16 v[224:227], v[36:39], v[144:147], v[224:227]
    v_add_f32 v211, v211, v214
    v_add_f32 v210, v210, v216
    v_mfma_f32_16x16x32_bf16 v[228:231], v[36:39], v[152:155], v[228:231]
    v_add_f32 v211, v211, v217
    v_add_f32 v211, v211, v220
    v_mfma_f32_16x16x32_bf16 v[232:235], v[36:39], v[156:159], v[232:235]
    s_waitcnt lgkmcnt(0)
    v_cndmask_b32 v216, v240, v248, s[74:75]
    v_cndmask_b32 v217, v241, v249, s[74:75]
    v_mfma_f32_16x16x32_bf16 v[236:239], v[36:39], v[96:99], v[236:239]
    v_cndmask_b32 v218, v242, v250, s[74:75]
    v_add_f32 v208, v208, v216
    v_mfma_f32_16x16x32_bf16 v[224:227], v[32:35], v[128:131], v[224:227]
    v_add_f32 v209, v209, v217
    v_add_f32 v210, v210, v218
    v_mfma_f32_16x16x32_bf16 v[228:231], v[32:35], v[136:139], v[228:231]
    v_cvt_pk_bf16_f32 v212, v208, v209
    v_cvt_pk_bf16_f32 v213, v210, v211
    v_mfma_f32_16x16x32_bf16 v[232:235], v[32:35], v[140:143], v[232:235]
    buffer_store_dwordx2 v[212:213], v12, s[60:63], s70 offen offset:3072 sc1
    v_mfma_f32_16x16x32_bf16 v[236:239], v[32:35], v[100:103], v[236:239]
    s_nop 5
    v_add_f32 v231, v231, v234
    s_nop 0
    v_add_f32 v235, v235, v238
    v_add_f32 v231, v231, v237
    ds_bpermute_b32 v246, v14, v239
    ds_bpermute_b32 v245, v14, v235
    ds_bpermute_b32 v244, v14, v231
    v_add_f32 v225, v225, v228
    v_add_f32 v226, v226, v229
    v_add_f32 v227, v227, v230
    v_add_f32 v226, v226, v232
    v_add_f32 v227, v227, v233
    v_add_f32 v227, v227, v236
    s_waitcnt lgkmcnt(0)
    v_cndmask_b32 v232, v244, v240, s[74:75]
    v_cndmask_b32 v233, v245, v241, s[74:75]
    v_cndmask_b32 v234, v246, v242, s[74:75]
    v_add_f32 v224, v224, v232
    v_add_f32 v225, v225, v233
    v_add_f32 v226, v226, v234
    v_cvt_pk_bf16_f32 v228, v224, v225
    v_cvt_pk_bf16_f32 v229, v226, v227
    buffer_store_dwordx2 v[228:229], v12, s[60:63], s70 offen offset:3584 sc1
    ds_read_b128 v[236:239], v252 offset:0
    ds_read_b128 v[240:243], v252 offset:1024
    ds_read_b128 v[244:247], v252 offset:2048
    ds_read_b128 v[248:251], v252 offset:3072
    v_mov_b32 v3, 162912
    v_mov_b32 v4, 1
    s_waitcnt lgkmcnt(0)
    s_mov_b64 exec, 1
    ds_add_u32 v3, v4 offset:12
    s_mov_b64 exec, -1
    v_mov_b32 v7, 162912
    s_mov_b32 s81, 2000000
Lspin_41:
    ds_read_b32 v6, v7 offset:4
    s_waitcnt lgkmcnt(0)
    v_cmp_eq_u32 vcc, 0, v6
    s_cbranch_vccz Lspun_42
    s_sleep 1
    s_sub_u32 s81, s81, 1
    s_cbranch_scc0 Lspin_41
Lspun_42:
    s_lshl_b32 s72, s6, 1
    s_lshr_b32 s73, s3, 2
    s_xor_b32 s73, s73, s7
    s_and_b32 s73, s73, 1
    s_add_u32 s72, s72, s73
    s_mul_i32 s72, s72, 40
    s_and_b32 s73, s3, 3
    s_mul_i32 s73, s73, 10
    s_add_u32 s72, s72, s73
    s_lshl_b32 s72, s72, 10
    s_add_u32 s72, s72, 4194304
    v_lshlrev_b32 v6, 4, v1
    buffer_load_dwordx4 v[116:119], v6, s[60:63], s72 offen offset:0 sc1
    buffer_load_dwordx4 v[120:123], v6, s[60:63], s72 offen offset:1024 sc1
    buffer_load_dwordx4 v[124:127], v6, s[60:63], s72 offen offset:2048 sc1
    buffer_load_dwordx4 v[128:131], v6, s[60:63], s72 offen offset:3072 sc1
    s_add_u32 s72, s72, 4096
    buffer_load_dwordx4 v[132:135], v6, s[60:63], s72 offen offset:0 sc1
    buffer_load_dwordx4 v[136:139], v6, s[60:63], s72 offen offset:1024 sc1
    buffer_load_dwordx4 v[140:143], v6, s[60:63], s72 offen offset:2048 sc1
    buffer_load_dwordx4 v[144:147], v6, s[60:63], s72 offen offset:3072 sc1
    s_add_u32 s72, s72, 4096
    buffer_load_dwordx4 v[148:151], v6, s[60:63], s72 offen offset:0 sc1
    buffer_load_dwordx4 v[152:155], v6, s[60:63], s72 offen offset:1024 sc1
    s_branch L_join1
L_aux5:
    s_and_b32 s10, s9, 1
    s_lshl_b32 s10, s10, 2
    s_add_u32 s10, s10, s3
    s_sub_u32 s10, s10, 4
    v_and_b32 v2, 15, v1
    v_lshrrev_b32 v3, 4, v1
    v_mul_u32_u24 v3, 7168, v3
    v_lshl_add_u32 v3, v2, 4, v3
    s_lshl_b32 s11, s10, 4
    v_add_u32 v4, s11, v2
    v_cmp_gt_u32 vcc, 105, v4
    v_mov_b32 v4, 2147483392
    s_nop 0
    v_cndmask_b32 v3, v4, v3, vcc
    s_lshr_b32 s11, s9, 1
    s_mul_i32 s73, s11, 28672
    s_lshl_b32 s12, s10, 8
    s_add_u32 s73, s73, s12
    s_add_u32 s73, s73, 2752512
    s_add_u32 s74, s73, 5376
    s_lshl_b32 s11, s11, 10
    s_lshl_b32 s12, s10, 7
    s_add_u32 s11, s11, s12
    s_add_u32 s11, s11, 3670016
    v_lshrrev_b32 v6, 4, v1
    v_mul_u32_u24 v6, 32896, v6
    v_lshl_add_u32 v6, v2, 3, v6
    s_add_u32 s10, s11, 131584
    s_waitcnt vmcnt(0)
    s_lshl_b32 s12, s3, 2
    s_add_u32 s12, s12, 162928
    v_mov_b32 v7, s12
    v_mov_b32 v8, 1
    ds_write_b32 v7, v8
    ds_read_b64_tr_b16 v[16:17], v236 offset:0
    ds_read_b64_tr_b16 v[18:19], v236 offset:2560
    ds_read_b64_tr_b16 v[20:21], v236 offset:32
    ds_read_b64_tr_b16 v[22:23], v236 offset:2592
    ds_read_b64_tr_b16 v[24:25], v236 offset:64
    ds_read_b64_tr_b16 v[26:27], v236 offset:2624
    ds_read_b64_tr_b16 v[28:29], v236 offset:96
    ds_read_b64_tr_b16 v[30:31], v236 offset:2656
    ds_read_b64_tr_b16 v[32:33], v236 offset:128
    ds_read_b64_tr_b16 v[34:35], v236 offset:2688
    ds_read_b64_tr_b16 v[36:37], v237 offset:0
    ds_read_b64_tr_b16 v[38:39], v237 offset:2560
    ds_read_b64_tr_b16 v[40:41], v237 offset:32
    ds_read_b64_tr_b16 v[42:43], v237 offset:2592
    ds_read_b64_tr_b16 v[44:45], v237 offset:64
    ds_read_b64_tr_b16 v[46:47], v237 offset:2624
    ds_read_b64_tr_b16 v[48:49], v237 offset:96
    ds_read_b64_tr_b16 v[50:51], v237 offset:2656
    ds_read_b64_tr_b16 v[52:53], v237 offset:128
    ds_read_b64_tr_b16 v[54:55], v237 offset:2688
    ds_read_b64_tr_b16 v[56:57], v238 offset:0
    ds_read_b64_tr_b16 v[58:59], v238 offset:2560
    ds_read_b64_tr_b16 v[60:61], v238 offset:32
    ds_read_b64_tr_b16 v[62:63], v238 offset:2592
    ds_read_b64_tr_b16 v[64:65], v238 offset:64
    ds_read_b64_tr_b16 v[66:67], v238 offset:2624
    ds_read_b64_tr_b16 v[68:69], v238 offset:96
    ds_read_b64_tr_b16 v[70:71], v238 offset:2656
    ds_read_b64_tr_b16 v[72:73], v238 offset:128
    ds_read_b64_tr_b16 v[74:75], v238 offset:2688
    ds_read_b64_tr_b16 v[76:77], v239 offset:0
    ds_read_b64_tr_b16 v[78:79], v239 offset:2560
    ds_read_b64_tr_b16 v[80:81], v239 offset:32
    ds_read_b64_tr_b16 v[82:83], v239 offset:2592
    ds_read_b64_tr_b16 v[84:85], v239 offset:64
    ds_read_b64_tr_b16 v[86:87], v239 offset:2624
    ds_read_b64_tr_b16 v[88:89], v239 offset:96
    ds_read_b64_tr_b16 v[90:91], v239 offset:2656
    ds_read_b64_tr_b16 v[92:93], v239 offset:128
    ds_read_b64_tr_b16 v[94:95], v239 offset:2688
    ds_read_b64_tr_b16 v[96:97], v240 offset:0
    ds_read_b64_tr_b16 v[98:99], v240 offset:2560
    ds_read_b64_tr_b16 v[100:101], v240 offset:32
    ds_read_b64_tr_b16 v[102:103], v240 offset:2592
    ds_read_b64_tr_b16 v[104:105], v240 offset:64
    ds_read_b64_tr_b16 v[106:107], v240 offset:2624
    ds_read_b64_tr_b16 v[108:109], v240 offset:96
    ds_read_b64_tr_b16 v[110:111], v240 offset:2656
    ds_read_b64_tr_b16 v[112:113], v240 offset:128
    ds_read_b64_tr_b16 v[114:115], v240 offset:2688
    s_setprio 3
    s_mov_b32 s81, 100000
Lspin_43:
    buffer_load_dwordx4 v[156:159], v3, s[60:63], s73 offen offset:0 sc1
    buffer_load_dwordx4 v[160:163], v3, s[60:63], s73 offen offset:1792 sc1
    buffer_load_dwordx4 v[164:167], v3, s[60:63], s73 offen offset:3584 sc1
    buffer_load_dwordx4 v[168:171], v3, s[60:63], s74 offen offset:0 sc1
    s_waitcnt vmcnt(0)
    v_max3_u32 v4, v156, v157, v158
    v_max3_u32 v4, v4, v159, v160
    v_max3_u32 v4, v4, v161, v162
    v_max3_u32 v4, v4, v163, v164
    v_max3_u32 v4, v4, v165, v166
    v_max3_u32 v4, v4, v167, v168
    v_max3_u32 v4, v4, v169, v170
    v_max_u32 v4, v4, v171
    v_cmp_eq_u32 vcc, -1, v4
    s_cbranch_vccz Lspun_44
    s_sleep 2
    s_sub_u32 s81, s81, 1
    s_cbranch_scc0 Lspin_43
Lspun_44:
    v_add_f32 v156, v156, v164
    v_add_f32 v157, v157, v165
    v_add_f32 v158, v158, v166
    v_add_f32 v159, v159, v167
    v_add_f32 v160, v160, v168
    v_add_f32 v161, v161, v169
    v_add_f32 v162, v162, v170
    v_add_f32 v163, v163, v171
    v_add_f32 v156, v156, v160
    v_add_f32 v157, v157, v161
    v_add_f32 v158, v158, v162
    v_add_f32 v159, v159, v163
    v_mov_b32 v160, v156
    v_mov_b32 v161, v157
    v_mov_b32 v162, v158
    v_mov_b32 v163, v159
    v_permlane16_swap_b32 v156, v160
    v_permlane16_swap_b32 v157, v161
    v_permlane16_swap_b32 v158, v162
    v_permlane16_swap_b32 v159, v163
    v_add_f32 v156, v156, v160
    v_add_f32 v157, v157, v161
    v_add_f32 v158, v158, v162
    v_add_f32 v159, v159, v163
    v_mov_b32 v160, v156
    v_mov_b32 v161, v157
    v_mov_b32 v162, v158
    v_mov_b32 v163, v159
    v_permlane32_swap_b32 v156, v160
    v_permlane32_swap_b32 v157, v161
    v_permlane32_swap_b32 v158, v162
    v_permlane32_swap_b32 v159, v163
    v_add_f32 v156, v156, v160
    v_add_f32 v157, v157, v161
    v_add_f32 v158, v158, v162
    v_add_f32 v159, v159, v163
    v_cvt_pk_bf16_f32 v4, v156, v157
    v_cvt_pk_bf16_f32 v5, v158, v159
    v_min_u32 v4, -2, v4
    v_min_u32 v5, -2, v5
    buffer_store_dwordx2 v[4:5], v6, s[60:63], s11 offen sc1
    buffer_store_dwordx2 v[4:5], v6, s[60:63], s10 offen sc1
    s_mov_b64 exec, -1
    s_setprio 0
L_help:
    s_lshl_b32 s72, s6, 11
    s_add_u32 s72, s72, 3997696
    v_and_b32 v2, 7, v1
    v_lshlrev_b32 v2, 7, v2
    s_mov_b32 s81, 100000
Lspin_45:
    buffer_load_dword v3, v2, s[60:63], s72 offen sc1
    s_waitcnt vmcnt(0)
    v_cmp_ne_u32 vcc, s0, v3
    s_cbranch_vccz Lspun_46
    s_sleep 2
    s_sub_u32 s81, s81, 1
    s_cbranch_scc0 Lspin_45
Lspun_46:
    v_mov_b32 v5, 162912
    v_mov_b32 v4, 1
    ds_write_b32 v5, v4 offset:4
    s_lshl_b32 s72, s6, 1
    s_lshr_b32 s73, s3, 2
    s_xor_b32 s73, s73, s7
    s_and_b32 s73, s73, 1
    s_add_u32 s72, s72, s73
    s_mul_i32 s72, s72, 40
    s_and_b32 s73, s3, 3
    s_mul_i32 s73, s73, 10
    s_add_u32 s72, s72, s73
    s_lshl_b32 s72, s72, 10
    s_add_u32 s72, s72, 4194304
    v_lshlrev_b32 v2, 4, v1
    buffer_load_dwordx4 v[116:119], v2, s[60:63], s72 offen offset:0 sc1
    buffer_load_dwordx4 v[120:123], v2, s[60:63], s72 offen offset:1024 sc1
    buffer_load_dwordx4 v[124:127], v2, s[60:63], s72 offen offset:2048 sc1
    buffer_load_dwordx4 v[128:131], v2, s[60:63], s72 offen offset:3072 sc1
    s_add_u32 s72, s72, 4096
    buffer_load_dwordx4 v[132:135], v2, s[60:63], s72 offen offset:0 sc1
    buffer_load_dwordx4 v[136:139], v2, s[60:63], s72 offen offset:1024 sc1
    buffer_load_dwordx4 v[140:143], v2, s[60:63], s72 offen offset:2048 sc1
    buffer_load_dwordx4 v[144:147], v2, s[60:63], s72 offen offset:3072 sc1
    s_add_u32 s72, s72, 4096
    buffer_load_dwordx4 v[148:151], v2, s[60:63], s72 offen offset:0 sc1
    buffer_load_dwordx4 v[152:155], v2, s[60:63], s72 offen offset:1024 sc1
    s_and_b32 s72, s3, 3
    s_lshl_b32 s72, s72, 10
    s_mul_i32 s73, s4, 32896
    s_add_u32 s72, s72, s73
    v_add_u32 v11, s72, v251
    v_add_u32 v10, 4096, v11
    s_mov_b32 s72, 3670016
    s_mov_b32 s73, 3678208
    s_mov_b32 s74, 3686400
    s_mov_b32 s75, 3694592
    buffer_load_dwordx4 v[156:159], v11, s[60:63], s72 offen sc1
    buffer_load_dwordx4 v[160:163], v10, s[60:63], s72 offen sc1
    buffer_load_dwordx4 v[164:167], v11, s[60:63], s73 offen sc1
    buffer_load_dwordx4 v[168:171], v10, s[60:63], s73 offen sc1
    buffer_load_dwordx4 v[172:175], v11, s[60:63], s74 offen sc1
    buffer_load_dwordx4 v[176:179], v10, s[60:63], s74 offen sc1
    buffer_load_dwordx4 v[180:183], v11, s[60:63], s75 offen sc1
    buffer_load_dwordx4 v[184:187], v10, s[60:63], s75 offen sc1
    s_waitcnt vmcnt(8)
    v_mov_b64 v[196:197], v[118:119]
    v_mov_b64 v[198:199], v[122:123]
    v_mov_b64 v[200:201], v[126:127]
    v_mov_b64 v[202:203], v[130:131]
    v_mov_b64 v[204:205], v[134:135]
    v_mov_b64 v[206:207], v[138:139]
    v_mov_b64 v[208:209], v[142:143]
    v_mov_b64 v[210:211], v[146:147]
    v_mov_b64 v[212:213], v[150:151]
    v_mov_b64 v[118:119], v[120:121]
    v_mov_b64 v[120:121], v[124:125]
    v_mov_b64 v[122:123], v[128:129]
    v_mov_b64 v[124:125], v[132:133]
    v_mov_b64 v[126:127], v[136:137]
    v_mov_b64 v[128:129], v[140:141]
    v_mov_b64 v[130:131], v[144:145]
    v_mov_b64 v[132:133], v[148:149]
    v_mov_b64 v[134:135], v[152:153]
    v_mov_b64 v[136:137], v[196:197]
    v_mov_b64 v[138:139], v[198:199]
    v_mov_b64 v[140:141], v[200:201]
    v_mov_b64 v[142:143], v[202:203]
    v_mov_b64 v[144:145], v[204:205]
    v_mov_b64 v[146:147], v[206:207]
    v_mov_b64 v[148:149], v[208:209]
    v_mov_b64 v[150:151], v[210:211]
    v_mov_b64 v[152:153], v[212:213]
    v_mov_b32 v3, 162912
    s_mov_b32 s81, 2000000
Lspin_47:
    ds_read_b32 v2, v3 offset:12
    s_waitcnt lgkmcnt(0)
    v_cmp_ne_u32 vcc, 4, v2
    s_cbranch_vccz Lspun_48
    s_sleep 1
    s_sub_u32 s81, s81, 1
    s_cbranch_scc0 Lspin_47
Lspun_48:
    v_mov_b32 v4, 0
    v_mov_b32 v5, 0
    v_mov_b32 v6, 0
    v_mov_b32 v7, 0
    s_and_b32 s1, s3, 3
    s_mul_i32 s1, s1, 1344
    s_add_u32 s1, s1, 102400
    v_add_u32 v2, s1, v251
    ds_write_b128 v2, v[4:7] offset:0
    ds_write_b128 v2, v[4:7] offset:5376
    ds_write_b128 v2, v[4:7] offset:10752
    ds_write_b128 v2, v[4:7] offset:16128
    ds_write_b128 v2, v[4:7] offset:21504
    ds_write_b128 v2, v[4:7] offset:26880
    ds_write_b128 v2, v[4:7] offset:32256
    ds_write_b128 v2, v[4:7] offset:37632
    s_mov_b64 exec, 0xfffff
    ds_write_b128 v2, v[4:7] offset:1024
    ds_write_b128 v2, v[4:7] offset:6400
    ds_write_b128 v2, v[4:7] offset:11776
    ds_write_b128 v2, v[4:7] offset:17152
    ds_write_b128 v2, v[4:7] offset:22528
    ds_write_b128 v2, v[4:7] offset:27904
    ds_write_b128 v2, v[4:7] offset:33280
    ds_write_b128 v2, v[4:7] offset:38656
    s_mov_b64 exec, -1
    s_waitcnt vmcnt(0)
    v_max3_u32 v8, v156, v157, v158
    v_max3_u32 v8, v8, v159, v160
    v_max3_u32 v8, v8, v161, v162
    v_max3_u32 v8, v8, v163, v164
    v_max3_u32 v8, v8, v165, v166
    v_max3_u32 v8, v8, v167, v168
    v_max3_u32 v8, v8, v169, v170
    v_max3_u32 v8, v8, v171, v172
    v_max3_u32 v8, v8, v173, v174
    v_max3_u32 v8, v8, v175, v176
    v_max3_u32 v8, v8, v177, v178
    v_max3_u32 v8, v8, v179, v180
    v_max3_u32 v8, v8, v181, v182
    v_max3_u32 v8, v8, v183, v184
    v_max3_u32 v8, v8, v185, v186
    v_max_u32 v8, v8, v187
    v_cmp_eq_u32 vcc, -1, v8
    s_cbranch_vccz Ltok_49
    s_mov_b32 s81, 100000
Lspin_50:
    buffer_load_dwordx4 v[156:159], v11, s[60:63], s72 offen sc1
    buffer_load_dwordx4 v[160:163], v10, s[60:63], s72 offen sc1
    buffer_load_dwordx4 v[164:167], v11, s[60:63], s73 offen sc1
    buffer_load_dwordx4 v[168:171], v10, s[60:63], s73 offen sc1
    buffer_load_dwordx4 v[172:175], v11, s[60:63], s74 offen sc1
    buffer_load_dwordx4 v[176:179], v10, s[60:63], s74 offen sc1
    buffer_load_dwordx4 v[180:183], v11, s[60:63], s75 offen sc1
    buffer_load_dwordx4 v[184:187], v10, s[60:63], s75 offen sc1
    s_waitcnt vmcnt(0)
    v_max3_u32 v8, v156, v157, v158
    v_max3_u32 v8, v8, v159, v160
    v_max3_u32 v8, v8, v161, v162
    v_max3_u32 v8, v8, v163, v164
    v_max3_u32 v8, v8, v165, v166
    v_max3_u32 v8, v8, v167, v168
    v_max3_u32 v8, v8, v169, v170
    v_max3_u32 v8, v8, v171, v172
    v_max3_u32 v8, v8, v173, v174
    v_max3_u32 v8, v8, v175, v176
    v_max3_u32 v8, v8, v177, v178
    v_max3_u32 v8, v8, v179, v180
    v_max3_u32 v8, v8, v181, v182
    v_max3_u32 v8, v8, v183, v184
    v_max3_u32 v8, v8, v185, v186
    v_max_u32 v8, v8, v187
    v_cmp_eq_u32 vcc, -1, v8
    s_cbranch_vccz Lspun_51
    s_sleep 1
    s_sub_u32 s81, s81, 1
    s_cbranch_scc0 Lspin_50
Lspun_51:
Ltok_49:
    s_branch L_scat
L_join:
    v_mov_b32 v7, 162912
    s_mov_b32 s81, 2000000
Lspin_52:
    ds_read_b32 v6, v7 offset:4
    s_waitcnt lgkmcnt(0)
    v_cmp_eq_u32 vcc, 0, v6
    s_cbranch_vccz Lspun_53
    s_sleep 1
    s_sub_u32 s81, s81, 1
    s_cbranch_scc0 Lspin_52
Lspun_53:
    s_lshl_b32 s72, s6, 1
    s_lshr_b32 s73, s3, 2
    s_xor_b32 s73, s73, s7
    s_and_b32 s73, s73, 1
    s_add_u32 s72, s72, s73
    s_mul_i32 s72, s72, 40
    s_and_b32 s73, s3, 3
    s_mul_i32 s73, s73, 10
    s_add_u32 s72, s72, s73
    s_lshl_b32 s72, s72, 10
    s_add_u32 s72, s72, 4194304
    v_lshlrev_b32 v6, 4, v1
    buffer_load_dwordx4 v[116:119], v6, s[60:63], s72 offen offset:0 sc1
    buffer_load_dwordx4 v[120:123], v6, s[60:63], s72 offen offset:1024 sc1
    buffer_load_dwordx4 v[124:127], v6, s[60:63], s72 offen offset:2048 sc1
    buffer_load_dwordx4 v[128:131], v6, s[60:63], s72 offen offset:3072 sc1
    s_add_u32 s72, s72, 4096
    buffer_load_dwordx4 v[132:135], v6, s[60:63], s72 offen offset:0 sc1
    buffer_load_dwordx4 v[136:139], v6, s[60:63], s72 offen offset:1024 sc1
    buffer_load_dwordx4 v[140:143], v6, s[60:63], s72 offen offset:2048 sc1
    buffer_load_dwordx4 v[144:147], v6, s[60:63], s72 offen offset:3072 sc1
    s_add_u32 s72, s72, 4096
    buffer_load_dwordx4 v[148:151], v6, s[60:63], s72 offen offset:0 sc1
    buffer_load_dwordx4 v[152:155], v6, s[60:63], s72 offen offset:1024 sc1
L_join1:
    s_lshl_b32 s72, s3, 2
    s_add_u32 s72, s72, 162944
    v_mov_b32 v3, s72
    s_mov_b32 s81, 2000000
Lspin_54:
    ds_read_b32 v2, v3
    s_waitcnt lgkmcnt(0)
    v_cmp_eq_u32 vcc, 0, v2
    s_cbranch_vccz Lspun_55
    s_sleep 1
    s_sub_u32 s81, s81, 1
    s_cbranch_scc0 Lspin_54
Lspun_55:
    ds_read_b64_tr_b16 v[16:17], v236 offset:0
    ds_read_b64_tr_b16 v[18:19], v236 offset:2560
    ds_read_b64_tr_b16 v[20:21], v236 offset:32
    ds_read_b64_tr_b16 v[22:23], v236 offset:2592
    ds_read_b64_tr_b16 v[24:25], v236 offset:64
    ds_read_b64_tr_b16 v[26:27], v236 offset:2624
    ds_read_b64_tr_b16 v[28:29], v236 offset:96
    ds_read_b64_tr_b16 v[30:31], v236 offset:2656
    ds_read_b64_tr_b16 v[32:33], v236 offset:128
    ds_read_b64_tr_b16 v[34:35], v236 offset:2688
    ds_read_b64_tr_b16 v[36:37], v237 offset:0
    ds_read_b64_tr_b16 v[38:39], v237 offset:2560
    ds_read_b64_tr_b16 v[40:41], v237 offset:32
    ds_read_b64_tr_b16 v[42:43], v237 offset:2592
    ds_read_b64_tr_b16 v[44:45], v237 offset:64
    ds_read_b64_tr_b16 v[46:47], v237 offset:2624
    ds_read_b64_tr_b16 v[48:49], v237 offset:96
    ds_read_b64_tr_b16 v[50:51], v237 offset:2656
    ds_read_b64_tr_b16 v[52:53], v237 offset:128
    ds_read_b64_tr_b16 v[54:55], v237 offset:2688
    ds_read_b64_tr_b16 v[56:57], v238 offset:0
    ds_read_b64_tr_b16 v[58:59], v238 offset:2560
    ds_read_b64_tr_b16 v[60:61], v238 offset:32
    ds_read_b64_tr_b16 v[62:63], v238 offset:2592
    ds_read_b64_tr_b16 v[64:65], v238 offset:64
    ds_read_b64_tr_b16 v[66:67], v238 offset:2624
    ds_read_b64_tr_b16 v[68:69], v238 offset:96
    ds_read_b64_tr_b16 v[70:71], v238 offset:2656
    ds_read_b64_tr_b16 v[72:73], v238 offset:128
    ds_read_b64_tr_b16 v[74:75], v238 offset:2688
    ds_read_b64_tr_b16 v[76:77], v239 offset:0
    ds_read_b64_tr_b16 v[78:79], v239 offset:2560
    ds_read_b64_tr_b16 v[80:81], v239 offset:32
    ds_read_b64_tr_b16 v[82:83], v239 offset:2592
    ds_read_b64_tr_b16 v[84:85], v239 offset:64
    ds_read_b64_tr_b16 v[86:87], v239 offset:2624
    ds_read_b64_tr_b16 v[88:89], v239 offset:96
    ds_read_b64_tr_b16 v[90:91], v239 offset:2656
    ds_read_b64_tr_b16 v[92:93], v239 offset:128
    ds_read_b64_tr_b16 v[94:95], v239 offset:2688
    ds_read_b64_tr_b16 v[96:97], v240 offset:0
    ds_read_b64_tr_b16 v[98:99], v240 offset:2560
    ds_read_b64_tr_b16 v[100:101], v240 offset:32
    ds_read_b64_tr_b16 v[102:103], v240 offset:2592
    ds_read_b64_tr_b16 v[104:105], v240 offset:64
    ds_read_b64_tr_b16 v[106:107], v240 offset:2624
    ds_read_b64_tr_b16 v[108:109], v240 offset:96
    ds_read_b64_tr_b16 v[110:111], v240 offset:2656
    ds_read_b64_tr_b16 v[112:113], v240 offset:128
    ds_read_b64_tr_b16 v[114:115], v240 offset:2688
    v_mov_b32 v3, 162912
    v_mov_b32 v4, 1
    s_waitcnt vmcnt(0)
    s_mov_b64 exec, 1
    ds_add_rtn_u32 v5, v3, v4 offset:8
    s_lshl_b32 s72, s14, 7
    s_add_u32 s72, s72, 4063232
    s_waitcnt lgkmcnt(0)
    v_readfirstlane_b32 s73, v5
    s_mov_b64 exec, -1
    v_lshlrev_b32 v2, 7, v1
    v_mov_b32 v3, s0
    s_cmp_eq_u32 s73, 3
    s_cselect_b32 s72, s72, 2147483392
    s_mov_b32 exec_hi, 0
    s_mov_b32 exec_lo, s13
    buffer_store_dword v3, v2, s[60:63], s72 offen sc1
    s_mov_b64 exec, -1
    v_mov_b64 v[196:197], v[118:119]
    v_mov_b64 v[198:199], v[122:123]
    v_mov_b64 v[200:201], v[126:127]
    v_mov_b64 v[202:203], v[130:131]
    v_mov_b64 v[204:205], v[134:135]
    v_mov_b64 v[206:207], v[138:139]
    v_mov_b64 v[208:209], v[142:143]
    v_mov_b64 v[210:211], v[146:147]
    v_mov_b64 v[212:213], v[150:151]
    v_mov_b64 v[118:119], v[120:121]
    v_mov_b64 v[120:121], v[124:125]
    v_mov_b64 v[122:123], v[128:129]
    v_mov_b64 v[124:125], v[132:133]
    v_mov_b64 v[126:127], v[136:137]
    v_mov_b64 v[128:129], v[140:141]
    v_mov_b64 v[130:131], v[144:145]
    v_mov_b64 v[132:133], v[148:149]
    v_mov_b64 v[134:135], v[152:153]
    v_mov_b64 v[136:137], v[196:197]
    v_mov_b64 v[138:139], v[198:199]
    v_mov_b64 v[140:141], v[200:201]
    v_mov_b64 v[142:143], v[202:203]
    v_mov_b64 v[144:145], v[204:205]
    v_mov_b64 v[146:147], v[206:207]
    v_mov_b64 v[148:149], v[208:209]
    v_mov_b64 v[150:151], v[210:211]
    v_mov_b64 v[152:153], v[212:213]
L_join2:
    s_mov_b32 s52, s36
    s_and_b32 s53, s37, 0xffff
    s_mov_b32 s54, 2621440
    s_mov_b32 s55, 0x00020000
    s_and_b32 s8, s3, 3
    s_lshr_b32 s9, s3, 2
    s_mul_i32 s72, s7, 5120
    s_lshl_b32 s73, s3, 9
    s_add_u32 s72, s72, s73
    s_add_u32 s72, s72, 4063232
    s_cmp_lt_u32 s3, 2
    s_cselect_b32 s74, 4096, 0
    s_lshl_b32 s73, s6, 11
    s_and_b32 s75, s8, 1
    s_lshl_b32 s75, s75, 9
    s_add_u32 s73, s73, s75
    s_lshr_b32 s75, s8, 1
    s_lshl_b32 s75, s75, 7
    s_add_u32 s73, s73, s75
    s_add_u32 s73, s73, 3998720
    v_and_b32 v3, 3, v1
    v_lshlrev_b32 v3, 7, v3
    v_bfe_u32 v6, v1, 2, 1
    v_mul_u32_u24 v6, s74, v6
    v_add3_u32 v3, v3, v6, s72
    v_and_b32 v6, 1, v1
    v_lshlrev_b32 v6, 8, v6
    v_add_u32 v6, s73, v6
    v_cmp_gt_u32 vcc, 8, v1
    s_nop 1
    v_cndmask_b32 v3, v6, v3, vcc
    s_lshl_b32 s10, s6, 8
    s_lshl_b32 s11, s8, 6
    s_add_u32 s10, s10, s11
    s_add_u32 s10, s10, 3948544
    v_and_b32 v8, 15, v1
    v_lshlrev_b32 v8, 2, v8
    s_cmp_ge_u32 s3, 2
    s_mov_b32 s73, 270336
    s_cselect_b32 s73, 2147483392, s73
    s_lshl_b32 s72, s3, 10
    s_add_u32 s72, s72, 81920
    v_add_u32 v6, s72, v251
    v_add_u32 v7, 40960, v247
    v_mov_b32 v12, 0
    v_mov_b32 v13, 897988541
    v_mov_b32 v14, 0
    v_mov_b32 v15, 0
    s_waitcnt lgkmcnt(0)
    s_barrier
    ds_read_b128 v[232:235], v245 offset:0
    ds_read_b128 v[228:231], v244 offset:0
    ds_read_b128 v[240:243], v245 offset:1344
    ds_read_b128 v[236:239], v244 offset:1344
    s_waitcnt lgkmcnt(2)
    v_mfma_f32_16x16x32_bf16 v[200:203], v[232:235], v[116:119], v[12:15]
    v_mfma_f32_16x16x32_bf16 v[208:211], v[232:235], v[136:139], v[12:15]
    v_mfma_f32_16x16x32_bf16 v[196:199], v[228:231], v[116:119], 0
    v_mfma_f32_16x16x32_bf16 v[204:207], v[228:231], v[136:139], 0
    s_waitcnt lgkmcnt(0)
    v_mfma_f32_16x16x32_bf16 v[216:219], v[240:243], v[118:121], v[12:15]
    ds_read_b128 v[232:235], v245 offset:2688
    ds_read_b128 v[228:231], v244 offset:2688
    v_mfma_f32_16x16x32_bf16 v[224:227], v[240:243], v[138:141], v[12:15]
    v_mfma_f32_16x16x32_bf16 v[212:215], v[236:239], v[118:121], 0
    v_mfma_f32_16x16x32_bf16 v[220:223], v[236:239], v[138:141], 0
    v_rcp_f32 v201, v201
    v_rcp_f32 v209, v209
    v_mul_f32 v196, v196, v201
    v_mul_f32 v197, v197, v201
    v_mul_f32 v198, v198, v201
    v_mul_f32 v199, v199, v201
    v_mul_f32 v4, v200, v201
    v_mul_f32 v204, v204, v209
    v_mul_f32 v205, v205, v209
    v_mul_f32 v206, v206, v209
    v_mul_f32 v207, v207, v209
    v_mul_f32 v5, v208, v209
    v_cvt_pk_bf16_f32 v116, v196, v197
    v_cvt_pk_bf16_f32 v117, v198, v199
    v_cvt_pk_bf16_f32 v136, v204, v205
    v_cvt_pk_bf16_f32 v137, v206, v207
    s_waitcnt lgkmcnt(0)
    v_mfma_f32_16x16x32_bf16 v[200:203], v[232:235], v[120:123], v[12:15]
    ds_read_b128 v[240:243], v245 offset:4032
    ds_read_b128 v[236:239], v244 offset:4032
    v_mfma_f32_16x16x32_bf16 v[208:211], v[232:235], v[140:143], v[12:15]
    v_rcp_f32 v217, v217
    v_rcp_f32 v225, v225
    v_mfma_f32_16x16x32_bf16 v[196:199], v[228:231], v[120:123], 0
    v_mul_f32 v212, v212, v217
    v_mul_f32 v213, v213, v217
    v_mfma_f32_16x16x32_bf16 v[204:207], v[228:231], v[140:143], 0
    v_mul_f32 v214, v214, v217
    v_mul_f32 v215, v215, v217
    v_mul_f32 v216, v216, v217
    v_mul_f32 v220, v220, v225
    v_mul_f32 v221, v221, v225
    v_mul_f32 v222, v222, v225
    v_mul_f32 v223, v223, v225
    v_mul_f32 v224, v224, v225
    v_cvt_pk_bf16_f32 v118, v4, v212
    v_cvt_pk_bf16_f32 v119, v213, v214
    v_cvt_pk_bf16_f32 v120, v215, v216
    v_cvt_pk_bf16_f32 v138, v5, v220
    v_cvt_pk_bf16_f32 v139, v221, v222
    v_cvt_pk_bf16_f32 v140, v223, v224
    s_waitcnt lgkmcnt(0)
    v_mfma_f32_16x16x32_bf16 v[216:219], v[240:243], v[122:125], v[12:15]
    ds_read_b128 v[232:235], v245 offset:5376
    ds_read_b128 v[228:231], v244 offset:5376
    v_mfma_f32_16x16x32_bf16 v[224:227], v[240:243], v[142:145], v[12:15]
    v_rcp_f32 v201, v201
    v_rcp_f32 v209, v209
    v_mfma_f32_16x16x32_bf16 v[212:215], v[236:239], v[122:125], 0
    v_mul_f32 v196, v196, v201
    v_mul_f32 v197, v197, v201
    v_mfma_f32_16x16x32_bf16 v[220:223], v[236:239], v[142:145], 0
    v_mul_f32 v198, v198, v201
    v_mul_f32 v199, v199, v201
    v_mfma_f32_16x16x32_bf16 v[156:159], v[16:19], v[116:119], 0
    v_mul_f32 v4, v200, v201
    v_mul_f32 v204, v204, v209
    v_mfma_f32_16x16x32_bf16 v[160:163], v[16:19], v[136:139], 0
    v_mul_f32 v205, v205, v209
    v_mul_f32 v206, v206, v209
    v_mfma_f32_16x16x32_bf16 v[164:167], v[20:23], v[116:119], 0
    v_mul_f32 v207, v207, v209
    v_mul_f32 v5, v208, v209
    v_mfma_f32_16x16x32_bf16 v[168:171], v[20:23], v[136:139], 0
    v_cvt_pk_bf16_f32 v121, v196, v197
    v_cvt_pk_bf16_f32 v122, v198, v199
    v_mfma_f32_16x16x32_bf16 v[172:175], v[24:27], v[116:119], 0
    v_cvt_pk_bf16_f32 v141, v204, v205
    v_cvt_pk_bf16_f32 v142, v206, v207
    buffer_load_dword v2, v3, s[60:63], 0 offen sc1
    s_waitcnt lgkmcnt(0)
    v_mfma_f32_16x16x32_bf16 v[200:203], v[232:235], v[126:129], v[12:15]
    ds_read_b128 v[240:243], v245 offset:6720
    ds_read_b128 v[236:239], v244 offset:6720
    v_mfma_f32_16x16x32_bf16 v[208:211], v[232:235], v[146:149], v[12:15]
    v_rcp_f32 v217, v217
    v_rcp_f32 v225, v225
    v_mfma_f32_16x16x32_bf16 v[196:199], v[228:231], v[126:129], 0
    v_mul_f32 v212, v212, v217
    v_mul_f32 v213, v213, v217
    v_mfma_f32_16x16x32_bf16 v[204:207], v[228:231], v[146:149], 0
    v_mul_f32 v214, v214, v217
    v_mul_f32 v215, v215, v217
    v_mfma_f32_16x16x32_bf16 v[176:179], v[24:27], v[136:139], 0
    v_mul_f32 v216, v216, v217
    v_mul_f32 v220, v220, v225
    v_mfma_f32_16x16x32_bf16 v[180:183], v[28:31], v[116:119], 0
    v_mul_f32 v221, v221, v225
    v_mul_f32 v222, v222, v225
    v_mfma_f32_16x16x32_bf16 v[184:187], v[28:31], v[136:139], 0
    v_mul_f32 v223, v223, v225
    v_mul_f32 v224, v224, v225
    v_mfma_f32_16x16x32_bf16 v[188:191], v[32:35], v[116:119], 0
    v_cvt_pk_bf16_f32 v123, v4, v212
    v_cvt_pk_bf16_f32 v124, v213, v214
    v_mfma_f32_16x16x32_bf16 v[192:195], v[32:35], v[136:139], 0
    v_cvt_pk_bf16_f32 v125, v215, v216
    v_cvt_pk_bf16_f32 v143, v5, v220
    v_cvt_pk_bf16_f32 v144, v221, v222
    v_cvt_pk_bf16_f32 v145, v223, v224
    s_waitcnt lgkmcnt(0)
    v_mfma_f32_16x16x32_bf16 v[216:219], v[240:243], v[128:131], v[12:15]
    ds_read_b128 v[232:235], v245 offset:8064
    ds_read_b128 v[228:231], v244 offset:8064
    v_mfma_f32_16x16x32_bf16 v[224:227], v[240:243], v[148:151], v[12:15]
    v_rcp_f32 v201, v201
    v_rcp_f32 v209, v209
    v_mfma_f32_16x16x32_bf16 v[212:215], v[236:239], v[128:131], 0
    v_mul_f32 v196, v196, v201
    v_mul_f32 v197, v197, v201
    v_mfma_f32_16x16x32_bf16 v[220:223], v[236:239], v[148:151], 0
    v_mul_f32 v198, v198, v201
    v_mul_f32 v199, v199, v201
    v_mfma_f32_16x16x32_bf16 v[156:159], v[36:39], v[120:123], v[156:159]
    v_mul_f32 v4, v200, v201
    v_mul_f32 v204, v204, v209
    v_mfma_f32_16x16x32_bf16 v[160:163], v[36:39], v[140:143], v[160:163]
    v_mul_f32 v205, v205, v209
    v_mul_f32 v206, v206, v209
    v_mfma_f32_16x16x32_bf16 v[164:167], v[40:43], v[120:123], v[164:167]
    v_mul_f32 v207, v207, v209
    v_mul_f32 v5, v208, v209
    v_mfma_f32_16x16x32_bf16 v[168:171], v[40:43], v[140:143], v[168:171]
    v_cvt_pk_bf16_f32 v126, v196, v197
    v_cvt_pk_bf16_f32 v127, v198, v199
    v_mfma_f32_16x16x32_bf16 v[172:175], v[44:47], v[120:123], v[172:175]
    v_cvt_pk_bf16_f32 v146, v204, v205
    v_cvt_pk_bf16_f32 v147, v206, v207
    s_waitcnt lgkmcnt(0)
    v_mfma_f32_16x16x32_bf16 v[200:203], v[232:235], v[130:133], v[12:15]
    ds_read_b128 v[240:243], v245 offset:9408
    ds_read_b128 v[236:239], v244 offset:9408
    v_mfma_f32_16x16x32_bf16 v[208:211], v[232:235], v[150:153], v[12:15]
    v_rcp_f32 v217, v217
    v_rcp_f32 v225, v225
    v_mfma_f32_16x16x32_bf16 v[196:199], v[228:231], v[130:133], 0
    v_mul_f32 v212, v212, v217
    v_mul_f32 v213, v213, v217
    v_mfma_f32_16x16x32_bf16 v[204:207], v[228:231], v[150:153], 0
    v_mul_f32 v214, v214, v217
    v_mul_f32 v215, v215, v217
    v_mfma_f32_16x16x32_bf16 v[176:179], v[44:47], v[140:143], v[176:179]
    v_mul_f32 v216, v216, v217
    v_mul_f32 v220, v220, v225
    v_mfma_f32_16x16x32_bf16 v[180:183], v[48:51], v[120:123], v[180:183]
    v_mul_f32 v221, v221, v225
    v_mul_f32 v222, v222, v225
    v_mfma_f32_16x16x32_bf16 v[184:187], v[48:51], v[140:143], v[184:187]
    v_mul_f32 v223, v223, v225
    v_mul_f32 v224, v224, v225
    v_mfma_f32_16x16x32_bf16 v[188:191], v[52:55], v[120:123], v[188:191]
    v_cvt_pk_bf16_f32 v128, v4, v212
    v_cvt_pk_bf16_f32 v129, v213, v214
    v_mfma_f32_16x16x32_bf16 v[192:195], v[52:55], v[140:143], v[192:195]
    v_cvt_pk_bf16_f32 v130, v215, v216
    v_cvt_pk_bf16_f32 v148, v5, v220
    v_cvt_pk_bf16_f32 v149, v221, v222
    v_cvt_pk_bf16_f32 v150, v223, v224
    s_waitcnt vmcnt(0)
    v_cmp_ne_u32 vcc, s0, v2
    s_cbranch_vccz L_yok
    s_mov_b32 s81, 100000
Lspin_56:
    buffer_load_dword v2, v3, s[60:63], 0 offen sc1
    s_waitcnt vmcnt(0)
    v_cmp_ne_u32 vcc, s0, v2
    s_cbranch_vccz Lspun_57
    s_sleep 2
    s_sub_u32 s81, s81, 1
    s_cbranch_scc0 Lspin_56
Lspun_57:
L_yok:
    buffer_load_dwordx4 v[16:19], v250, s[60:63], 0 offen sc1
    buffer_load_dwordx4 v[20:23], v250, s[60:63], s73 offen sc1
    buffer_load_dword v30, v8, s[60:63], s10 offen sc1
    s_cmp_eq_u32 s9, 0
    s_cselect_b32 s11, 0, 2147483392
    buffer_load_dwordx2 v[24:25], v248, s[44:47], 0 offen offset:0
    buffer_load_dwordx2 v[26:27], v248, s[44:47], 0 offen offset:64
    buffer_load_dwordx2 v[28:29], v248, s[44:47], s11 offen offset:128
    s_waitcnt lgkmcnt(0)
    v_mfma_f32_16x16x32_bf16 v[216:219], v[240:243], v[132:135], v[12:15]
    v_rcp_f32 v201, v201
    v_rcp_f32 v209, v209
    v_mfma_f32_16x16x32_bf16 v[224:227], v[240:243], v[152:155], v[12:15]
    v_mul_f32 v196, v196, v201
    v_mul_f32 v197, v197, v201
    v_mfma_f32_16x16x32_bf16 v[212:215], v[236:239], v[132:135], 0
    v_mul_f32 v198, v198, v201
    v_mul_f32 v199, v199, v201
    v_mfma_f32_16x16x32_bf16 v[220:223], v[236:239], v[152:155], 0
    v_mul_f32 v4, v200, v201
    v_mul_f32 v204, v204, v209
    v_mfma_f32_16x16x32_bf16 v[156:159], v[56:59], v[124:127], v[156:159]
    v_mul_f32 v205, v205, v209
    v_mul_f32 v206, v206, v209
    v_mfma_f32_16x16x32_bf16 v[160:163], v[56:59], v[144:147], v[160:163]
    v_mul_f32 v207, v207, v209
    v_mul_f32 v5, v208, v209
    v_mfma_f32_16x16x32_bf16 v[164:167], v[60:63], v[124:127], v[164:167]
    v_cvt_pk_bf16_f32 v131, v196, v197
    v_cvt_pk_bf16_f32 v132, v198, v199
    v_mfma_f32_16x16x32_bf16 v[168:171], v[60:63], v[144:147], v[168:171]
    v_cvt_pk_bf16_f32 v151, v204, v205
    v_cvt_pk_bf16_f32 v152, v206, v207
    v_mfma_f32_16x16x32_bf16 v[172:175], v[64:67], v[124:127], v[172:175]
    v_mfma_f32_16x16x32_bf16 v[176:179], v[64:67], v[144:147], v[176:179]
    v_rcp_f32 v217, v217
    v_rcp_f32 v225, v225
    v_mfma_f32_16x16x32_bf16 v[180:183], v[68:71], v[124:127], v[180:183]
    v_mul_f32 v212, v212, v217
    v_mul_f32 v213, v213, v217
    v_mfma_f32_16x16x32_bf16 v[184:187], v[68:71], v[144:147], v[184:187]
    v_mul_f32 v214, v214, v217
    v_mul_f32 v215, v215, v217
    v_mfma_f32_16x16x32_bf16 v[188:191], v[72:75], v[124:127], v[188:191]
    v_mul_f32 v216, v216, v217
    v_mul_f32 v220, v220, v225
    v_mfma_f32_16x16x32_bf16 v[192:195], v[72:75], v[144:147], v[192:195]
    v_mul_f32 v221, v221, v225
    v_mul_f32 v222, v222, v225
    v_mul_f32 v223, v223, v225
    v_mul_f32 v224, v224, v225
    v_cvt_pk_bf16_f32 v133, v4, v212
    v_cvt_pk_bf16_f32 v134, v213, v214
    v_cvt_pk_bf16_f32 v135, v215, v216
    v_cvt_pk_bf16_f32 v153, v5, v220
    v_cvt_pk_bf16_f32 v154, v221, v222
    v_cvt_pk_bf16_f32 v155, v223, v224
    v_mfma_f32_16x16x32_bf16 v[156:159], v[76:79], v[128:131], v[156:159]
    v_mfma_f32_16x16x32_bf16 v[160:163], v[76:79], v[148:151], v[160:163]
    v_mfma_f32_16x16x32_bf16 v[156:159], v[96:99], v[132:135], v[156:159]
    v_mfma_f32_16x16x32_bf16 v[160:163], v[96:99], v[152:155], v[160:163]
    v_mfma_f32_16x16x32_bf16 v[164:167], v[80:83], v[128:131], v[164:167]
    v_mfma_f32_16x16x32_bf16 v[168:171], v[80:83], v[148:151], v[168:171]
    v_mfma_f32_16x16x32_bf16 v[164:167], v[100:103], v[132:135], v[164:167]
    v_mfma_f32_16x16x32_bf16 v[168:171], v[100:103], v[152:155], v[168:171]
    v_mfma_f32_16x16x32_bf16 v[172:175], v[84:87], v[128:131], v[172:175]
    v_mfma_f32_16x16x32_bf16 v[176:179], v[84:87], v[148:151], v[176:179]
    v_mfma_f32_16x16x32_bf16 v[172:175], v[104:107], v[132:135], v[172:175]
    v_mfma_f32_16x16x32_bf16 v[176:179], v[104:107], v[152:155], v[176:179]
    ds_write_b128 v246, v[156:159] offset:0
    ds_write_b128 v246, v[160:163] offset:5120
    v_mfma_f32_16x16x32_bf16 v[180:183], v[88:91], v[128:131], v[180:183]
    v_mfma_f32_16x16x32_bf16 v[184:187], v[88:91], v[148:151], v[184:187]
    v_mfma_f32_16x16x32_bf16 v[180:183], v[108:111], v[132:135], v[180:183]
    v_mfma_f32_16x16x32_bf16 v[184:187], v[108:111], v[152:155], v[184:187]
    ds_write_b128 v246, v[164:167] offset:1024
    ds_write_b128 v246, v[168:171] offset:6144
    v_mfma_f32_16x16x32_bf16 v[188:191], v[92:95], v[128:131], v[188:191]
    v_mfma_f32_16x16x32_bf16 v[192:195], v[92:95], v[148:151], v[192:195]
    v_mfma_f32_16x16x32_bf16 v[188:191], v[112:115], v[132:135], v[188:191]
    v_mfma_f32_16x16x32_bf16 v[192:195], v[112:115], v[152:155], v[192:195]
    ds_write_b128 v246, v[172:175] offset:2048
    ds_write_b128 v246, v[176:179] offset:7168
    s_waitcnt vmcnt(0)
    ds_write_b128 v6, v[16:19]
    ds_write_b128 v6, v[20:23] offset:8192
    ds_write_b128 v246, v[180:183] offset:3072
    ds_write_b128 v246, v[184:187] offset:8192
    ds_write_b128 v246, v[188:191] offset:4096
    ds_write_b128 v246, v[192:195] offset:9216
    v_sub_f32 v31, 1.0, v30
    s_mov_b32 s10, 0xffff0000
    v_lshlrev_b32 v32, 16, v24
    v_and_b32 v33, s10, v24
    v_lshlrev_b32 v34, 16, v25
    v_and_b32 v35, s10, v25
    v_lshlrev_b32 v36, 16, v26
    v_and_b32 v37, s10, v26
    v_lshlrev_b32 v38, 16, v27
    v_and_b32 v39, s10, v27
    v_lshlrev_b32 v40, 16, v28
    v_and_b32 v41, s10, v28
    v_lshlrev_b32 v42, 16, v29
    v_and_b32 v43, s10, v29
    v_mul_f32 v32, v32, v31
    v_mul_f32 v33, v33, v31
    v_mul_f32 v34, v34, v31
    v_mul_f32 v35, v35, v31
    v_mul_f32 v36, v36, v31
    v_mul_f32 v37, v37, v31
    v_mul_f32 v38, v38, v31
    v_mul_f32 v39, v39, v31
    v_mul_f32 v40, v40, v31
    v_mul_f32 v41, v41, v31
    v_mul_f32 v42, v42, v31
    v_mul_f32 v43, v43, v31
    s_waitcnt lgkmcnt(0)
    s_barrier
    ds_read_b64_tr_b16 v[100:101], v249 offset:0
    ds_read_b128 v[48:51], v247 offset:0
    ds_read_b128 v[52:55], v247 offset:20480
    ds_read_b128 v[56:59], v7 offset:0
    ds_read_b128 v[60:63], v7 offset:20480
    ds_read_b64_tr_b16 v[102:103], v249 offset:4096
    ds_read_b128 v[64:67], v247 offset:2048
    ds_read_b128 v[68:71], v247 offset:22528
    ds_read_b128 v[72:75], v7 offset:2048
    ds_read_b128 v[76:79], v7 offset:22528
    ds_read_b64_tr_b16 v[104:105], v249 offset:8192
    ds_read_b128 v[80:83], v247 offset:4096
    ds_read_b128 v[84:87], v247 offset:24576
    ds_read_b128 v[88:91], v7 offset:4096
    ds_read_b128 v[92:95], v7 offset:24576
    s_waitcnt lgkmcnt(10)
    v_lshlrev_b32 v108, 16, v100
    v_and_b32 v109, s10, v100
    v_lshlrev_b32 v110, 16, v101
    v_and_b32 v111, s10, v101
    v_add_f32 v48, v48, v52
    v_add_f32 v56, v56, v60
    v_add_f32 v49, v49, v53
    v_add_f32 v57, v57, v61
    v_add_f32 v50, v50, v54
    v_add_f32 v58, v58, v62
    v_add_f32 v51, v51, v55
    v_add_f32 v59, v59, v63
    v_mul_f32 v108, v108, v32
    v_add_f32 v48, v48, v56
    v_mul_f32 v109, v109, v33
    v_add_f32 v49, v49, v57
    v_mul_f32 v110, v110, v34
    v_add_f32 v50, v50, v58
    v_mul_f32 v111, v111, v35
    v_add_f32 v51, v51, v59
    v_fmac_f32 v108, v48, v30
    v_fmac_f32 v109, v49, v30
    v_fmac_f32 v110, v50, v30
    v_fmac_f32 v111, v51, v30
    v_cvt_pk_bf16_f32 v48, v108, v109
    v_cvt_pk_bf16_f32 v49, v110, v111
    buffer_store_dwordx2 v[48:49], v248, s[52:55], 0 offen offset:0
    s_waitcnt lgkmcnt(5)
    v_lshlrev_b32 v108, 16, v102
    v_and_b32 v109, s10, v102
    v_lshlrev_b32 v110, 16, v103
    v_and_b32 v111, s10, v103
    v_add_f32 v64, v64, v68
    v_add_f32 v72, v72, v76
    v_add_f32 v65, v65, v69
    v_add_f32 v73, v73, v77
    v_add_f32 v66, v66, v70
    v_add_f32 v74, v74, v78
    v_add_f32 v67, v67, v71
    v_add_f32 v75, v75, v79
    v_mul_f32 v108, v108, v36
    v_add_f32 v64, v64, v72
    v_mul_f32 v109, v109, v37
    v_add_f32 v65, v65, v73
    v_mul_f32 v110, v110, v38
    v_add_f32 v66, v66, v74
    v_mul_f32 v111, v111, v39
    v_add_f32 v67, v67, v75
    v_fmac_f32 v108, v64, v30
    v_fmac_f32 v109, v65, v30
    v_fmac_f32 v110, v66, v30
    v_fmac_f32 v111, v67, v30
    v_cvt_pk_bf16_f32 v64, v108, v109
    v_cvt_pk_bf16_f32 v65, v110, v111
    buffer_store_dwordx2 v[64:65], v248, s[52:55], 0 offen offset:64
    s_cmp_eq_u32 s9, 0
    s_cbranch_scc0 L_done
    s_waitcnt lgkmcnt(0)
    v_lshlrev_b32 v108, 16, v104
    v_and_b32 v109, s10, v104
    v_lshlrev_b32 v110, 16, v105
    v_and_b32 v111, s10, v105
    v_add_f32 v80, v80, v84
    v_add_f32 v88, v88, v92
    v_add_f32 v81, v81, v85
    v_add_f32 v89, v89, v93
    v_add_f32 v82, v82, v86
    v_add_f32 v90, v90, v94
    v_add_f32 v83, v83, v87
    v_add_f32 v91, v91, v95
    v_mul_f32 v108, v108, v40
    v_add_f32 v80, v80, v88
    v_mul_f32 v109, v109, v41
    v_add_f32 v81, v81, v89
    v_mul_f32 v110, v110, v42
    v_add_f32 v82, v82, v90
    v_mul_f32 v111, v111, v43
    v_add_f32 v83, v83, v91
    v_fmac_f32 v108, v80, v30
    v_fmac_f32 v109, v81, v30
    v_fmac_f32 v110, v82, v30
    v_fmac_f32 v111, v83, v30
    v_cvt_pk_bf16_f32 v80, v108, v109
    v_cvt_pk_bf16_f32 v81, v110, v111
    buffer_store_dwordx2 v[80:81], v248, s[52:55], 0 offen offset:128
L_done:
L_end:
    s_endpgm
.section .rodata,"a"
.p2align 6
.amdhsa_kernel gated_mix__linear_attn_block__ssm_conv_h3__prompt_kernel
  .amdhsa_next_free_vgpr 256
  .amdhsa_next_free_sgpr 102
  .amdhsa_accum_offset 256
  .amdhsa_group_segment_fixed_size 0
  .amdhsa_kernarg_size 104
  .amdhsa_user_sgpr_count 2
  .amdhsa_user_sgpr_kernarg_segment_ptr 1
  .amdhsa_system_sgpr_workgroup_id_x 1
.end_amdhsa_kernel
```
